```python
import torch

def _softmax(x, axis=-1):
    return torch.softmax(x, dim=axis)
def _gelu(x):
    return torch.nn.functional.gelu(x, approximate="tanh")
def _silu(x):
    return torch.nn.functional.silu(x)
def _sigmoid(x):
    return torch.sigmoid(x)
def _layernorm(x, axis=-1, eps=1e-5):
    m = x.mean(dim=axis, keepdim=True)
    v = x.var(dim=axis, keepdim=True, unbiased=False)
    return (x - m) / torch.sqrt(v + eps)
def _scatter_add(tgt, idx, src, axis=0):
    return tgt.clone().index_add_(axis, idx, src)
def _segment_sum(src, seg, n):
    out = torch.zeros((n,) + src.shape[1:], dtype=src.dtype)
    return out.index_add_(0, seg, src)
def _pad(x, pw):
    flat = tuple(v for pair in reversed(pw) for v in pair)
    return torch.nn.functional.pad(x, flat)

kernel_name = 'gated_mix__mha_block__mixer_token_mlp__prompt'

def setup_inputs():

    _w = (lambda a: (lambda t: t.to(torch.bfloat16) if t.is_floating_point() else t)(torch.as_tensor(a)))
    def _A_setup():
        B, S, D, H = 1, 2048, 640, 32
        return {
            "x": _w((lambda *s: torch.randn(*s, dtype=torch.bfloat16) * 0.05)(B, S, D)),
            "wqkv": _w((lambda *s: torch.randn(*s, dtype=torch.bfloat16) * 0.8)(D, 3 * D)),
            "wo": _w((lambda *s: torch.randn(*s, dtype=torch.bfloat16) * 0.05)(D, D)),
        }
    _A_in = _A_setup()

    def _B_setup():
        B, S, D, F = 1, 2048, 640, 1536
        return {
            "x": _w((lambda *s: torch.randn(*s, dtype=torch.bfloat16) * 0.05)(B, S, D)),
            "w1": _w((lambda *s: torch.randn(*s, dtype=torch.bfloat16) * 0.8)(S, F) * (S ** -0.5)),
            "b1": _w((lambda *s: torch.randn(*s, dtype=torch.bfloat16) * 12.8)(F) * 0.02),
            "w2": _w((lambda *s: torch.randn(*s, dtype=torch.bfloat16) * 0.1)(F, S) * (F ** -0.5)),
            "b2": _w((lambda *s: torch.randn(*s, dtype=torch.bfloat16) * 0.8)(S) * 0.02),
        }
    _B_in = _B_setup()

    return {
        "A_x": _A_in["x"],
        "A_wqkv": _A_in["wqkv"],
        "A_wo": _A_in["wo"],
        "B_x": _B_in["x"],
        "B_w1": _B_in["w1"],
        "B_b1": _B_in["b1"],
        "B_w2": _B_in["w2"],
        "B_b2": _B_in["b2"],
        "gate_w": _w((lambda *s: torch.randn(*s, dtype=torch.bfloat16) * 0.05)(640) * 16.0),
    }

def reference(A_x, A_wqkv, A_wo, B_x, B_w1, B_b1, B_w2, B_b2, gate_w):
    def _A_ref(x, wqkv, wo):
        B, S, D = x.shape
        H = 32
        Dh = D // H
        qkv = (lambda x, *d: x.permute(*d))((x @ wqkv).reshape(B, S, 3, H, Dh), 2, 0, 3, 1, 4)
        q, k, v = qkv[0], qkv[1], qkv[2]
        scores = torch.einsum("bhqd,bhkd->bhqk", q, k) * (Dh ** -0.5)
        p = _softmax(scores, axis=-1)
        o = torch.einsum("bhqk,bhkd->bhqd", p, v)
        return (lambda x, *d: x.permute(*d))(o, 0, 2, 1, 3).reshape(B, S, D) @ wo

    def _B_ref(x, w1, b1, w2, b2):
        B, S, D = x.shape
        h = _layernorm(x, axis=-1)
        u = torch.einsum("bsd,sf->bdf", h, w1) + b1
        u = _gelu(u)
        y = torch.einsum("bdf,fs->bds", u, w2) + b2
        return (lambda x, *d: x.permute(*d))(y, 0, 2, 1)

    x = A_x
    g = _sigmoid((x * gate_w).sum(-1, keepdims=True))
    a = _A_ref(x, A_wqkv, A_wo)
    b = _B_ref(x, B_w1, B_b1, B_w2, B_b2)
    return g * a + (1 - g) * b
```

```asm
; @launch grid=(256,1,1) block=(512,1,1) lds=161856
.amdgcn_target "amdgcn-amd-amdhsa--gfx950"
.text
.globl gated_mix__mha_block__mixer_token_mlp__prompt_kernel
.p2align 8
.type gated_mix__mha_block__mixer_token_mlp__prompt_kernel,@function
gated_mix__mha_block__mixer_token_mlp__prompt_kernel:
    s_cmp_ge_u32 s2, 256
    s_cbranch_scc1 L_end
    s_load_dwordx16 s[16:31], s[0:1], 0
    s_load_dwordx8 s[32:39], s[0:1], 64
    s_getpc_b64 s[68:69]
    v_lshrrev_b32 v2, 6, v0
    v_and_b32 v1, 63, v0
    s_and_b32 s78, s2, 7
    s_lshr_b32 s79, s2, 3
    v_readfirstlane_b32 s76, v2
    s_and_b32 s3, s78, 1
    s_mul_i32 s3, s3, 30
    s_add_u32 s3, s3, s79
    s_lshr_b32 s81, s3, 2
    s_and_b32 s80, s3, 3
    s_and_b32 s3, s78, 6
    s_lshl_b32 s3, s3, 1
    s_add_u32 s80, s80, s3
    s_and_b32 s77, s76, 3
    s_and_b32 s83, s76, 1
    s_lshr_b32 s84, s77, 1
    s_cmp_ge_u32 s76, 4
    s_cbranch_scc1 L_T
    s_and_b32 s68, s68, 0xffffff00
    s_mov_b32 s70, 0xa200
    s_mov_b32 s71, 0x20000
    s_mul_i32 s3, s79, 1408
    v_lshlrev_b32 v8, 7, v0
    s_cmp_lg_u32 s76, 0
    s_cbranch_scc1 L_npf_1
    s_mov_b64 exec, 0x7ff
    buffer_load_dword v223, v8, s[68:71], s3 offen
    s_mov_b64 exec, -1
L_npf_1:
    s_lshl_b32 s82, s78, 5
    s_add_u32 s82, s82, s79
    s_lshl_b32 s3, s82, 2
    s_add_u32 s3, s3, s77
    s_mul_i32 s3, s3, 2560
    v_lshrrev_b32 v9, 5, v1
    v_mul_u32_u24 v10, 1280, v9
    v_and_b32 v8, 31, v1
    v_lshlrev_b32 v14, 4, v8
    v_lshlrev_b32 v15, 3, v8
    v_add_u32 v12, v10, v14
    v_add_u32 v13, v10, v15
    s_waitcnt lgkmcnt(0)
    s_mov_b32 s4, s16
    s_mov_b32 s5, s17
    s_mov_b32 s6, 2621440
    s_mov_b32 s7, 0x20000
    s_mov_b32 s60, s32
    s_mov_b32 s61, s33
    s_mov_b32 s62, 1280
    s_mov_b32 s63, 0x20000
    buffer_load_dwordx4 v[200:203], v12, s[4:7], s3 offen
    buffer_load_dwordx4 v[204:207], v12, s[4:7], s3 offen offset:512
    buffer_load_dwordx2 v[208:209], v13, s[4:7], s3 offen offset:1024
    buffer_load_dwordx4 v[210:213], v14, s[60:63], 0 offen
    buffer_load_dwordx4 v[214:217], v14, s[60:63], 0 offen offset:512
    buffer_load_dwordx2 v[218:219], v15, s[60:63], 0 offen offset:1024
    s_mov_b32 s12, s38
    s_mov_b32 s13, s39
    s_mov_b32 s14, 21889024
    s_mov_b32 s15, 0x20000
    s_load_dwordx2 s[72:73], s[38:39], 0
    s_branch L_M
L_T:
    s_lshl_b32 s3, s80, 2
    s_add_u32 s3, s3, s77
    s_mul_i32 s3, s3, 40960
    v_lshrrev_b32 v16, 3, v1
    v_mul_u32_u24 v16, 1280, v16
    v_add_u32 v16, s3, v16
    v_and_b32 v17, 7, v1
    v_lshrrev_b32 v18, 4, v1
    v_xor_b32 v17, v17, v18
    v_lshl_add_u32 v2, v17, 4, v16
    v_xor_b32 v19, 64, v2
    v_add_u32 v3, 9216, v19
    v_add_u32 v4, 18432, v2
    v_add_u32 v5, 27648, v19
    s_mul_i32 s3, s77, 61440
    s_lshl_b32 s85, s81, 8
    s_add_u32 s3, s3, s85
    v_and_b32 v17, 15, v1
    v_lshlrev_b32 v19, 1, v18
    v_xor_b32 v17, v17, v19
    v_lshlrev_b32 v17, 4, v17
    v_mul_u32_u24 v16, 3840, v18
    v_add3_u32 v6, v16, v17, s3
    v_xor_b32 v19, 128, v6
    v_add_u32 v7, 14336, v6
    v_add_u32 v8, 28672, v19
    v_add_u32 v9, 43008, v19
    s_lshl_b32 s62, s77, 12
    s_add_u32 s63, s62, 65536
    s_and_b32 s3, s80, 3
    s_mul_i32 s3, s3, 5
    s_add_u32 s3, s3, 1
    s_lshr_b32 s3, s3, 1
    s_add_u32 s3, s3, s81
    s_mul_i32 s85, s3, 26
    s_lshr_b32 s85, s85, 8
    s_mul_i32 s85, s85, 10
    s_sub_u32 s3, s3, s85
    s_lshl_b32 s60, s3, 7
    s_mul_i32 s61, s3, 245760
    s_waitcnt lgkmcnt(0)
    s_mov_b32 s4, s16
    s_mov_b32 s5, s17
    s_mov_b32 s6, 2621440
    s_mov_b32 s7, 0x20000
    s_mov_b32 s8, s18
    s_mov_b32 s9, s19
    s_mov_b32 s10, 2457600
    s_mov_b32 s11, 0x20000
    s_cmp_ge_u32 s79, 30
    s_cbranch_scc1 L_nost0_2
    s_add_u32 m0, s62, 0
    s_nop 0
    buffer_load_dwordx4 v2, s[4:7], s60 offen offset:0  lds
    buffer_load_dwordx4 v3, s[4:7], s60 offen offset:1024  lds
    buffer_load_dwordx4 v4, s[4:7], s60 offen offset:2048  lds
    buffer_load_dwordx4 v5, s[4:7], s60 offen offset:3072  lds
    s_add_u32 s60, s60, 128
    s_add_u32 m0, s63, 0
    s_nop 0
    buffer_load_dwordx4 v6, s[8:11], s61 offen offset:0  lds
    buffer_load_dwordx4 v7, s[8:11], s61 offen offset:1024  lds
    buffer_load_dwordx4 v8, s[8:11], s61 offen offset:2048  lds
    buffer_load_dwordx4 v9, s[8:11], s61 offen offset:3072  lds
    s_add_u32 s61, s61, 245760
    s_cmp_eq_u32 s60, 1280
    s_cselect_b32 s60, 0, s60
    s_cselect_b32 s61, 0, s61
L_nost0_2:
    s_mov_b32 s12, s38
    s_mov_b32 s13, s39
    s_mov_b32 s14, 21889024
    s_mov_b32 s15, 0x20000
    s_load_dwordx2 s[72:73], s[38:39], 0
    v_lshlrev_b32 v19, 4, v1
    s_mul_i32 s3, s79, 52
    s_lshr_b32 s3, s3, 8
    s_mul_i32 s37, s3, 5
    s_sub_u32 s37, s79, s37
    s_and_b32 s36, s78, 1
    s_mul_i32 s36, s36, 6
    s_add_u32 s36, s36, s3
    s_lshr_b32 s22, s78, 1
    s_mov_b32 s40, s24
    s_mov_b32 s41, s25
    s_mov_b32 s42, 6291456
    s_mov_b32 s43, 0x20000
    s_mov_b64 s[44:45], s[28:29]
    s_mov_b64 s[48:49], s[20:21]
    s_mov_b64 s[64:65], s[34:35]
    s_mov_b64 s[66:67], s[30:31]
    s_lshl_b32 s3, s22, 5
    s_add_u32 s3, s3, s77
    s_mul_i32 s3, s3, 49152
    s_lshl_b32 s85, s36, 8
    s_add_u32 s3, s3, s85
    v_mul_u32_u24 v16, 3072, v18
    v_add3_u32 v12, v16, v17, s3
    v_xor_b32 v16, 128, v12
    v_add_u32 v13, 11264, v12
    v_add_u32 v14, 22528, v16
    v_add_u32 v15, 33792, v16
    s_lshl_b32 s3, s22, 5
    s_add_u32 s3, s3, s77
    s_mul_i32 s3, s3, 20480
    s_lshl_b32 s85, s37, 11
    s_add_u32 s3, s3, s85
    s_add_u32 s3, s3, 8617984
    v_add_u32 v10, s3, v19
    v_add_u32 v11, 8192, v10
    s_lshl_b32 s3, s22, 10
    s_add_u32 s3, s3, 4096
    v_add_u32 v30, s3, v19
    s_lshl_b32 s21, s78, 2
    s_lshr_b32 s3, s79, 3
    s_add_u32 s21, s21, s3
    s_and_b32 s34, s79, 7
    s_lshl_b32 s34, s34, 1
    s_add_u32 s34, s34, s84
    s_mul_i32 s23, s21, 20
    s_add_u32 s35, s23, 19
    s_lshr_b32 s33, s23, 7
    s_lshr_b32 s35, s35, 7
    v_bfe_u32 v22, v1, 3, 1
    s_sub_u32 s3, s35, s33
    v_mul_u32_u24 v22, s3, v22
    v_add_u32 v22, s33, v22
    v_lshrrev_b32 v23, 4, v1
    v_add_u32 v23, 1, v23
    v_mul_u32_u24 v23, 5, v23
    v_and_b32 v24, 7, v1
    s_lshl_b32 s3, s83, 3
    v_add_u32 v24, s3, v24
    v_cmp_gt_u32 vcc, 32, v1
    v_mov_b32 v25, s34
    s_nop 0
    v_cndmask_b32 v23, 0, v23, vcc
    v_cndmask_b32 v24, v25, v24, vcc
    v_add_u32 v22, v22, v23
    v_lshl_add_u32 v22, v22, 4, v24
    v_lshlrev_b32 v22, 4, v22
    v_add_u32 v31, 8192, v22
    v_lshrrev_b32 v22, 3, v1
    v_lshlrev_b32 v22, 7, v22
    v_lshl_add_u32 v22, v24, 3, v22
    s_lshl_b32 s3, s21, 10
    s_add_u32 s3, s3, 524288
    v_add_u32 v31, s3, v22
    s_cmp_eq_u32 s33, s35
    s_cselect_b32 s56, 0x00ff00ff, -1
    s_cselect_b32 s57, 1, 0x101
    v_and_b32 v20, 31, v1
    v_lshrrev_b32 v21, 5, v1
    s_and_b32 s3, s21, 1
    v_add_u32 v22, s3, v21
    v_lshlrev_b32 v22, 15, v22
    v_lshl_add_u32 v60, v20, 4, v22
    s_cmp_eq_u32 s3, 0
    s_cselect_b32 s3, 0x10000, 8
    v_lshl_add_u32 v22, v20, 4, s3
    v_lshl_add_u32 v122, v21, 31, v22
    s_mul_i32 s3, s21, 5
    s_lshr_b32 s3, s3, 1
    s_sub_u32 s3, s33, s3
    s_lshl_b32 s3, s3, 15
    s_add_u32 s3, s3, 12615680
    v_mov_b32 v23, s3
    v_cmp_gt_u32 vcc, 32, v1
    s_nop 1
    v_cndmask_b32 v61, v23, v22, vcc
    s_lshl_b32 s29, s34, 1
    s_add_u32 s29, s29, s83
    v_lshrrev_b32 v22, 3, v20
    v_lshlrev_b32 v22, 7, v22
    v_and_b32 v23, 7, v1
    v_lshl_add_u32 v22, v23, 2, v22
    s_lshl_b32 s3, s29, 10
    s_add_u32 s3, s3, 229376
    v_add_u32 v63, s3, v22
    v_add_u32 v22, s23, v20
    v_lshrrev_b32 v23, 7, v22
    v_and_b32 v22, 127, v22
    v_cmp_gt_u32 vcc, 20, v20
    v_mov_b32 v24, s33
    v_mov_b32 v25, 128
    v_cndmask_b32 v23, v24, v23, vcc
    v_cndmask_b32 v22, v25, v22, vcc
    v_mul_u32_u24 v23, 557056, v23
    v_lshl_add_u32 v23, v22, 4, v23
    v_mul_u32_u24 v24, 4352, v21
    v_add_u32 v62, v23, v24
    s_mov_b32 s30, 0xeef00000
    s_mov_b32 s31, 0xeef00000
    v_mov_b32 v24, 0x80000000
    v_cndmask_b32 v62, v62, v24, s[30:31]
    s_mul_i32 s26, s21, 5
    s_lshr_b32 s26, s26, 1
    s_lshl_b32 s26, s26, 15
    s_add_u32 s26, s26, 589824
    s_lshl_b32 s3, s83, 14
    s_add_u32 s27, s26, s3
    s_add_u32 s27, s27, 2621440
    s_lshl_b32 s3, s34, 11
    s_add_u32 s26, s26, s3
    s_mul_i32 s28, s83, 278528
    s_add_u32 s28, s28, 5832704
    s_mov_b32 s20, 0
    s_mov_b32 s55, 0
    s_mul_i32 s3, s77, 6656
    s_add_u32 s3, s3, 135168
    v_lshl_add_u32 v240, v1, 4, s3
    v_lshl_add_u32 v241, v20, 3, s3
    s_xor_b32 s3, s77, 1
    s_mul_i32 s3, s3, 6656
    s_add_u32 s3, s3, 135168
    v_lshl_add_u32 v242, v1, 4, s3
    v_lshl_add_u32 v243, v20, 3, s3
    s_lshl_b32 s3, s84, 2
    s_add_u32 s3, s3, 161792
    v_mov_b32 v244, s3
    v_lshlrev_b32 v245, 15, v21
    v_lshl_add_u32 v245, v20, 4, v245
    v_lshlrev_b32 v246, 31, v21
    v_lshl_add_u32 v246, v20, 3, v246
    s_lshl_b32 s52, s21, 16
    s_lshl_b32 s3, s29, 10
    s_add_u32 s52, s52, s3
    s_add_u32 s52, s52, 13205504
    s_lshl_b32 s53, s21, 14
    s_lshl_b32 s3, s29, 9
    s_add_u32 s53, s53, s3
    s_add_u32 s53, s53, 15302656
    s_lshl_b32 s54, s29, 5
    s_add_u32 s54, s54, s21
    s_lshl_b32 s54, s54, 7
    s_add_u32 s54, s54, 98304
    v_mov_b64 v[128:129], 0
    v_mov_b64 v[130:131], 0
    v_mov_b64 v[132:133], 0
    v_mov_b64 v[134:135], 0
    v_mov_b64 v[136:137], 0
    v_mov_b64 v[138:139], 0
    v_mov_b64 v[140:141], 0
    v_mov_b64 v[142:143], 0
    v_mov_b64 v[144:145], 0
    v_mov_b64 v[146:147], 0
    v_mov_b64 v[148:149], 0
    v_mov_b64 v[150:151], 0
    v_mov_b64 v[152:153], 0
    v_mov_b64 v[154:155], 0
    v_mov_b64 v[156:157], 0
    v_mov_b64 v[158:159], 0
    v_mov_b64 v[160:161], 0
    v_mov_b64 v[162:163], 0
    v_mov_b64 v[164:165], 0
    v_mov_b64 v[166:167], 0
    v_mov_b64 v[168:169], 0
    v_mov_b64 v[170:171], 0
    v_mov_b64 v[172:173], 0
    v_mov_b64 v[174:175], 0
    v_mov_b64 v[176:177], 0
    v_mov_b64 v[178:179], 0
    v_mov_b64 v[180:181], 0
    v_mov_b64 v[182:183], 0
    v_mov_b64 v[184:185], 0
    v_mov_b64 v[186:187], 0
    v_mov_b64 v[188:189], 0
    v_mov_b64 v[190:191], 0
    v_mov_b32 v254, 161792
    v_mov_b32 v255, 1
    s_waitcnt lgkmcnt(0)
    s_mul_i32 s74, s72, 1664525
    s_add_u32 s74, s74, 1013904223
    s_mul_i32 s75, s73, 22695477
    s_add_u32 s75, s75, 0x3c6ef35f
    s_cmp_ge_u32 s79, 30
    s_cbranch_scc1 L_T_idle
    s_add_u32 m0, s62, 16384
    s_nop 0
    buffer_load_dwordx4 v2, s[4:7], s60 offen offset:0  lds
    buffer_load_dwordx4 v3, s[4:7], s60 offen offset:1024  lds
    buffer_load_dwordx4 v4, s[4:7], s60 offen offset:2048  lds
    buffer_load_dwordx4 v5, s[4:7], s60 offen offset:3072  lds
    s_add_u32 s60, s60, 128
    s_add_u32 m0, s63, 16384
    s_nop 0
    buffer_load_dwordx4 v6, s[8:11], s61 offen offset:0  lds
    buffer_load_dwordx4 v7, s[8:11], s61 offen offset:1024  lds
    buffer_load_dwordx4 v8, s[8:11], s61 offen offset:2048  lds
    buffer_load_dwordx4 v9, s[8:11], s61 offen offset:3072  lds
    s_add_u32 s61, s61, 245760
    s_cmp_eq_u32 s60, 1280
    s_cselect_b32 s60, 0, s60
    s_cselect_b32 s61, 0, s61
    s_waitcnt vmcnt(8)
    s_barrier
    s_add_u32 m0, s62, 32768
    s_nop 0
    buffer_load_dwordx4 v2, s[4:7], s60 offen offset:0  lds
    buffer_load_dwordx4 v3, s[4:7], s60 offen offset:1024  lds
    buffer_load_dwordx4 v4, s[4:7], s60 offen offset:2048  lds
    buffer_load_dwordx4 v5, s[4:7], s60 offen offset:3072  lds
    s_add_u32 s60, s60, 128
    s_add_u32 m0, s63, 32768
    s_nop 0
    buffer_load_dwordx4 v6, s[8:11], s61 offen offset:0  lds
    buffer_load_dwordx4 v7, s[8:11], s61 offen offset:1024  lds
    buffer_load_dwordx4 v8, s[8:11], s61 offen offset:2048  lds
    buffer_load_dwordx4 v9, s[8:11], s61 offen offset:3072  lds
    s_add_u32 s61, s61, 245760
    s_cmp_eq_u32 s60, 1280
    s_cselect_b32 s60, 0, s60
    s_cselect_b32 s61, 0, s61
    s_waitcnt vmcnt(8)
    s_barrier
    s_add_u32 m0, s62, 49152
    s_nop 0
    buffer_load_dwordx4 v2, s[4:7], s60 offen offset:0  lds
    buffer_load_dwordx4 v3, s[4:7], s60 offen offset:1024  lds
    buffer_load_dwordx4 v4, s[4:7], s60 offen offset:2048  lds
    buffer_load_dwordx4 v5, s[4:7], s60 offen offset:3072  lds
    s_add_u32 s60, s60, 128
    s_add_u32 m0, s63, 49152
    s_nop 0
    buffer_load_dwordx4 v6, s[8:11], s61 offen offset:0  lds
    buffer_load_dwordx4 v7, s[8:11], s61 offen offset:1024  lds
    buffer_load_dwordx4 v8, s[8:11], s61 offen offset:2048  lds
    buffer_load_dwordx4 v9, s[8:11], s61 offen offset:3072  lds
    s_add_u32 s61, s61, 245760
    s_cmp_eq_u32 s60, 1280
    s_cselect_b32 s60, 0, s60
    s_cselect_b32 s61, 0, s61
    s_waitcnt vmcnt(8)
    s_barrier
    s_add_u32 m0, s62, 0
    s_nop 0
    buffer_load_dwordx4 v2, s[4:7], s60 offen offset:0  lds
    buffer_load_dwordx4 v3, s[4:7], s60 offen offset:1024  lds
    buffer_load_dwordx4 v4, s[4:7], s60 offen offset:2048  lds
    buffer_load_dwordx4 v5, s[4:7], s60 offen offset:3072  lds
    s_add_u32 s60, s60, 128
    s_add_u32 m0, s63, 0
    s_nop 0
    buffer_load_dwordx4 v6, s[8:11], s61 offen offset:0  lds
    buffer_load_dwordx4 v7, s[8:11], s61 offen offset:1024  lds
    buffer_load_dwordx4 v8, s[8:11], s61 offen offset:2048  lds
    buffer_load_dwordx4 v9, s[8:11], s61 offen offset:3072  lds
    s_add_u32 s61, s61, 245760
    s_cmp_eq_u32 s60, 1280
    s_cselect_b32 s60, 0, s60
    s_cselect_b32 s61, 0, s61
    s_waitcnt vmcnt(8)
    s_barrier
    s_add_u32 m0, s62, 16384
    s_nop 0
    buffer_load_dwordx4 v2, s[4:7], s60 offen offset:0  lds
    buffer_load_dwordx4 v3, s[4:7], s60 offen offset:1024  lds
    buffer_load_dwordx4 v4, s[4:7], s60 offen offset:2048  lds
    buffer_load_dwordx4 v5, s[4:7], s60 offen offset:3072  lds
    s_add_u32 s60, s60, 128
    s_add_u32 m0, s63, 16384
    s_nop 0
    buffer_load_dwordx4 v6, s[8:11], s61 offen offset:0  lds
    buffer_load_dwordx4 v7, s[8:11], s61 offen offset:1024  lds
    buffer_load_dwordx4 v8, s[8:11], s61 offen offset:2048  lds
    buffer_load_dwordx4 v9, s[8:11], s61 offen offset:3072  lds
    s_add_u32 s61, s61, 245760
    s_cmp_eq_u32 s60, 1280
    s_cselect_b32 s60, 0, s60
    s_cselect_b32 s61, 0, s61
    s_waitcnt vmcnt(8)
    s_barrier
    s_add_u32 m0, s62, 32768
    s_nop 0
    buffer_load_dwordx4 v2, s[4:7], s60 offen offset:0  lds
    buffer_load_dwordx4 v3, s[4:7], s60 offen offset:1024  lds
    buffer_load_dwordx4 v4, s[4:7], s60 offen offset:2048  lds
    buffer_load_dwordx4 v5, s[4:7], s60 offen offset:3072  lds
    s_add_u32 s60, s60, 128
    s_add_u32 m0, s63, 32768
    s_nop 0
    buffer_load_dwordx4 v6, s[8:11], s61 offen offset:0  lds
    buffer_load_dwordx4 v7, s[8:11], s61 offen offset:1024  lds
    buffer_load_dwordx4 v8, s[8:11], s61 offen offset:2048  lds
    buffer_load_dwordx4 v9, s[8:11], s61 offen offset:3072  lds
    s_add_u32 s61, s61, 245760
    s_cmp_eq_u32 s60, 1280
    s_cselect_b32 s60, 0, s60
    s_cselect_b32 s61, 0, s61
    s_waitcnt vmcnt(8)
    s_barrier
    s_add_u32 m0, s62, 49152
    s_nop 0
    buffer_load_dwordx4 v2, s[4:7], s60 offen offset:0  lds
    buffer_load_dwordx4 v3, s[4:7], s60 offen offset:1024  lds
    buffer_load_dwordx4 v4, s[4:7], s60 offen offset:2048  lds
    buffer_load_dwordx4 v5, s[4:7], s60 offen offset:3072  lds
    s_add_u32 s60, s60, 128
    s_add_u32 m0, s63, 49152
    s_nop 0
    buffer_load_dwordx4 v6, s[8:11], s61 offen offset:0  lds
    buffer_load_dwordx4 v7, s[8:11], s61 offen offset:1024  lds
    buffer_load_dwordx4 v8, s[8:11], s61 offen offset:2048  lds
    buffer_load_dwordx4 v9, s[8:11], s61 offen offset:3072  lds
    s_add_u32 s61, s61, 245760
    s_cmp_eq_u32 s60, 1280
    s_cselect_b32 s60, 0, s60
    s_cselect_b32 s61, 0, s61
    s_waitcnt vmcnt(8)
    s_barrier
    s_add_u32 m0, s62, 0
    s_nop 0
    buffer_load_dwordx4 v2, s[4:7], s60 offen offset:0  lds
    buffer_load_dwordx4 v3, s[4:7], s60 offen offset:1024  lds
    buffer_load_dwordx4 v4, s[4:7], s60 offen offset:2048  lds
    buffer_load_dwordx4 v5, s[4:7], s60 offen offset:3072  lds
    s_add_u32 s60, s60, 128
    s_add_u32 m0, s63, 0
    s_nop 0
    buffer_load_dwordx4 v6, s[8:11], s61 offen offset:0  lds
    buffer_load_dwordx4 v7, s[8:11], s61 offen offset:1024  lds
    buffer_load_dwordx4 v8, s[8:11], s61 offen offset:2048  lds
    buffer_load_dwordx4 v9, s[8:11], s61 offen offset:3072  lds
    s_add_u32 s61, s61, 245760
    s_cmp_eq_u32 s60, 1280
    s_cselect_b32 s60, 0, s60
    s_cselect_b32 s61, 0, s61
    s_waitcnt vmcnt(8)
    s_barrier
    s_add_u32 m0, s62, 16384
    s_nop 0
    buffer_load_dwordx4 v2, s[4:7], s60 offen offset:0  lds
    buffer_load_dwordx4 v3, s[4:7], s60 offen offset:1024  lds
    buffer_load_dwordx4 v4, s[4:7], s60 offen offset:2048  lds
    buffer_load_dwordx4 v5, s[4:7], s60 offen offset:3072  lds
    s_add_u32 s60, s60, 128
    s_add_u32 m0, s63, 16384
    s_nop 0
    buffer_load_dwordx4 v6, s[8:11], s61 offen offset:0  lds
    buffer_load_dwordx4 v7, s[8:11], s61 offen offset:1024  lds
    buffer_load_dwordx4 v8, s[8:11], s61 offen offset:2048  lds
    buffer_load_dwordx4 v9, s[8:11], s61 offen offset:3072  lds
    s_add_u32 s61, s61, 245760
    s_cmp_eq_u32 s60, 1280
    s_cselect_b32 s60, 0, s60
    s_cselect_b32 s61, 0, s61
    s_waitcnt vmcnt(8)
    s_barrier
    buffer_load_dwordx2 v[28:29], v30, s[12:15], 0 offen sc1
    s_mul_i32 s3, s37, 3
    s_add_u32 s3, s3, 1
    s_lshr_b32 s3, s3, 1
    s_mul_i32 s85, s36, 344
    s_add_u32 s85, s85, 86
    s_lshr_b32 s85, s85, 8
    s_add_u32 s3, s3, s85
    s_and_b32 s3, s3, 7
    s_mul_i32 s60, s3, 81920
    s_mul_i32 s61, s3, 196608
    s_add_u32 s3, s37, s36
    s_add_u32 s3, s3, 0
    s_and_b32 s3, s3, 3
    s_add_u32 s3, s3, 0
    s_mul_i32 s60, s3, 81920
    s_mul_i32 s61, s3, 196608
    s_add_u32 m0, s63, 32768
    s_nop 0
    buffer_load_dwordx4 v12, s[40:43], s61 offen offset:0  lds
    buffer_load_dwordx4 v13, s[40:43], s61 offen offset:1024  lds
    buffer_load_dwordx4 v14, s[40:43], s61 offen offset:2048  lds
    buffer_load_dwordx4 v15, s[40:43], s61 offen offset:3072  lds
    s_add_u32 s61, s61, 196608
    s_waitcnt vmcnt(4)
    v_cmp_ne_u64 vcc, s[74:75], v[28:29]
    s_cbranch_vccz L_hok_3
    s_mov_b32 s82, 65536
L_po_4:
    buffer_load_dwordx2 v[28:29], v30, s[12:15], 0 offen sc1
    s_waitcnt vmcnt(0)
    v_cmp_ne_u64 vcc, s[74:75], v[28:29]
    s_cbranch_vccz L_pod_5
    s_sleep 1
    s_sub_u32 s82, s82, 1
    s_cmp_lg_u32 s82, 0
    s_cbranch_scc1 L_po_4
L_pod_5:
L_hok_3:
    s_add_u32 m0, s62, 32768
    s_nop 0
    buffer_load_dwordx4 v10, s[12:15], s60 offen offset:0 sc1 lds
    buffer_load_dwordx4 v10, s[12:15], s60 offen offset:1024 sc1 lds
    buffer_load_dwordx4 v11, s[12:15], s60 offen offset:2048 sc1 lds
    buffer_load_dwordx4 v11, s[12:15], s60 offen offset:3072 sc1 lds
    s_add_u32 s60, s60, 81920
    s_cmp_eq_u32 s60, 655360
    s_cselect_b32 s60, 0, s60
    s_cselect_b32 s61, 0, s61
    s_waitcnt vmcnt(9)
    s_barrier
    s_add_u32 s3, s37, s36
    s_add_u32 s3, s3, 1
    s_and_b32 s3, s3, 3
    s_add_u32 s3, s3, 0
    s_mul_i32 s60, s3, 81920
    s_mul_i32 s61, s3, 196608
    s_add_u32 m0, s63, 49152
    s_nop 0
    buffer_load_dwordx4 v12, s[40:43], s61 offen offset:0  lds
    buffer_load_dwordx4 v13, s[40:43], s61 offen offset:1024  lds
    buffer_load_dwordx4 v14, s[40:43], s61 offen offset:2048  lds
    buffer_load_dwordx4 v15, s[40:43], s61 offen offset:3072  lds
    s_add_u32 s61, s61, 196608
    s_add_u32 m0, s62, 49152
    s_nop 0
    buffer_load_dwordx4 v10, s[12:15], s60 offen offset:0 sc1 lds
    buffer_load_dwordx4 v10, s[12:15], s60 offen offset:1024 sc1 lds
    buffer_load_dwordx4 v11, s[12:15], s60 offen offset:2048 sc1 lds
    buffer_load_dwordx4 v11, s[12:15], s60 offen offset:3072 sc1 lds
    s_add_u32 s60, s60, 81920
    s_cmp_eq_u32 s60, 655360
    s_cselect_b32 s60, 0, s60
    s_cselect_b32 s61, 0, s61
    s_waitcnt vmcnt(8)
    s_barrier
    s_add_u32 s3, s37, s36
    s_add_u32 s3, s3, 2
    s_and_b32 s3, s3, 3
    s_add_u32 s3, s3, 0
    s_mul_i32 s60, s3, 81920
    s_mul_i32 s61, s3, 196608
    s_add_u32 m0, s63, 0
    s_nop 0
    buffer_load_dwordx4 v12, s[40:43], s61 offen offset:0  lds
    buffer_load_dwordx4 v13, s[40:43], s61 offen offset:1024  lds
    buffer_load_dwordx4 v14, s[40:43], s61 offen offset:2048  lds
    buffer_load_dwordx4 v15, s[40:43], s61 offen offset:3072  lds
    s_add_u32 s61, s61, 196608
    s_add_u32 m0, s62, 0
    s_nop 0
    buffer_load_dwordx4 v10, s[12:15], s60 offen offset:0 sc1 lds
    buffer_load_dwordx4 v10, s[12:15], s60 offen offset:1024 sc1 lds
    buffer_load_dwordx4 v11, s[12:15], s60 offen offset:2048 sc1 lds
    buffer_load_dwordx4 v11, s[12:15], s60 offen offset:3072 sc1 lds
    s_add_u32 s60, s60, 81920
    s_cmp_eq_u32 s60, 655360
    s_cselect_b32 s60, 0, s60
    s_cselect_b32 s61, 0, s61
    s_waitcnt vmcnt(8)
    s_barrier
    s_add_u32 s3, s37, s36
    s_add_u32 s3, s3, 3
    s_and_b32 s3, s3, 3
    s_add_u32 s3, s3, 0
    s_mul_i32 s60, s3, 81920
    s_mul_i32 s61, s3, 196608
    s_add_u32 m0, s63, 16384
    s_nop 0
    buffer_load_dwordx4 v12, s[40:43], s61 offen offset:0  lds
    buffer_load_dwordx4 v13, s[40:43], s61 offen offset:1024  lds
    buffer_load_dwordx4 v14, s[40:43], s61 offen offset:2048  lds
    buffer_load_dwordx4 v15, s[40:43], s61 offen offset:3072  lds
    s_add_u32 s61, s61, 196608
    s_add_u32 m0, s62, 16384
    s_nop 0
    buffer_load_dwordx4 v10, s[12:15], s60 offen offset:0 sc1 lds
    buffer_load_dwordx4 v10, s[12:15], s60 offen offset:1024 sc1 lds
    buffer_load_dwordx4 v11, s[12:15], s60 offen offset:2048 sc1 lds
    buffer_load_dwordx4 v11, s[12:15], s60 offen offset:3072 sc1 lds
    s_add_u32 s60, s60, 81920
    s_cmp_eq_u32 s60, 655360
    s_cselect_b32 s60, 0, s60
    s_cselect_b32 s61, 0, s61
    s_waitcnt vmcnt(8)
    s_barrier
    s_add_u32 s3, s37, s36
    s_add_u32 s3, s3, 4
    s_and_b32 s3, s3, 3
    s_add_u32 s3, s3, 4
    s_mul_i32 s60, s3, 81920
    s_mul_i32 s61, s3, 196608
    s_add_u32 m0, s63, 32768
    s_nop 0
    buffer_load_dwordx4 v12, s[40:43], s61 offen offset:0  lds
    buffer_load_dwordx4 v13, s[40:43], s61 offen offset:1024  lds
    buffer_load_dwordx4 v14, s[40:43], s61 offen offset:2048  lds
    buffer_load_dwordx4 v15, s[40:43], s61 offen offset:3072  lds
    s_add_u32 s61, s61, 196608
    s_add_u32 m0, s62, 32768
    s_nop 0
    buffer_load_dwordx4 v10, s[12:15], s60 offen offset:0 sc1 lds
    buffer_load_dwordx4 v10, s[12:15], s60 offen offset:1024 sc1 lds
    buffer_load_dwordx4 v11, s[12:15], s60 offen offset:2048 sc1 lds
    buffer_load_dwordx4 v11, s[12:15], s60 offen offset:3072 sc1 lds
    s_add_u32 s60, s60, 81920
    s_cmp_eq_u32 s60, 655360
    s_cselect_b32 s60, 0, s60
    s_cselect_b32 s61, 0, s61
    s_waitcnt vmcnt(8)
    s_barrier
    s_add_u32 s3, s37, s36
    s_add_u32 s3, s3, 5
    s_and_b32 s3, s3, 3
    s_add_u32 s3, s3, 4
    s_mul_i32 s60, s3, 81920
    s_mul_i32 s61, s3, 196608
    s_add_u32 m0, s63, 49152
    s_nop 0
    buffer_load_dwordx4 v12, s[40:43], s61 offen offset:0  lds
    buffer_load_dwordx4 v13, s[40:43], s61 offen offset:1024  lds
    buffer_load_dwordx4 v14, s[40:43], s61 offen offset:2048  lds
    buffer_load_dwordx4 v15, s[40:43], s61 offen offset:3072  lds
    s_add_u32 s61, s61, 196608
    s_add_u32 m0, s62, 49152
    s_nop 0
    buffer_load_dwordx4 v10, s[12:15], s60 offen offset:0 sc1 lds
    buffer_load_dwordx4 v10, s[12:15], s60 offen offset:1024 sc1 lds
    buffer_load_dwordx4 v11, s[12:15], s60 offen offset:2048 sc1 lds
    buffer_load_dwordx4 v11, s[12:15], s60 offen offset:3072 sc1 lds
    s_add_u32 s60, s60, 81920
    s_cmp_eq_u32 s60, 655360
    s_cselect_b32 s60, 0, s60
    s_cselect_b32 s61, 0, s61
    s_waitcnt vmcnt(8)
    s_barrier
    s_mov_b64 exec, s[56:57]
    v_mov_b32 v28, 0
    v_mov_b32 v29, 0
    buffer_atomic_add_x2 v[28:29], v31, s[12:15], 0 offen sc0 sc1
    s_mov_b64 exec, -1
    s_add_u32 s3, s37, s36
    s_add_u32 s3, s3, 6
    s_and_b32 s3, s3, 3
    s_add_u32 s3, s3, 4
    s_mul_i32 s60, s3, 81920
    s_mul_i32 s61, s3, 196608
    s_add_u32 m0, s63, 0
    s_nop 0
    buffer_load_dwordx4 v12, s[40:43], s61 offen offset:0  lds
    buffer_load_dwordx4 v13, s[40:43], s61 offen offset:1024  lds
    buffer_load_dwordx4 v14, s[40:43], s61 offen offset:2048  lds
    buffer_load_dwordx4 v15, s[40:43], s61 offen offset:3072  lds
    s_add_u32 s61, s61, 196608
    s_add_u32 m0, s62, 0
    s_nop 0
    buffer_load_dwordx4 v10, s[12:15], s60 offen offset:0 sc1 lds
    buffer_load_dwordx4 v10, s[12:15], s60 offen offset:1024 sc1 lds
    buffer_load_dwordx4 v11, s[12:15], s60 offen offset:2048 sc1 lds
    buffer_load_dwordx4 v11, s[12:15], s60 offen offset:3072 sc1 lds
    s_add_u32 s60, s60, 81920
    s_cmp_eq_u32 s60, 655360
    s_cselect_b32 s60, 0, s60
    s_cselect_b32 s61, 0, s61
    s_waitcnt vmcnt(9)
    s_barrier
    s_waitcnt vmcnt(8)
    v_cmp_ne_u64 vcc, s[74:75], v[28:29]
    s_nop 0
    s_and_b64 s[56:57], s[56:57], vcc
    s_cbranch_scc1 L_T_na
    s_lshl_b32 s3, s83, 10
    s_add_u32 s29, s26, s3
    s_xor_b32 s3, s3, 1024
    s_add_u32 s30, s26, s3
    buffer_load_dwordx4 v[32:35], v60, s[12:15], s30 offen offset:0
    buffer_load_dwordx2 v[36:37], v122, s[12:15], s30 offen offset:0
    buffer_load_dwordx4 v[38:41], v60, s[12:15], s30 offen offset:512
    buffer_load_dwordx2 v[42:43], v122, s[12:15], s30 offen offset:512
    buffer_load_dwordx4 v[44:47], v60, s[12:15], s29 offen offset:0
    buffer_load_dwordx2 v[48:49], v122, s[12:15], s29 offen offset:0
    buffer_load_dwordx4 v[50:53], v60, s[12:15], s29 offen offset:512
    buffer_load_dwordx2 v[54:55], v122, s[12:15], s29 offen offset:512
    v_mov_b32 v56, 0xff800000
    v_mov_b32 v57, 0xff800000
    v_mov_b32 v58, 0xff800000
    v_mov_b32 v59, 0xff800000
    s_and_b32 s3, s79, 7
    s_lshl_b32 s16, s3, 11
    s_add_u32 s16, s16, s27
    s_mul_i32 s18, s3, 34816
    s_add_u32 s18, s18, s28
    s_add_u32 s17, s27, 16384
    buffer_load_dwordx4 v[64:67], v60, s[12:15], s16 offen offset:0
    buffer_load_dwordx2 v[68:69], v61, s[12:15], s16 offen offset:0
    v_mov_b32 v116, 0
    v_mov_b32 v117, 0
    v_mov_b32 v118, 0
    v_mov_b32 v119, 0
    s_waitcnt vmcnt(10)
    s_barrier
    s_add_u32 s3, s37, s36
    s_add_u32 s3, s3, 7
    s_and_b32 s3, s3, 3
    s_add_u32 s3, s3, 4
    s_mul_i32 s60, s3, 81920
    s_mul_i32 s61, s3, 196608
    s_add_u32 m0, s63, 16384
    s_nop 0
    buffer_load_dwordx4 v12, s[40:43], s61 offen offset:0  lds
    buffer_load_dwordx4 v13, s[40:43], s61 offen offset:1024  lds
    buffer_load_dwordx4 v14, s[40:43], s61 offen offset:2048  lds
    buffer_load_dwordx4 v15, s[40:43], s61 offen offset:3072  lds
    s_add_u32 s61, s61, 196608
    s_add_u32 m0, s62, 16384
    s_nop 0
    buffer_load_dwordx4 v10, s[12:15], s60 offen offset:0 sc1 lds
    buffer_load_dwordx4 v10, s[12:15], s60 offen offset:1024 sc1 lds
    buffer_load_dwordx4 v11, s[12:15], s60 offen offset:2048 sc1 lds
    buffer_load_dwordx4 v11, s[12:15], s60 offen offset:3072 sc1 lds
    s_add_u32 s60, s60, 81920
    s_cmp_eq_u32 s60, 655360
    s_cselect_b32 s60, 0, s60
    s_cselect_b32 s61, 0, s61
    s_setprio 2
    s_mov_b32 s55, 1
    s_waitcnt vmcnt(8)
    s_branch L_att_pre2
L_T_na:
    s_mov_b64 exec, s[56:57]
    v_mov_b32 v28, 0
    v_mov_b32 v29, 0
    buffer_atomic_add_x2 v[28:29], v31, s[12:15], 0 offen sc0 sc1
    s_mov_b64 exec, -1
    s_add_u32 s3, s37, s36
    s_add_u32 s3, s3, 7
    s_and_b32 s3, s3, 3
    s_add_u32 s3, s3, 4
    s_mul_i32 s60, s3, 81920
    s_mul_i32 s61, s3, 196608
    s_add_u32 m0, s63, 16384
    s_nop 0
    buffer_load_dwordx4 v12, s[40:43], s61 offen offset:0  lds
    buffer_load_dwordx4 v13, s[40:43], s61 offen offset:1024  lds
    buffer_load_dwordx4 v14, s[40:43], s61 offen offset:2048  lds
    buffer_load_dwordx4 v15, s[40:43], s61 offen offset:3072  lds
    s_add_u32 s61, s61, 196608
    s_add_u32 m0, s62, 16384
    s_nop 0
    buffer_load_dwordx4 v10, s[12:15], s60 offen offset:0 sc1 lds
    buffer_load_dwordx4 v10, s[12:15], s60 offen offset:1024 sc1 lds
    buffer_load_dwordx4 v11, s[12:15], s60 offen offset:2048 sc1 lds
    buffer_load_dwordx4 v11, s[12:15], s60 offen offset:3072 sc1 lds
    s_add_u32 s60, s60, 81920
    s_cmp_eq_u32 s60, 655360
    s_cselect_b32 s60, 0, s60
    s_cselect_b32 s61, 0, s61
    s_waitcnt vmcnt(8)
    v_cmp_ne_u64 vcc, s[74:75], v[28:29]
    s_nop 0
    s_and_b64 s[56:57], s[56:57], vcc
    s_cbranch_scc1 L_T_late
    s_waitcnt vmcnt(9)
    s_barrier
    s_lshl_b32 s3, s83, 10
    s_add_u32 s29, s26, s3
    s_xor_b32 s3, s3, 1024
    s_add_u32 s30, s26, s3
    buffer_load_dwordx4 v[32:35], v60, s[12:15], s30 offen offset:0
    buffer_load_dwordx2 v[36:37], v122, s[12:15], s30 offen offset:0
    buffer_load_dwordx4 v[38:41], v60, s[12:15], s30 offen offset:512
    buffer_load_dwordx2 v[42:43], v122, s[12:15], s30 offen offset:512
    buffer_load_dwordx4 v[44:47], v60, s[12:15], s29 offen offset:0
    buffer_load_dwordx2 v[48:49], v122, s[12:15], s29 offen offset:0
    buffer_load_dwordx4 v[50:53], v60, s[12:15], s29 offen offset:512
    buffer_load_dwordx2 v[54:55], v122, s[12:15], s29 offen offset:512
    v_mov_b32 v56, 0xff800000
    v_mov_b32 v57, 0xff800000
    v_mov_b32 v58, 0xff800000
    v_mov_b32 v59, 0xff800000
    s_and_b32 s3, s79, 7
    s_lshl_b32 s16, s3, 11
    s_add_u32 s16, s16, s27
    s_mul_i32 s18, s3, 34816
    s_add_u32 s18, s18, s28
    s_add_u32 s17, s27, 16384
    buffer_load_dwordx4 v[64:67], v60, s[12:15], s16 offen offset:0
    buffer_load_dwordx2 v[68:69], v61, s[12:15], s16 offen offset:0
    v_mov_b32 v116, 0
    v_mov_b32 v117, 0
    v_mov_b32 v118, 0
    v_mov_b32 v119, 0
    s_waitcnt vmcnt(10)
    s_barrier
    s_setprio 2
    s_branch L_att_pre
L_T_late:
    s_waitcnt vmcnt(9)
    s_barrier
    s_waitcnt vmcnt(0)
    s_barrier
    s_branch L_T_att
L_T_idle:
    s_and_b32 s3, s79, 1
    s_lshl_b32 s3, s3, 2
    s_add_u32 s3, s3, s77
    s_lshl_b32 s60, s22, 9
    s_add_u32 s3, s3, s60
    s_mul_i32 s3, s3, 3072
    s_and_b32 s60, s78, 1
    s_mul_i32 s60, s60, 1536
    s_add_u32 s60, s3, s60
    v_lshrrev_b32 v26, 2, v1
    v_mul_u32_u24 v26, 24576, v26
    v_and_b32 v27, 3, v1
    v_lshl_add_u32 v26, v27, 7, v26
    s_and_b32 s3, s79, 1
    s_lshl_b32 s3, s3, 2
    s_add_u32 s3, s3, s77
    s_mul_i32 s3, s3, 5
    s_lshl_b32 s60, s22, 9
    s_add_u32 s3, s3, s60
    s_mul_i32 s3, s3, 3072
    s_and_b32 s60, s78, 1
    s_mul_i32 s60, s60, 1536
    s_add_u32 s60, s3, s60
    v_min_u32 v27, 59, v1
    v_mul_u32_u24 v26, 43, v27
    v_lshrrev_b32 v26, 9, v26
    v_mul_u32_u24 v26, 1536, v26
    v_lshl_add_u32 v26, v27, 7, v26
    buffer_load_dword v208, v26, s[40:43], s60 offen
    s_add_u32 s60, s60, 122880
    s_barrier
    buffer_load_dword v209, v26, s[40:43], s60 offen
    s_add_u32 s60, s60, 122880
    s_barrier
    buffer_load_dword v210, v26, s[40:43], s60 offen
    s_add_u32 s60, s60, 122880
    buffer_load_dword v211, v26, s[40:43], s60 offen
    s_add_u32 s60, s60, 122880
    buffer_load_dword v212, v26, s[40:43], s60 offen
    s_add_u32 s60, s60, 122880
    buffer_load_dword v213, v26, s[40:43], s60 offen
    s_add_u32 s60, s60, 122880
    buffer_load_dword v214, v26, s[40:43], s60 offen
    s_add_u32 s60, s60, 122880
    buffer_load_dword v215, v26, s[40:43], s60 offen
    s_add_u32 s60, s60, 122880
    buffer_load_dword v216, v26, s[40:43], s60 offen
    s_add_u32 s60, s60, 122880
    buffer_load_dword v217, v26, s[40:43], s60 offen
    s_add_u32 s60, s60, 122880
    buffer_load_dword v218, v26, s[40:43], s60 offen
    s_add_u32 s60, s60, 122880
    buffer_load_dword v219, v26, s[40:43], s60 offen
    s_add_u32 s60, s60, 122880
L_T_att:
    s_setprio 2
    s_mov_b32 s82, 65536
L_qp_6:
    s_mov_b64 exec, s[56:57]
    v_mov_b32 v28, 0
    v_mov_b32 v29, 0
    buffer_atomic_add_x2 v[28:29], v31, s[12:15], 0 offen sc0 sc1
    s_mov_b64 exec, -1
    s_waitcnt vmcnt(0)
    v_cmp_ne_u64 vcc, s[74:75], v[28:29]
    s_nop 0
    s_and_b64 s[56:57], s[56:57], vcc
    s_cbranch_scc0 L_T_att2
    s_sleep 1
    s_sub_u32 s82, s82, 1
    s_cmp_lg_u32 s82, 0
    s_cbranch_scc1 L_qp_6
L_T_att2:
    s_lshl_b32 s3, s83, 10
    s_add_u32 s29, s26, s3
    s_xor_b32 s3, s3, 1024
    s_add_u32 s30, s26, s3
    buffer_load_dwordx4 v[32:35], v60, s[12:15], s30 offen offset:0
    buffer_load_dwordx2 v[36:37], v122, s[12:15], s30 offen offset:0
    buffer_load_dwordx4 v[38:41], v60, s[12:15], s30 offen offset:512
    buffer_load_dwordx2 v[42:43], v122, s[12:15], s30 offen offset:512
    buffer_load_dwordx4 v[44:47], v60, s[12:15], s29 offen offset:0
    buffer_load_dwordx2 v[48:49], v122, s[12:15], s29 offen offset:0
    buffer_load_dwordx4 v[50:53], v60, s[12:15], s29 offen offset:512
    buffer_load_dwordx2 v[54:55], v122, s[12:15], s29 offen offset:512
    v_mov_b32 v56, 0xff800000
    v_mov_b32 v57, 0xff800000
    v_mov_b32 v58, 0xff800000
    v_mov_b32 v59, 0xff800000
    s_and_b32 s3, s79, 7
    s_lshl_b32 s16, s3, 11
    s_add_u32 s16, s16, s27
    s_mul_i32 s18, s3, 34816
    s_add_u32 s18, s18, s28
    s_add_u32 s17, s27, 16384
    buffer_load_dwordx4 v[64:67], v60, s[12:15], s16 offen offset:0
    buffer_load_dwordx2 v[68:69], v61, s[12:15], s16 offen offset:0
    v_mov_b32 v116, 0
    v_mov_b32 v117, 0
    v_mov_b32 v118, 0
    v_mov_b32 v119, 0
    s_branch L_att_pre
L_att_start:
    s_mov_b32 exec_lo, 0
    v_mov_b32 v36, 0
    v_mov_b32 v37, 0
    v_mov_b32 v42, 0
    v_mov_b32 v43, 0
    v_mov_b32 v48, 0
    v_mov_b32 v49, 0
    v_mov_b32 v54, 0
    v_mov_b32 v55, 0
    s_mov_b32 exec_lo, -1
    v_mov_b32 v56, 0xff800000
    v_mov_b32 v57, 0xff800000
    v_mov_b32 v58, 0xff800000
    v_mov_b32 v59, 0xff800000
    s_add_u32 s16, s27, 15872
L_att_max:
    buffer_load_dwordx4 v[64:67], v60, s[12:15], s16 offen offset:0
    buffer_load_dwordx2 v[68:69], v61, s[12:15], s16 offen offset:0
    s_waitcnt vmcnt(0)
    v_mfma_f32_32x32x16_bf16 v[192:207], v[64:67], v[32:35], 0
    v_mfma_f32_32x32x8_bf16 v[192:207], v[68:69], v[36:37], v[192:207]
    v_mfma_f32_32x32x16_bf16 v[208:223], v[64:67], v[38:41], 0
    v_mfma_f32_32x32x8_bf16 v[208:223], v[68:69], v[42:43], v[208:223]
    v_mfma_f32_32x32x16_bf16 v[224:239], v[64:67], v[44:47], 0
    s_nop 8
    v_max3_f32 v56, v56, v192, v193
    v_max3_f32 v56, v56, v194, v195
    v_max3_f32 v56, v56, v196, v197
    v_max3_f32 v56, v56, v198, v199
    v_mfma_f32_32x32x8_bf16 v[224:239], v[68:69], v[48:49], v[224:239]
    v_max3_f32 v56, v56, v200, v201
    v_max3_f32 v56, v56, v202, v203
    v_max3_f32 v56, v56, v204, v205
    v_max3_f32 v56, v56, v206, v207
    v_mfma_f32_32x32x16_bf16 v[8:23], v[64:67], v[50:53], 0
    v_max3_f32 v57, v57, v208, v209
    v_max3_f32 v57, v57, v210, v211
    v_max3_f32 v57, v57, v212, v213
    v_max3_f32 v57, v57, v214, v215
    v_mfma_f32_32x32x8_bf16 v[8:23], v[68:69], v[54:55], v[8:23]
    v_max3_f32 v57, v57, v216, v217
    v_max3_f32 v57, v57, v218, v219
    v_max3_f32 v57, v57, v220, v221
    v_max3_f32 v57, v57, v222, v223
    v_max3_f32 v58, v58, v224, v225
    v_max3_f32 v58, v58, v226, v227
    v_max3_f32 v58, v58, v228, v229
    v_max3_f32 v58, v58, v230, v231
    v_max3_f32 v58, v58, v232, v233
    v_max3_f32 v58, v58, v234, v235
    v_max3_f32 v58, v58, v236, v237
    v_max3_f32 v58, v58, v238, v239
    v_max3_f32 v59, v59, v8, v9
    v_max3_f32 v59, v59, v10, v11
    v_max3_f32 v59, v59, v12, v13
    v_max3_f32 v59, v59, v14, v15
    v_max3_f32 v59, v59, v16, v17
    v_max3_f32 v59, v59, v18, v19
    v_max3_f32 v59, v59, v20, v21
    v_max3_f32 v59, v59, v22, v23
    s_sub_u32 s16, s16, 512
    s_cmp_ge_u32 s16, s27
    s_cbranch_scc1 L_att_max
    v_mov_b32 v128, 0
    v_mov_b32 v129, 0
    v_mov_b32 v130, 0
    v_mov_b32 v131, 0
    v_mov_b32 v132, 0
    v_mov_b32 v133, 0
    v_mov_b32 v134, 0
    v_mov_b32 v135, 0
    v_mov_b32 v136, 0
    v_mov_b32 v137, 0
    v_mov_b32 v138, 0
    v_mov_b32 v139, 0
    v_mov_b32 v140, 0
    v_mov_b32 v141, 0
    v_mov_b32 v142, 0
    v_mov_b32 v143, 0
    v_mov_b32 v144, 0
    v_mov_b32 v145, 0
    v_mov_b32 v146, 0
    v_mov_b32 v147, 0
    v_mov_b32 v148, 0
    v_mov_b32 v149, 0
    v_mov_b32 v150, 0
    v_mov_b32 v151, 0
    v_mov_b32 v152, 0
    v_mov_b32 v153, 0
    v_mov_b32 v154, 0
    v_mov_b32 v155, 0
    v_mov_b32 v156, 0
    v_mov_b32 v157, 0
    v_mov_b32 v158, 0
    v_mov_b32 v159, 0
    v_mov_b32 v160, 0
    v_mov_b32 v161, 0
    v_mov_b32 v162, 0
    v_mov_b32 v163, 0
    v_mov_b32 v164, 0
    v_mov_b32 v165, 0
    v_mov_b32 v166, 0
    v_mov_b32 v167, 0
    v_mov_b32 v168, 0
    v_mov_b32 v169, 0
    v_mov_b32 v170, 0
    v_mov_b32 v171, 0
    v_mov_b32 v172, 0
    v_mov_b32 v173, 0
    v_mov_b32 v174, 0
    v_mov_b32 v175, 0
    v_mov_b32 v176, 0
    v_mov_b32 v177, 0
    v_mov_b32 v178, 0
    v_mov_b32 v179, 0
    v_mov_b32 v180, 0
    v_mov_b32 v181, 0
    v_mov_b32 v182, 0
    v_mov_b32 v183, 0
    v_mov_b32 v184, 0
    v_mov_b32 v185, 0
    v_mov_b32 v186, 0
    v_mov_b32 v187, 0
    v_mov_b32 v188, 0
    v_mov_b32 v189, 0
    v_mov_b32 v190, 0
    v_mov_b32 v191, 0
    s_and_b32 s3, s79, 7
    s_lshl_b32 s16, s3, 11
    s_add_u32 s16, s16, s27
    s_mul_i32 s18, s3, 34816
    s_add_u32 s18, s18, s28
    s_add_u32 s17, s27, 16384
    buffer_load_dwordx4 v[64:67], v60, s[12:15], s16 offen offset:0
    buffer_load_dwordx2 v[68:69], v61, s[12:15], s16 offen offset:0
    v_mov_b32 v116, 0
    v_mov_b32 v117, 0
    v_mov_b32 v118, 0
    v_mov_b32 v119, 0
L_att_pre:
    s_waitcnt vmcnt(0)
L_att_pre2:
    v_mfma_f32_32x32x16_bf16 v[192:207], v[64:67], v[32:35], 0
    buffer_load_dwordx4 v[70:73], v62, s[12:15], s18 offen
    v_mfma_f32_32x32x8_bf16 v[192:207], v[68:69], v[36:37], v[192:207]
    buffer_load_dwordx4 v[74:77], v62, s[12:15], s18 offen offset:2176
    s_add_u32 s18, s18, 8704
    v_mfma_f32_32x32x16_bf16 v[208:223], v[64:67], v[38:41], 0
    buffer_load_dword v120, v63, s[12:15], 0 offen sc1
    v_mfma_f32_32x32x8_bf16 v[208:223], v[68:69], v[42:43], v[208:223]
    buffer_load_dword v121, v63, s[12:15], 0 offen offset:512 sc1
    v_mfma_f32_32x32x16_bf16 v[224:239], v[64:67], v[44:47], 0
    buffer_load_dwordx4 v[78:81], v60, s[12:15], s16 offen offset:512
    s_nop 3
    v_max3_f32 v56, v56, v192, v193
    v_max3_f32 v56, v56, v194, v195
    v_max3_f32 v56, v56, v196, v197
    v_max3_f32 v56, v56, v198, v199
    v_mfma_f32_32x32x8_bf16 v[224:239], v[68:69], v[48:49], v[224:239]
    v_max3_f32 v56, v56, v200, v201
    v_max3_f32 v56, v56, v202, v203
    v_max3_f32 v56, v56, v204, v205
    v_max3_f32 v56, v56, v206, v207
    v_mfma_f32_32x32x16_bf16 v[8:23], v[64:67], v[50:53], 0
    buffer_load_dwordx2 v[82:83], v61, s[12:15], s16 offen offset:512
    v_max3_f32 v57, v57, v208, v209
    v_max3_f32 v57, v57, v210, v211
    v_max3_f32 v57, v57, v212, v213
    v_max3_f32 v57, v57, v214, v215
    v_mfma_f32_32x32x8_bf16 v[8:23], v[68:69], v[54:55], v[8:23]
    v_max3_f32 v57, v57, v216, v217
    v_max3_f32 v57, v57, v218, v219
    v_max3_f32 v57, v57, v220, v221
    v_max3_f32 v57, v57, v222, v223
    v_max3_f32 v58, v58, v224, v225
    v_max3_f32 v58, v58, v226, v227
    v_max3_f32 v58, v58, v228, v229
    v_max3_f32 v58, v58, v230, v231
    v_max3_f32 v58, v58, v232, v233
    v_max3_f32 v58, v58, v234, v235
    v_max3_f32 v58, v58, v236, v237
    v_max3_f32 v58, v58, v238, v239
    buffer_load_dwordx4 v[84:87], v62, s[12:15], s18 offen
    v_max3_f32 v59, v59, v8, v9
    v_max3_f32 v59, v59, v10, v11
    v_max3_f32 v59, v59, v12, v13
    v_max3_f32 v59, v59, v14, v15
    v_max3_f32 v59, v59, v16, v17
    v_max3_f32 v59, v59, v18, v19
    v_max3_f32 v59, v59, v20, v21
    v_max3_f32 v59, v59, v22, v23
    buffer_load_dwordx4 v[88:91], v62, s[12:15], s18 offen offset:2176
    s_add_u32 s18, s18, 8704
    v_mov_b32 v2, v56
    v_mov_b32 v3, v57
    v_mov_b32 v4, v58
    v_mov_b32 v5, v59
    v_permlane32_swap_b32 v2, v56
    v_permlane32_swap_b32 v3, v57
    v_permlane32_swap_b32 v4, v58
    v_permlane32_swap_b32 v5, v59
    v_max_f32 v56, v2, v56
    v_max_f32 v57, v3, v57
    v_max_f32 v58, v4, v58
    v_max_f32 v59, v5, v59
    buffer_load_dwordx4 v[92:95], v60, s[12:15], s16 offen offset:1024
    v_and_b32 v2, 0xffff0000, v56
    v_and_b32 v3, 0xffff0000, v57
    v_and_b32 v4, 0xffff0000, v58
    v_and_b32 v5, 0xffff0000, v59
    v_sub_f32 v8, v56, v2
    v_sub_f32 v9, v57, v3
    v_sub_f32 v10, v58, v4
    v_sub_f32 v11, v59, v5
    v_and_b32 v12, 0xffff0000, v8
    v_and_b32 v13, 0xffff0000, v9
    v_and_b32 v14, 0xffff0000, v10
    v_and_b32 v15, 0xffff0000, v11
    v_sub_f32 v8, v8, v12
    v_sub_f32 v9, v9, v13
    v_sub_f32 v10, v10, v14
    v_sub_f32 v11, v11, v15
    buffer_load_dwordx2 v[96:97], v61, s[12:15], s16 offen offset:1024
    s_mov_b32 exec_lo, 0
    v_cvt_pk_bf16_f32 v36, -v2, -v12
    v_cvt_pk_bf16_f32 v42, -v3, -v13
    v_cvt_pk_bf16_f32 v48, -v4, -v14
    v_cvt_pk_bf16_f32 v54, -v5, -v15
    v_cvt_pk_bf16_f32 v37, -v8, 0
    v_cvt_pk_bf16_f32 v43, -v9, 0
    v_cvt_pk_bf16_f32 v49, -v10, 0
    v_cvt_pk_bf16_f32 v55, -v11, 0
    s_mov_b32 exec_lo, -1
    v_mfma_f32_32x32x16_bf16 v[192:207], v[64:67], v[32:35], 0
    buffer_load_dwordx4 v[98:101], v62, s[12:15], s18 offen
    v_mfma_f32_32x32x8_bf16 v[192:207], v[68:69], v[36:37], v[192:207]
    buffer_load_dwordx4 v[102:105], v62, s[12:15], s18 offen offset:2176
    s_add_u32 s18, s18, 8704
    v_mov_b32 v228, 0
    v_mov_b32 v229, 0
    v_mov_b32 v230, 0
    v_mov_b32 v231, 0
    s_cmp_lg_u32 s20, 0
    s_cbranch_scc1 L_noarr_7
    s_mov_b64 exec, 1
    ds_add_u32 v254, v255 offset:0
    s_mov_b64 exec, -1
L_noarr_7:
    s_cmp_eq_u32 s55, 0
    s_cbranch_scc1 L_nob17_8
    s_mov_b32 s55, 0
    s_waitcnt vmcnt(12)
    s_barrier
L_nob17_8:
    s_mov_b32 s19, 7
    s_waitcnt vmcnt(10)
    s_nop 3
    s_branch L_att_entry
    .p2align 6
L_att_loop:
    v_mfma_f32_32x32x16_bf16 v[208:223], v[78:81], v[38:41], 0
    buffer_load_dwordx4 v[64:67], v60, s[12:15], s16 offen offset:0
    v_exp_f32 v192, v192
    v_exp_f32 v193, v193
    v_exp_f32 v194, v194
    v_exp_f32 v195, v195
    v_cvt_pk_bf16_f32 v224, v192, v193
    v_cvt_pk_bf16_f32 v225, v194, v195
    v_mfma_f32_32x32x8_bf16 v[208:223], v[82:83], v[42:43], v[208:223]
    v_exp_f32 v196, v196
    v_exp_f32 v197, v197
    v_exp_f32 v198, v198
    v_exp_f32 v199, v199
    v_cvt_pk_bf16_f32 v226, v196, v197
    v_cvt_pk_bf16_f32 v227, v198, v199
    v_mfma_f32_32x32x16_bf16 v[176:191], v[74:77], v[228:231], v[176:191]
    v_exp_f32 v200, v200
    v_exp_f32 v201, v201
    v_exp_f32 v202, v202
    v_exp_f32 v203, v203
    v_cvt_pk_bf16_f32 v228, v200, v201
    v_cvt_pk_bf16_f32 v229, v202, v203
    v_mfma_f32_32x32x16_bf16 v[128:143], v[84:87], v[224:227], v[128:143]
    buffer_load_dwordx2 v[68:69], v61, s[12:15], s16 offen offset:0
    v_exp_f32 v204, v204
    v_exp_f32 v205, v205
    v_exp_f32 v206, v206
    v_exp_f32 v207, v207
    v_cvt_pk_bf16_f32 v230, v204, v205
    v_cvt_pk_bf16_f32 v231, v206, v207
    v_mfma_f32_32x32x16_bf16 v[192:207], v[78:81], v[44:47], 0
    buffer_load_dwordx4 v[70:73], v62, s[12:15], s18 offen
    v_exp_f32 v208, v208
    v_exp_f32 v209, v209
    v_exp_f32 v210, v210
    v_exp_f32 v211, v211
    v_cvt_pk_bf16_f32 v224, v208, v209
    v_cvt_pk_bf16_f32 v225, v210, v211
    v_mfma_f32_32x32x8_bf16 v[192:207], v[82:83], v[48:49], v[192:207]
    v_exp_f32 v212, v212
    v_exp_f32 v213, v213
    v_exp_f32 v214, v214
    v_exp_f32 v215, v215
    v_cvt_pk_bf16_f32 v226, v212, v213
    v_cvt_pk_bf16_f32 v227, v214, v215
    v_mfma_f32_32x32x16_bf16 v[128:143], v[88:91], v[228:231], v[128:143]
    v_exp_f32 v216, v216
    v_exp_f32 v217, v217
    v_exp_f32 v218, v218
    v_exp_f32 v219, v219
    v_cvt_pk_bf16_f32 v228, v216, v217
    v_cvt_pk_bf16_f32 v229, v218, v219
    v_mfma_f32_32x32x16_bf16 v[144:159], v[84:87], v[224:227], v[144:159]
    buffer_load_dwordx4 v[74:77], v62, s[12:15], s18 offen offset:2176
    v_exp_f32 v220, v220
    v_exp_f32 v221, v221
    v_exp_f32 v222, v222
    v_exp_f32 v223, v223
    v_cvt_pk_bf16_f32 v230, v220, v221
    v_cvt_pk_bf16_f32 v231, v222, v223
    v_mfma_f32_32x32x16_bf16 v[208:223], v[78:81], v[50:53], 0
    s_add_u32 s18, s18, 8704
    v_exp_f32 v192, v192
    v_exp_f32 v193, v193
    v_exp_f32 v194, v194
    v_exp_f32 v195, v195
    v_cvt_pk_bf16_f32 v224, v192, v193
    v_cvt_pk_bf16_f32 v225, v194, v195
    v_mfma_f32_32x32x8_bf16 v[208:223], v[82:83], v[54:55], v[208:223]
    v_exp_f32 v196, v196
    v_exp_f32 v197, v197
    v_exp_f32 v198, v198
    v_exp_f32 v199, v199
    v_cvt_pk_bf16_f32 v226, v196, v197
    v_cvt_pk_bf16_f32 v227, v198, v199
    v_mfma_f32_32x32x16_bf16 v[144:159], v[88:91], v[228:231], v[144:159]
    v_exp_f32 v200, v200
    v_exp_f32 v201, v201
    v_exp_f32 v202, v202
    v_exp_f32 v203, v203
    v_cvt_pk_bf16_f32 v228, v200, v201
    v_cvt_pk_bf16_f32 v229, v202, v203
    v_mfma_f32_32x32x16_bf16 v[160:175], v[84:87], v[224:227], v[160:175]
    s_waitcnt vmcnt(8)
    v_exp_f32 v204, v204
    v_exp_f32 v205, v205
    v_exp_f32 v206, v206
    v_exp_f32_e64 v207, v207
    v_cvt_pk_bf16_f32 v230, v204, v205
    v_cvt_pk_bf16_f32 v231, v206, v207
    v_mfma_f32_32x32x16_bf16 v[192:207], v[92:95], v[32:35], 0
    v_exp_f32 v208, v208
    v_exp_f32 v209, v209
    v_exp_f32 v210, v210
    v_exp_f32 v211, v211
    v_cvt_pk_bf16_f32 v224, v208, v209
    v_cvt_pk_bf16_f32 v225, v210, v211
    v_mfma_f32_32x32x8_bf16 v[192:207], v[96:97], v[36:37], v[192:207]
    v_exp_f32 v212, v212
    v_exp_f32 v213, v213
    v_exp_f32 v214, v214
    v_exp_f32 v215, v215
    v_cvt_pk_bf16_f32 v226, v212, v213
    v_cvt_pk_bf16_f32 v227, v214, v215
    v_mfma_f32_32x32x16_bf16 v[160:175], v[88:91], v[228:231], v[160:175]
    v_exp_f32 v216, v216
    v_exp_f32 v217, v217
    v_exp_f32 v218, v218
    v_exp_f32 v219, v219
    v_cvt_pk_bf16_f32 v228, v216, v217
    v_cvt_pk_bf16_f32 v229, v218, v219
    v_mfma_f32_32x32x16_bf16 v[176:191], v[84:87], v[224:227], v[176:191]
    v_exp_f32 v220, v220
    v_exp_f32 v221, v221
    v_exp_f32 v222, v222
    v_exp_f32 v223, v223
    v_cvt_pk_bf16_f32 v230, v220, v221
    v_cvt_pk_bf16_f32 v231, v222, v223
    v_mfma_f32_32x32x16_bf16 v[208:223], v[92:95], v[38:41], 0
    buffer_load_dwordx4 v[78:81], v60, s[12:15], s16 offen offset:512
    v_exp_f32 v192, v192
    v_exp_f32 v193, v193
    v_exp_f32 v194, v194
    v_exp_f32 v195, v195
    v_cvt_pk_bf16_f32 v224, v192, v193
    v_cvt_pk_bf16_f32 v225, v194, v195
    v_mfma_f32_32x32x8_bf16 v[208:223], v[96:97], v[42:43], v[208:223]
    v_exp_f32 v196, v196
    v_exp_f32 v197, v197
    v_exp_f32 v198, v198
    v_exp_f32 v199, v199
    v_cvt_pk_bf16_f32 v226, v196, v197
    v_cvt_pk_bf16_f32 v227, v198, v199
    v_mfma_f32_32x32x16_bf16 v[176:191], v[88:91], v[228:231], v[176:191]
    v_exp_f32 v200, v200
    v_exp_f32 v201, v201
    v_exp_f32 v202, v202
    v_exp_f32 v203, v203
    v_cvt_pk_bf16_f32 v228, v200, v201
    v_cvt_pk_bf16_f32 v229, v202, v203
    v_mfma_f32_32x32x16_bf16 v[128:143], v[98:101], v[224:227], v[128:143]
    buffer_load_dwordx2 v[82:83], v61, s[12:15], s16 offen offset:512
    v_exp_f32 v204, v204
    v_exp_f32 v205, v205
    v_exp_f32 v206, v206
    v_exp_f32 v207, v207
    v_cvt_pk_bf16_f32 v230, v204, v205
    v_cvt_pk_bf16_f32 v231, v206, v207
    v_mfma_f32_32x32x16_bf16 v[192:207], v[92:95], v[44:47], 0
    buffer_load_dwordx4 v[84:87], v62, s[12:15], s18 offen
    v_exp_f32 v208, v208
    v_exp_f32 v209, v209
    v_exp_f32 v210, v210
    v_exp_f32 v211, v211
    v_cvt_pk_bf16_f32 v224, v208, v209
    v_cvt_pk_bf16_f32 v225, v210, v211
    v_mfma_f32_32x32x8_bf16 v[192:207], v[96:97], v[48:49], v[192:207]
    v_exp_f32 v212, v212
    v_exp_f32 v213, v213
    v_exp_f32 v214, v214
    v_exp_f32 v215, v215
    v_cvt_pk_bf16_f32 v226, v212, v213
    v_cvt_pk_bf16_f32 v227, v214, v215
    v_mfma_f32_32x32x16_bf16 v[128:143], v[102:105], v[228:231], v[128:143]
    v_exp_f32 v216, v216
    v_exp_f32 v217, v217
    v_exp_f32 v218, v218
    v_exp_f32 v219, v219
    v_cvt_pk_bf16_f32 v228, v216, v217
    v_cvt_pk_bf16_f32 v229, v218, v219
    v_mfma_f32_32x32x16_bf16 v[144:159], v[98:101], v[224:227], v[144:159]
    buffer_load_dwordx4 v[88:91], v62, s[12:15], s18 offen offset:2176
    v_exp_f32 v220, v220
    v_exp_f32 v221, v221
    v_exp_f32 v222, v222
    v_exp_f32 v223, v223
    v_cvt_pk_bf16_f32 v230, v220, v221
    v_cvt_pk_bf16_f32 v231, v222, v223
    v_mfma_f32_32x32x16_bf16 v[208:223], v[92:95], v[50:53], 0
    s_add_u32 s18, s18, 8704
    v_exp_f32 v192, v192
    v_exp_f32 v193, v193
    v_exp_f32 v194, v194
    v_exp_f32 v195, v195
    v_cvt_pk_bf16_f32 v224, v192, v193
    v_cvt_pk_bf16_f32 v225, v194, v195
    v_mfma_f32_32x32x8_bf16 v[208:223], v[96:97], v[54:55], v[208:223]
    v_exp_f32 v196, v196
    v_exp_f32 v197, v197
    v_exp_f32 v198, v198
    v_exp_f32 v199, v199
    v_cvt_pk_bf16_f32 v226, v196, v197
    v_cvt_pk_bf16_f32 v227, v198, v199
    v_mfma_f32_32x32x16_bf16 v[144:159], v[102:105], v[228:231], v[144:159]
    v_exp_f32 v200, v200
    v_exp_f32 v201, v201
    v_exp_f32 v202, v202
    v_exp_f32 v203, v203
    v_cvt_pk_bf16_f32 v228, v200, v201
    v_cvt_pk_bf16_f32 v229, v202, v203
    v_mfma_f32_32x32x16_bf16 v[160:175], v[98:101], v[224:227], v[160:175]
    s_waitcnt vmcnt(8)
    v_exp_f32 v204, v204
    v_exp_f32 v205, v205
    v_exp_f32 v206, v206
    v_exp_f32_e64 v207, v207
    v_cvt_pk_bf16_f32 v230, v204, v205
    v_cvt_pk_bf16_f32 v231, v206, v207
    v_mfma_f32_32x32x16_bf16 v[192:207], v[106:109], v[32:35], 0
    v_exp_f32 v208, v208
    v_exp_f32 v209, v209
    v_exp_f32 v210, v210
    v_exp_f32 v211, v211
    v_cvt_pk_bf16_f32 v224, v208, v209
    v_cvt_pk_bf16_f32 v225, v210, v211
    v_mfma_f32_32x32x8_bf16 v[192:207], v[110:111], v[36:37], v[192:207]
    v_exp_f32 v212, v212
    v_exp_f32 v213, v213
    v_exp_f32 v214, v214
    v_exp_f32 v215, v215
    v_cvt_pk_bf16_f32 v226, v212, v213
    v_cvt_pk_bf16_f32 v227, v214, v215
    v_mfma_f32_32x32x16_bf16 v[160:175], v[102:105], v[228:231], v[160:175]
    v_exp_f32 v216, v216
    v_exp_f32 v217, v217
    v_exp_f32 v218, v218
    v_exp_f32 v219, v219
    v_cvt_pk_bf16_f32 v228, v216, v217
    v_cvt_pk_bf16_f32 v229, v218, v219
    v_mfma_f32_32x32x16_bf16 v[176:191], v[98:101], v[224:227], v[176:191]
    v_exp_f32 v220, v220
    v_exp_f32 v221, v221
    v_exp_f32 v222, v222
    v_exp_f32 v223, v223
    v_cvt_pk_bf16_f32 v230, v220, v221
    v_cvt_pk_bf16_f32 v231, v222, v223
    v_mfma_f32_32x32x16_bf16 v[208:223], v[106:109], v[38:41], 0
    buffer_load_dwordx4 v[92:95], v60, s[12:15], s16 offen offset:1024
    v_exp_f32 v192, v192
    v_exp_f32 v193, v193
    v_exp_f32 v194, v194
    v_exp_f32 v195, v195
    v_cvt_pk_bf16_f32 v224, v192, v193
    v_cvt_pk_bf16_f32 v225, v194, v195
    v_mfma_f32_32x32x8_bf16 v[208:223], v[110:111], v[42:43], v[208:223]
    v_exp_f32 v196, v196
    v_exp_f32 v197, v197
    v_exp_f32 v198, v198
    v_exp_f32 v199, v199
    v_cvt_pk_bf16_f32 v226, v196, v197
    v_cvt_pk_bf16_f32 v227, v198, v199
    v_mfma_f32_32x32x16_bf16 v[176:191], v[102:105], v[228:231], v[176:191]
    v_exp_f32 v200, v200
    v_exp_f32 v201, v201
    v_exp_f32 v202, v202
    v_exp_f32 v203, v203
    v_cvt_pk_bf16_f32 v228, v200, v201
    v_cvt_pk_bf16_f32 v229, v202, v203
    v_mfma_f32_32x32x16_bf16 v[128:143], v[112:115], v[224:227], v[128:143]
    buffer_load_dwordx2 v[96:97], v61, s[12:15], s16 offen offset:1024
    v_exp_f32 v204, v204
    v_exp_f32 v205, v205
    v_exp_f32 v206, v206
    v_exp_f32 v207, v207
    v_cvt_pk_bf16_f32 v230, v204, v205
    v_cvt_pk_bf16_f32 v231, v206, v207
    v_mfma_f32_32x32x16_bf16 v[192:207], v[106:109], v[44:47], 0
    buffer_load_dwordx4 v[98:101], v62, s[12:15], s18 offen
    v_exp_f32 v208, v208
    v_exp_f32 v209, v209
    v_exp_f32 v210, v210
    v_exp_f32 v211, v211
    v_cvt_pk_bf16_f32 v224, v208, v209
    v_cvt_pk_bf16_f32 v225, v210, v211
    v_mfma_f32_32x32x8_bf16 v[192:207], v[110:111], v[48:49], v[192:207]
    v_exp_f32 v212, v212
    v_exp_f32 v213, v213
    v_exp_f32 v214, v214
    v_exp_f32 v215, v215
    v_cvt_pk_bf16_f32 v226, v212, v213
    v_cvt_pk_bf16_f32 v227, v214, v215
    v_mfma_f32_32x32x16_bf16 v[128:143], v[116:119], v[228:231], v[128:143]
    v_exp_f32 v216, v216
    v_exp_f32 v217, v217
    v_exp_f32 v218, v218
    v_exp_f32 v219, v219
    v_cvt_pk_bf16_f32 v228, v216, v217
    v_cvt_pk_bf16_f32 v229, v218, v219
    v_mfma_f32_32x32x16_bf16 v[144:159], v[112:115], v[224:227], v[144:159]
    buffer_load_dwordx4 v[102:105], v62, s[12:15], s18 offen offset:2176
    v_exp_f32 v220, v220
    v_exp_f32 v221, v221
    v_exp_f32 v222, v222
    v_exp_f32 v223, v223
    v_cvt_pk_bf16_f32 v230, v220, v221
    v_cvt_pk_bf16_f32 v231, v222, v223
    v_mfma_f32_32x32x16_bf16 v[208:223], v[106:109], v[50:53], 0
    s_add_u32 s18, s18, 8704
    v_exp_f32 v192, v192
    v_exp_f32 v193, v193
    v_exp_f32 v194, v194
    v_exp_f32 v195, v195
    v_cvt_pk_bf16_f32 v224, v192, v193
    v_cvt_pk_bf16_f32 v225, v194, v195
    v_mfma_f32_32x32x8_bf16 v[208:223], v[110:111], v[54:55], v[208:223]
    v_exp_f32 v196, v196
    v_exp_f32 v197, v197
    v_exp_f32 v198, v198
    v_exp_f32 v199, v199
    v_cvt_pk_bf16_f32 v226, v196, v197
    v_cvt_pk_bf16_f32 v227, v198, v199
    v_mfma_f32_32x32x16_bf16 v[144:159], v[116:119], v[228:231], v[144:159]
    v_exp_f32 v200, v200
    v_exp_f32 v201, v201
    v_exp_f32 v202, v202
    v_exp_f32 v203, v203
    v_cvt_pk_bf16_f32 v228, v200, v201
    v_cvt_pk_bf16_f32 v229, v202, v203
    v_mfma_f32_32x32x16_bf16 v[160:175], v[112:115], v[224:227], v[160:175]
    s_waitcnt vmcnt(8)
    v_exp_f32 v204, v204
    v_exp_f32 v205, v205
    v_exp_f32 v206, v206
    v_exp_f32_e64 v207, v207
    v_cvt_pk_bf16_f32 v230, v204, v205
    v_cvt_pk_bf16_f32 v231, v206, v207
    v_mfma_f32_32x32x16_bf16 v[192:207], v[64:67], v[32:35], 0
    v_exp_f32 v208, v208
    v_exp_f32 v209, v209
    v_exp_f32 v210, v210
    v_exp_f32 v211, v211
    v_cvt_pk_bf16_f32 v224, v208, v209
    v_cvt_pk_bf16_f32 v225, v210, v211
    v_mfma_f32_32x32x8_bf16 v[192:207], v[68:69], v[36:37], v[192:207]
    v_exp_f32 v212, v212
    v_exp_f32 v213, v213
    v_exp_f32 v214, v214
    v_exp_f32 v215, v215
    v_cvt_pk_bf16_f32 v226, v212, v213
    v_cvt_pk_bf16_f32 v227, v214, v215
    v_mfma_f32_32x32x16_bf16 v[160:175], v[116:119], v[228:231], v[160:175]
    v_exp_f32 v216, v216
    v_exp_f32 v217, v217
    v_exp_f32 v218, v218
    v_exp_f32 v219, v219
    v_cvt_pk_bf16_f32 v228, v216, v217
    v_cvt_pk_bf16_f32 v229, v218, v219
    v_mfma_f32_32x32x16_bf16 v[176:191], v[112:115], v[224:227], v[176:191]
    v_exp_f32 v220, v220
    v_exp_f32 v221, v221
    v_exp_f32 v222, v222
    v_exp_f32 v223, v223
    v_cvt_pk_bf16_f32 v230, v220, v221
    v_cvt_pk_bf16_f32 v231, v222, v223
L_att_entry:
    v_mfma_f32_32x32x16_bf16 v[208:223], v[64:67], v[38:41], 0
    buffer_load_dwordx4 v[106:109], v60, s[12:15], s16 offen offset:1536
    v_exp_f32 v192, v192
    v_exp_f32 v193, v193
    v_exp_f32 v194, v194
    v_exp_f32 v195, v195
    v_cvt_pk_bf16_f32 v224, v192, v193
    v_cvt_pk_bf16_f32 v225, v194, v195
    v_mfma_f32_32x32x8_bf16 v[208:223], v[68:69], v[42:43], v[208:223]
    v_exp_f32 v196, v196
    v_exp_f32 v197, v197
    v_exp_f32 v198, v198
    v_exp_f32 v199, v199
    v_cvt_pk_bf16_f32 v226, v196, v197
    v_cvt_pk_bf16_f32 v227, v198, v199
    v_mfma_f32_32x32x16_bf16 v[176:191], v[116:119], v[228:231], v[176:191]
    v_exp_f32 v200, v200
    v_exp_f32 v201, v201
    v_exp_f32 v202, v202
    v_exp_f32 v203, v203
    v_cvt_pk_bf16_f32 v228, v200, v201
    v_cvt_pk_bf16_f32 v229, v202, v203
    v_mfma_f32_32x32x16_bf16 v[128:143], v[70:73], v[224:227], v[128:143]
    buffer_load_dwordx2 v[110:111], v61, s[12:15], s16 offen offset:1536
    v_exp_f32 v204, v204
    v_exp_f32 v205, v205
    v_exp_f32 v206, v206
    v_exp_f32 v207, v207
    v_cvt_pk_bf16_f32 v230, v204, v205
    v_cvt_pk_bf16_f32 v231, v206, v207
    v_mfma_f32_32x32x16_bf16 v[192:207], v[64:67], v[44:47], 0
    buffer_load_dwordx4 v[112:115], v62, s[12:15], s18 offen
    v_exp_f32 v208, v208
    v_exp_f32 v209, v209
    v_exp_f32 v210, v210
    v_exp_f32 v211, v211
    v_cvt_pk_bf16_f32 v224, v208, v209
    v_cvt_pk_bf16_f32 v225, v210, v211
    v_mfma_f32_32x32x8_bf16 v[192:207], v[68:69], v[48:49], v[192:207]
    v_exp_f32 v212, v212
    v_exp_f32 v213, v213
    v_exp_f32 v214, v214
    v_exp_f32 v215, v215
    v_cvt_pk_bf16_f32 v226, v212, v213
    v_cvt_pk_bf16_f32 v227, v214, v215
    v_mfma_f32_32x32x16_bf16 v[128:143], v[74:77], v[228:231], v[128:143]
    s_add_u32 s16, s16, 2048
    v_exp_f32 v216, v216
    v_exp_f32 v217, v217
    v_exp_f32 v218, v218
    v_exp_f32 v219, v219
    v_cvt_pk_bf16_f32 v228, v216, v217
    v_cvt_pk_bf16_f32 v229, v218, v219
    v_mfma_f32_32x32x16_bf16 v[144:159], v[70:73], v[224:227], v[144:159]
    buffer_load_dwordx4 v[116:119], v62, s[12:15], s18 offen offset:2176
    v_exp_f32 v220, v220
    v_exp_f32 v221, v221
    v_exp_f32 v222, v222
    v_exp_f32 v223, v223
    v_cvt_pk_bf16_f32 v230, v220, v221
    v_cvt_pk_bf16_f32 v231, v222, v223
    v_mfma_f32_32x32x16_bf16 v[208:223], v[64:67], v[50:53], 0
    s_add_u32 s18, s18, 8704
    v_exp_f32 v192, v192
    v_exp_f32 v193, v193
    v_exp_f32 v194, v194
    v_exp_f32 v195, v195
    v_cvt_pk_bf16_f32 v224, v192, v193
    v_cvt_pk_bf16_f32 v225, v194, v195
    v_mfma_f32_32x32x8_bf16 v[208:223], v[68:69], v[54:55], v[208:223]
    v_exp_f32 v196, v196
    v_exp_f32 v197, v197
    v_exp_f32 v198, v198
    v_exp_f32 v199, v199
    v_cvt_pk_bf16_f32 v226, v196, v197
    v_cvt_pk_bf16_f32 v227, v198, v199
    v_mfma_f32_32x32x16_bf16 v[144:159], v[74:77], v[228:231], v[144:159]
    s_cmp_eq_u32 s16, s17
    v_exp_f32 v200, v200
    v_exp_f32 v201, v201
    v_exp_f32 v202, v202
    v_exp_f32_e64 v203, v203
    v_cvt_pk_bf16_f32 v228, v200, v201
    v_cvt_pk_bf16_f32 v229, v202, v203
    v_mfma_f32_32x32x16_bf16 v[160:175], v[70:73], v[224:227], v[160:175]
    s_waitcnt vmcnt(8)
    v_exp_f32 v204, v204
    v_exp_f32 v205, v205
    v_exp_f32 v206, v206
    v_exp_f32_e64 v207, v207
    v_cvt_pk_bf16_f32 v230, v204, v205
    v_cvt_pk_bf16_f32 v231, v206, v207
    v_mfma_f32_32x32x16_bf16 v[192:207], v[78:81], v[32:35], 0
    s_cselect_b32 s16, s27, s16
    v_exp_f32 v208, v208
    v_exp_f32 v209, v209
    v_exp_f32 v210, v210
    v_exp_f32_e64 v211, v211
    v_cvt_pk_bf16_f32 v224, v208, v209
    v_cvt_pk_bf16_f32 v225, v210, v211
    v_mfma_f32_32x32x8_bf16 v[192:207], v[82:83], v[36:37], v[192:207]
    v_exp_f32 v212, v212
    v_exp_f32 v213, v213
    v_exp_f32 v214, v214
    v_exp_f32 v215, v215
    v_cvt_pk_bf16_f32 v226, v212, v213
    v_cvt_pk_bf16_f32 v227, v214, v215
    v_mfma_f32_32x32x16_bf16 v[160:175], v[74:77], v[228:231], v[160:175]
    s_cselect_b32 s18, s28, s18
    v_exp_f32 v216, v216
    v_exp_f32 v217, v217
    v_exp_f32 v218, v218
    v_exp_f32_e64 v219, v219
    v_cvt_pk_bf16_f32 v228, v216, v217
    v_cvt_pk_bf16_f32 v229, v218, v219
    v_mfma_f32_32x32x16_bf16 v[176:191], v[70:73], v[224:227], v[176:191]
    s_sub_u32 s19, s19, 1
    v_exp_f32 v220, v220
    v_exp_f32 v221, v221
    v_exp_f32 v222, v222
    v_exp_f32_e64 v223, v223
    v_cvt_pk_bf16_f32 v230, v220, v221
    v_cvt_pk_bf16_f32 v231, v222, v223
    s_cbranch_scc0 L_att_loop
    s_nop 0
    v_mfma_f32_32x32x16_bf16 v[208:223], v[78:81], v[38:41], 0
    v_exp_f32 v192, v192
    v_exp_f32 v193, v193
    v_exp_f32 v194, v194
    v_exp_f32 v195, v195
    v_cvt_pk_bf16_f32 v224, v192, v193
    v_cvt_pk_bf16_f32 v225, v194, v195
    v_mfma_f32_32x32x8_bf16 v[208:223], v[82:83], v[42:43], v[208:223]
    v_exp_f32 v196, v196
    v_exp_f32 v197, v197
    v_exp_f32 v198, v198
    v_exp_f32 v199, v199
    v_cvt_pk_bf16_f32 v226, v196, v197
    v_cvt_pk_bf16_f32 v227, v198, v199
    v_mfma_f32_32x32x16_bf16 v[176:191], v[74:77], v[228:231], v[176:191]
    v_exp_f32 v200, v200
    v_exp_f32 v201, v201
    v_exp_f32 v202, v202
    v_exp_f32 v203, v203
    v_cvt_pk_bf16_f32 v228, v200, v201
    v_cvt_pk_bf16_f32 v229, v202, v203
    v_mfma_f32_32x32x16_bf16 v[128:143], v[84:87], v[224:227], v[128:143]
    v_exp_f32 v204, v204
    v_exp_f32 v205, v205
    v_exp_f32 v206, v206
    v_exp_f32 v207, v207
    v_cvt_pk_bf16_f32 v230, v204, v205
    v_cvt_pk_bf16_f32 v231, v206, v207
    v_mfma_f32_32x32x16_bf16 v[192:207], v[78:81], v[44:47], 0
    v_exp_f32 v208, v208
    v_exp_f32 v209, v209
    v_exp_f32 v210, v210
    v_exp_f32 v211, v211
    v_cvt_pk_bf16_f32 v224, v208, v209
    v_cvt_pk_bf16_f32 v225, v210, v211
    v_mfma_f32_32x32x8_bf16 v[192:207], v[82:83], v[48:49], v[192:207]
    v_exp_f32 v212, v212
    v_exp_f32 v213, v213
    v_exp_f32 v214, v214
    v_exp_f32 v215, v215
    v_cvt_pk_bf16_f32 v226, v212, v213
    v_cvt_pk_bf16_f32 v227, v214, v215
    v_mfma_f32_32x32x16_bf16 v[128:143], v[88:91], v[228:231], v[128:143]
    v_exp_f32 v216, v216
    v_exp_f32 v217, v217
    v_exp_f32 v218, v218
    v_exp_f32 v219, v219
    v_cvt_pk_bf16_f32 v228, v216, v217
    v_cvt_pk_bf16_f32 v229, v218, v219
    v_mfma_f32_32x32x16_bf16 v[144:159], v[84:87], v[224:227], v[144:159]
    v_exp_f32 v220, v220
    v_exp_f32 v221, v221
    v_exp_f32 v222, v222
    v_exp_f32 v223, v223
    v_cvt_pk_bf16_f32 v230, v220, v221
    v_cvt_pk_bf16_f32 v231, v222, v223
    v_mfma_f32_32x32x16_bf16 v[208:223], v[78:81], v[50:53], 0
    v_exp_f32 v192, v192
    v_exp_f32 v193, v193
    v_exp_f32 v194, v194
    v_exp_f32 v195, v195
    v_cvt_pk_bf16_f32 v224, v192, v193
    v_cvt_pk_bf16_f32 v225, v194, v195
    v_mfma_f32_32x32x8_bf16 v[208:223], v[82:83], v[54:55], v[208:223]
    v_exp_f32 v196, v196
    v_exp_f32 v197, v197
    v_exp_f32 v198, v198
    v_exp_f32 v199, v199
    v_cvt_pk_bf16_f32 v226, v196, v197
    v_cvt_pk_bf16_f32 v227, v198, v199
    v_mfma_f32_32x32x16_bf16 v[144:159], v[88:91], v[228:231], v[144:159]
    v_exp_f32 v200, v200
    v_exp_f32 v201, v201
    v_exp_f32 v202, v202
    v_exp_f32 v203, v203
    v_cvt_pk_bf16_f32 v228, v200, v201
    v_cvt_pk_bf16_f32 v229, v202, v203
    v_mfma_f32_32x32x16_bf16 v[160:175], v[84:87], v[224:227], v[160:175]
    s_waitcnt vmcnt(4)
    v_exp_f32 v204, v204
    v_exp_f32 v205, v205
    v_exp_f32 v206, v206
    v_exp_f32_e64 v207, v207
    v_cvt_pk_bf16_f32 v230, v204, v205
    v_cvt_pk_bf16_f32 v231, v206, v207
    v_mfma_f32_32x32x16_bf16 v[192:207], v[92:95], v[32:35], 0
    v_exp_f32 v208, v208
    v_exp_f32 v209, v209
    v_exp_f32 v210, v210
    v_exp_f32 v211, v211
    v_cvt_pk_bf16_f32 v224, v208, v209
    v_cvt_pk_bf16_f32 v225, v210, v211
    v_mfma_f32_32x32x8_bf16 v[192:207], v[96:97], v[36:37], v[192:207]
    v_exp_f32 v212, v212
    v_exp_f32 v213, v213
    v_exp_f32 v214, v214
    v_exp_f32 v215, v215
    v_cvt_pk_bf16_f32 v226, v212, v213
    v_cvt_pk_bf16_f32 v227, v214, v215
    v_mfma_f32_32x32x16_bf16 v[160:175], v[88:91], v[228:231], v[160:175]
    v_exp_f32 v216, v216
    v_exp_f32 v217, v217
    v_exp_f32 v218, v218
    v_exp_f32 v219, v219
    v_cvt_pk_bf16_f32 v228, v216, v217
    v_cvt_pk_bf16_f32 v229, v218, v219
    v_mfma_f32_32x32x16_bf16 v[176:191], v[84:87], v[224:227], v[176:191]
    v_exp_f32 v220, v220
    v_exp_f32 v221, v221
    v_exp_f32 v222, v222
    v_exp_f32 v223, v223
    v_cvt_pk_bf16_f32 v230, v220, v221
    v_cvt_pk_bf16_f32 v231, v222, v223
    v_mfma_f32_32x32x16_bf16 v[208:223], v[92:95], v[38:41], 0
    v_exp_f32 v192, v192
    v_exp_f32 v193, v193
    v_exp_f32 v194, v194
    v_exp_f32 v195, v195
    v_cvt_pk_bf16_f32 v224, v192, v193
    v_cvt_pk_bf16_f32 v225, v194, v195
    v_mfma_f32_32x32x8_bf16 v[208:223], v[96:97], v[42:43], v[208:223]
    v_exp_f32 v196, v196
    v_exp_f32 v197, v197
    v_exp_f32 v198, v198
    v_exp_f32 v199, v199
    v_cvt_pk_bf16_f32 v226, v196, v197
    v_cvt_pk_bf16_f32 v227, v198, v199
    v_mfma_f32_32x32x16_bf16 v[176:191], v[88:91], v[228:231], v[176:191]
    v_exp_f32 v200, v200
    v_exp_f32 v201, v201
    v_exp_f32 v202, v202
    v_exp_f32 v203, v203
    v_cvt_pk_bf16_f32 v228, v200, v201
    v_cvt_pk_bf16_f32 v229, v202, v203
    v_mfma_f32_32x32x16_bf16 v[128:143], v[98:101], v[224:227], v[128:143]
    v_exp_f32 v204, v204
    v_exp_f32 v205, v205
    v_exp_f32 v206, v206
    v_exp_f32 v207, v207
    v_cvt_pk_bf16_f32 v230, v204, v205
    v_cvt_pk_bf16_f32 v231, v206, v207
    v_mfma_f32_32x32x16_bf16 v[192:207], v[92:95], v[44:47], 0
    v_exp_f32 v208, v208
    v_exp_f32 v209, v209
    v_exp_f32 v210, v210
    v_exp_f32 v211, v211
    v_cvt_pk_bf16_f32 v224, v208, v209
    v_cvt_pk_bf16_f32 v225, v210, v211
    v_mfma_f32_32x32x8_bf16 v[192:207], v[96:97], v[48:49], v[192:207]
    v_exp_f32 v212, v212
    v_exp_f32 v213, v213
    v_exp_f32 v214, v214
    v_exp_f32 v215, v215
    v_cvt_pk_bf16_f32 v226, v212, v213
    v_cvt_pk_bf16_f32 v227, v214, v215
    v_mfma_f32_32x32x16_bf16 v[128:143], v[102:105], v[228:231], v[128:143]
    v_exp_f32 v216, v216
    v_exp_f32 v217, v217
    v_exp_f32 v218, v218
    v_exp_f32 v219, v219
    v_cvt_pk_bf16_f32 v228, v216, v217
    v_cvt_pk_bf16_f32 v229, v218, v219
    v_mfma_f32_32x32x16_bf16 v[144:159], v[98:101], v[224:227], v[144:159]
    v_exp_f32 v220, v220
    v_exp_f32 v221, v221
    v_exp_f32 v222, v222
    v_exp_f32 v223, v223
    v_cvt_pk_bf16_f32 v230, v220, v221
    v_cvt_pk_bf16_f32 v231, v222, v223
    v_mfma_f32_32x32x16_bf16 v[208:223], v[92:95], v[50:53], 0
    v_exp_f32 v192, v192
    v_exp_f32 v193, v193
    v_exp_f32 v194, v194
    v_exp_f32 v195, v195
    v_cvt_pk_bf16_f32 v224, v192, v193
    v_cvt_pk_bf16_f32 v225, v194, v195
    v_mfma_f32_32x32x8_bf16 v[208:223], v[96:97], v[54:55], v[208:223]
    v_exp_f32 v196, v196
    v_exp_f32 v197, v197
    v_exp_f32 v198, v198
    v_exp_f32 v199, v199
    v_cvt_pk_bf16_f32 v226, v196, v197
    v_cvt_pk_bf16_f32 v227, v198, v199
    v_mfma_f32_32x32x16_bf16 v[144:159], v[102:105], v[228:231], v[144:159]
    v_exp_f32 v200, v200
    v_exp_f32 v201, v201
    v_exp_f32 v202, v202
    v_exp_f32 v203, v203
    v_cvt_pk_bf16_f32 v228, v200, v201
    v_cvt_pk_bf16_f32 v229, v202, v203
    v_mfma_f32_32x32x16_bf16 v[160:175], v[98:101], v[224:227], v[160:175]
    s_waitcnt vmcnt(0)
    v_exp_f32 v204, v204
    v_exp_f32 v205, v205
    v_exp_f32 v206, v206
    v_exp_f32_e64 v207, v207
    v_cvt_pk_bf16_f32 v230, v204, v205
    v_cvt_pk_bf16_f32 v231, v206, v207
    v_mfma_f32_32x32x16_bf16 v[192:207], v[106:109], v[32:35], 0
    v_exp_f32 v208, v208
    v_exp_f32 v209, v209
    v_exp_f32 v210, v210
    v_exp_f32 v211, v211
    v_cvt_pk_bf16_f32 v224, v208, v209
    v_cvt_pk_bf16_f32 v225, v210, v211
    v_mfma_f32_32x32x8_bf16 v[192:207], v[110:111], v[36:37], v[192:207]
    v_exp_f32 v212, v212
    v_exp_f32 v213, v213
    v_exp_f32 v214, v214
    v_exp_f32 v215, v215
    v_cvt_pk_bf16_f32 v226, v212, v213
    v_cvt_pk_bf16_f32 v227, v214, v215
    v_mfma_f32_32x32x16_bf16 v[160:175], v[102:105], v[228:231], v[160:175]
    v_exp_f32 v216, v216
    v_exp_f32 v217, v217
    v_exp_f32 v218, v218
    v_exp_f32 v219, v219
    v_cvt_pk_bf16_f32 v228, v216, v217
    v_cvt_pk_bf16_f32 v229, v218, v219
    v_mfma_f32_32x32x16_bf16 v[176:191], v[98:101], v[224:227], v[176:191]
    v_exp_f32 v220, v220
    v_exp_f32 v221, v221
    v_exp_f32 v222, v222
    v_exp_f32 v223, v223
    v_cvt_pk_bf16_f32 v230, v220, v221
    v_cvt_pk_bf16_f32 v231, v222, v223
    v_mfma_f32_32x32x16_bf16 v[208:223], v[106:109], v[38:41], 0
    v_exp_f32 v192, v192
    v_exp_f32 v193, v193
    v_exp_f32 v194, v194
    v_exp_f32 v195, v195
    v_cvt_pk_bf16_f32 v224, v192, v193
    v_cvt_pk_bf16_f32 v225, v194, v195
    v_mfma_f32_32x32x8_bf16 v[208:223], v[110:111], v[42:43], v[208:223]
    v_exp_f32 v196, v196
    v_exp_f32 v197, v197
    v_exp_f32 v198, v198
    v_exp_f32 v199, v199
    v_cvt_pk_bf16_f32 v226, v196, v197
    v_cvt_pk_bf16_f32 v227, v198, v199
    v_mfma_f32_32x32x16_bf16 v[176:191], v[102:105], v[228:231], v[176:191]
    v_exp_f32 v200, v200
    v_exp_f32 v201, v201
    v_exp_f32 v202, v202
    v_exp_f32 v203, v203
    v_cvt_pk_bf16_f32 v228, v200, v201
    v_cvt_pk_bf16_f32 v229, v202, v203
    v_mfma_f32_32x32x16_bf16 v[128:143], v[112:115], v[224:227], v[128:143]
    v_exp_f32 v204, v204
    v_exp_f32 v205, v205
    v_exp_f32 v206, v206
    v_exp_f32 v207, v207
    v_cvt_pk_bf16_f32 v230, v204, v205
    v_cvt_pk_bf16_f32 v231, v206, v207
    v_mfma_f32_32x32x16_bf16 v[192:207], v[106:109], v[44:47], 0
    v_exp_f32 v208, v208
    v_exp_f32 v209, v209
    v_exp_f32 v210, v210
    v_exp_f32 v211, v211
    v_cvt_pk_bf16_f32 v224, v208, v209
    v_cvt_pk_bf16_f32 v225, v210, v211
    v_mfma_f32_32x32x8_bf16 v[192:207], v[110:111], v[48:49], v[192:207]
    v_exp_f32 v212, v212
    v_exp_f32 v213, v213
    v_exp_f32 v214, v214
    v_exp_f32 v215, v215
    v_cvt_pk_bf16_f32 v226, v212, v213
    v_cvt_pk_bf16_f32 v227, v214, v215
    v_mfma_f32_32x32x16_bf16 v[128:143], v[116:119], v[228:231], v[128:143]
    v_exp_f32 v216, v216
    v_exp_f32 v217, v217
    v_exp_f32 v218, v218
    v_exp_f32 v219, v219
    v_cvt_pk_bf16_f32 v228, v216, v217
    v_cvt_pk_bf16_f32 v229, v218, v219
    v_mfma_f32_32x32x16_bf16 v[144:159], v[112:115], v[224:227], v[144:159]
    v_exp_f32 v220, v220
    v_exp_f32 v221, v221
    v_exp_f32 v222, v222
    v_exp_f32 v223, v223
    v_cvt_pk_bf16_f32 v230, v220, v221
    v_cvt_pk_bf16_f32 v231, v222, v223
    v_mfma_f32_32x32x16_bf16 v[208:223], v[106:109], v[50:53], 0
    ds_write_b128 v240, v[128:131] offset:0
    v_exp_f32 v192, v192
    v_exp_f32 v193, v193
    v_exp_f32 v194, v194
    v_exp_f32 v195, v195
    v_cvt_pk_bf16_f32 v224, v192, v193
    v_cvt_pk_bf16_f32 v225, v194, v195
    v_mfma_f32_32x32x8_bf16 v[208:223], v[110:111], v[54:55], v[208:223]
    ds_write_b128 v240, v[132:135] offset:1024
    v_mov_b32 v141, v56
    v_exp_f32 v196, v196
    v_exp_f32 v197, v197
    v_exp_f32 v198, v198
    v_exp_f32_e64 v199, v199
    v_cvt_pk_bf16_f32 v226, v196, v197
    v_cvt_pk_bf16_f32 v227, v198, v199
    v_mfma_f32_32x32x16_bf16 v[144:159], v[116:119], v[228:231], v[144:159]
    ds_write_b128 v240, v[136:139] offset:2048
    v_exp_f32 v200, v200
    v_exp_f32 v201, v201
    v_exp_f32 v202, v202
    v_exp_f32 v203, v203
    v_cvt_pk_bf16_f32 v228, v200, v201
    v_cvt_pk_bf16_f32 v229, v202, v203
    v_mfma_f32_32x32x16_bf16 v[160:175], v[112:115], v[224:227], v[160:175]
    ds_write_b64 v241, v[140:141] offset:3072
    v_exp_f32 v204, v204
    v_exp_f32 v205, v205
    v_exp_f32 v206, v206
    v_exp_f32 v207, v207
    v_cvt_pk_bf16_f32 v230, v204, v205
    v_cvt_pk_bf16_f32 v231, v206, v207
    ds_write_b128 v240, v[144:147] offset:3328
    v_exp_f32 v208, v208
    v_exp_f32 v209, v209
    v_exp_f32 v210, v210
    v_exp_f32 v211, v211
    v_cvt_pk_bf16_f32 v224, v208, v209
    v_cvt_pk_bf16_f32 v225, v210, v211
    ds_write_b128 v240, v[148:151] offset:4352
    v_mov_b32 v157, v57
    v_exp_f32 v212, v212
    v_exp_f32 v213, v213
    v_exp_f32 v214, v214
    v_exp_f32_e64 v215, v215
    v_cvt_pk_bf16_f32 v226, v212, v213
    v_cvt_pk_bf16_f32 v227, v214, v215
    v_mfma_f32_32x32x16_bf16 v[160:175], v[116:119], v[228:231], v[160:175]
    ds_write_b128 v240, v[152:155] offset:5376
    v_exp_f32 v216, v216
    v_exp_f32 v217, v217
    v_exp_f32 v218, v218
    v_exp_f32 v219, v219
    v_cvt_pk_bf16_f32 v228, v216, v217
    v_cvt_pk_bf16_f32 v229, v218, v219
    v_mfma_f32_32x32x16_bf16 v[176:191], v[112:115], v[224:227], v[176:191]
    ds_write_b64 v241, v[156:157] offset:6400
    v_exp_f32 v220, v220
    v_exp_f32 v221, v221
    v_exp_f32 v222, v222
    v_exp_f32 v223, v223
    v_cvt_pk_bf16_f32 v230, v220, v221
    v_cvt_pk_bf16_f32 v231, v222, v223
    s_nop 1
    v_mfma_f32_32x32x16_bf16 v[176:191], v[116:119], v[228:231], v[176:191]
    v_mov_b32 v4, s74
    v_mov_b32 v5, s75
    v_lshlrev_b32 v6, 7, v1
    v_max3_f32 v2, v140, v156, v172
    s_nop 7
    v_max_f32 v2, v2, v188
    v_cmp_lt_f32 vcc, 0x4e800000, v2
    s_cbranch_vccz L_att_ok
    s_cmp_lg_u32 s20, 0
    s_cbranch_scc1 L_att_ok
    s_mov_b32 s20, 1
    s_waitcnt vmcnt(0)
    s_branch L_att_start
L_att_ok:
    s_mov_b64 exec, 1
    ds_add_u32 v244, v255 offset:16
    s_mov_b64 exec, -1
    s_mov_b32 s82, 262144
L_xw_9:
    ds_read_b32 v7, v244 offset:16
    ds_read_b64 v[220:221], v243 offset:3072
    ds_read_b64 v[204:205], v243 offset:6400
    ds_read_b128 v[208:211], v242 offset:0
    ds_read_b128 v[212:215], v242 offset:1024
    ds_read_b128 v[216:219], v242 offset:2048
    ds_read_b128 v[192:195], v242 offset:3328
    ds_read_b128 v[196:199], v242 offset:4352
    ds_read_b128 v[200:203], v242 offset:5376
    s_waitcnt lgkmcnt(8)
    v_readfirstlane_b32 s3, v7
    s_nop 0
    s_cmp_ge_u32 s3, 2
    s_cbranch_scc1 L_xd_10
    s_sub_u32 s82, s82, 1
    s_cbranch_scc0 L_xw_9
L_xd_10:
    s_waitcnt lgkmcnt(6)
    v_max_f32 v12, v58, v221
    v_sub_f32 v14, v221, v12
    v_sub_f32 v12, v58, v12
    v_exp_f32 v12, v12
    v_exp_f32 v14, v14
    v_max_f32 v16, v59, v205
    v_sub_f32 v18, v205, v16
    v_sub_f32 v16, v59, v16
    v_exp_f32 v16, v16
    v_exp_f32 v18, v18
    v_mul_f32 v13, v12, v172
    v_fma_f32 v13, v14, v220, v13
    v_rcp_f32 v13, v13
    v_mul_f32 v17, v16, v188
    v_fma_f32 v17, v18, v204, v17
    v_rcp_f32 v17, v17
    v_mul_f32 v13, v120, v13
    v_mul_f32 v12, v12, v13
    v_mul_f32 v14, v14, v13
    v_mul_f32 v17, v121, v17
    v_mul_f32 v16, v16, v17
    v_mul_f32 v18, v18, v17
    s_waitcnt lgkmcnt(3)
    v_pk_mul_f32 v[160:161], v[160:161], v[12:13] op_sel_hi:[1,0]
    v_pk_mul_f32 v[162:163], v[162:163], v[12:13] op_sel_hi:[1,0]
    v_pk_mul_f32 v[164:165], v[164:165], v[12:13] op_sel_hi:[1,0]
    v_pk_mul_f32 v[166:167], v[166:167], v[12:13] op_sel_hi:[1,0]
    v_pk_mul_f32 v[168:169], v[168:169], v[12:13] op_sel_hi:[1,0]
    v_pk_mul_f32 v[170:171], v[170:171], v[12:13] op_sel_hi:[1,0]
    v_pk_fma_f32 v[160:161], v[208:209], v[14:15], v[160:161] op_sel_hi:[1,0,1]
    v_pk_fma_f32 v[162:163], v[210:211], v[14:15], v[162:163] op_sel_hi:[1,0,1]
    v_pk_fma_f32 v[164:165], v[212:213], v[14:15], v[164:165] op_sel_hi:[1,0,1]
    v_pk_fma_f32 v[166:167], v[214:215], v[14:15], v[166:167] op_sel_hi:[1,0,1]
    v_pk_fma_f32 v[168:169], v[216:217], v[14:15], v[168:169] op_sel_hi:[1,0,1]
    v_pk_fma_f32 v[170:171], v[218:219], v[14:15], v[170:171] op_sel_hi:[1,0,1]
    v_cvt_pk_bf16_f32 v160, v160, v161
    v_cvt_pk_bf16_f32 v161, v162, v163
    v_cvt_pk_bf16_f32 v162, v164, v165
    v_cvt_pk_bf16_f32 v163, v166, v167
    v_cvt_pk_bf16_f32 v164, v168, v169
    v_cvt_pk_bf16_f32 v165, v170, v171
    buffer_store_dwordx4 v[160:163], v245, s[12:15], s52 offen offset:0 sc1
    buffer_store_dwordx2 v[164:165], v246, s[12:15], s53 offen offset:0 sc1
    s_waitcnt lgkmcnt(0)
    v_pk_mul_f32 v[176:177], v[176:177], v[16:17] op_sel_hi:[1,0]
    v_pk_mul_f32 v[178:179], v[178:179], v[16:17] op_sel_hi:[1,0]
    v_pk_mul_f32 v[180:181], v[180:181], v[16:17] op_sel_hi:[1,0]
    v_pk_mul_f32 v[182:183], v[182:183], v[16:17] op_sel_hi:[1,0]
    v_pk_mul_f32 v[184:185], v[184:185], v[16:17] op_sel_hi:[1,0]
    v_pk_mul_f32 v[186:187], v[186:187], v[16:17] op_sel_hi:[1,0]
    v_pk_fma_f32 v[176:177], v[192:193], v[18:19], v[176:177] op_sel_hi:[1,0,1]
    v_pk_fma_f32 v[178:179], v[194:195], v[18:19], v[178:179] op_sel_hi:[1,0,1]
    v_pk_fma_f32 v[180:181], v[196:197], v[18:19], v[180:181] op_sel_hi:[1,0,1]
    v_pk_fma_f32 v[182:183], v[198:199], v[18:19], v[182:183] op_sel_hi:[1,0,1]
    v_pk_fma_f32 v[184:185], v[200:201], v[18:19], v[184:185] op_sel_hi:[1,0,1]
    v_pk_fma_f32 v[186:187], v[202:203], v[18:19], v[186:187] op_sel_hi:[1,0,1]
    v_cvt_pk_bf16_f32 v176, v176, v177
    v_cvt_pk_bf16_f32 v177, v178, v179
    v_cvt_pk_bf16_f32 v178, v180, v181
    v_cvt_pk_bf16_f32 v179, v182, v183
    v_cvt_pk_bf16_f32 v180, v184, v185
    v_cvt_pk_bf16_f32 v181, v186, v187
    buffer_store_dwordx4 v[176:179], v245, s[12:15], s52 offen offset:512 sc1
    buffer_store_dwordx2 v[180:181], v246, s[12:15], s53 offen offset:256 sc1
    s_mov_b64 exec, 1
    ds_add_u32 v254, v255 offset:24
    s_mov_b64 exec, -1
    s_mov_b64 exec, 1
    s_waitcnt vmcnt(0)
    buffer_store_dwordx2 v[4:5], v6, s[12:15], s54 offen sc1
    s_mov_b64 exec, -1
    s_endpgm
L_M:
    v_mov_b32 v254, 161792
    v_mov_b32 v255, 1
    v_mov_b32 v16, 0
    v_lshl_add_u32 v17, v1, 2, v254
    s_cmp_lg_u32 s76, 0
    s_cbranch_scc1 L_nz_11
    s_mov_b64 exec, 0xffff
    ds_write_b32 v17, v16
    s_mov_b64 exec, -1
L_nz_11:
    s_mul_i32 s3, s79, 52
    s_lshr_b32 s3, s3, 8
    s_mul_i32 s37, s3, 5
    s_sub_u32 s37, s79, s37
    s_and_b32 s36, s78, 1
    s_mul_i32 s36, s36, 6
    s_add_u32 s36, s36, s3
    s_lshr_b32 s22, s78, 1
    s_mov_b32 s52, s26
    s_mov_b32 s53, s27
    s_mov_b32 s54, 3072
    s_mov_b32 s55, 0x20000
    s_mov_b32 s44, s28
    s_mov_b32 s45, s29
    s_mov_b32 s46, 6291456
    s_mov_b32 s47, 0x20000
    s_mov_b32 s48, s20
    s_mov_b32 s49, s21
    s_mov_b32 s50, 819200
    s_mov_b32 s51, 0x20000
    s_mov_b32 s56, s30
    s_mov_b32 s57, s31
    s_mov_b32 s58, 4096
    s_mov_b32 s59, 0x20000
    s_mov_b32 s64, s34
    s_mov_b32 s65, s35
    s_mov_b32 s66, 2621440
    s_mov_b32 s67, 0x20000
    s_lshr_b32 s26, s22, 1
    s_and_b32 s27, s22, 1
    s_lshl_b32 s24, s36, 1
    s_add_u32 s24, s24, s83
    s_lshl_b32 s24, s24, 1
    s_add_u32 s24, s24, s26
    s_lshl_b32 s25, s37, 1
    s_add_u32 s25, s25, s84
    s_lshl_b32 s25, s25, 1
    s_add_u32 s25, s25, s27
    v_lshrrev_b32 v26, 4, v1
    v_and_b32 v27, 15, v1
    v_lshlrev_b32 v16, 29, v26
    v_lshl_add_u32 v16, v27, 1, v16
    s_lshl_b32 s3, s24, 6
    buffer_load_ushort v194, v16, s[52:55], s3 offen
    buffer_load_ushort v196, v16, s[52:55], s3 offen offset:32
    v_mov_b32 v195, 0
    v_mov_b32 v197, 0
    v_mov_b32 v22, 0x3f80
    v_mov_b32 v23, 0
    s_mul_i32 s3, s77, 2560
    s_add_u32 s3, s3, 135168
    v_add_u32 v12, s3, v12
    v_add_u32 v13, s3, v13
    v_lshrrev_b32 v10, 1, v27
    v_xor_b32 v10, v10, v26
    v_lshlrev_b32 v10, 4, v10
    s_lshl_b32 s3, s84, 13
    v_lshlrev_b32 v11, 7, v27
    v_add3_u32 v2, v11, v10, s3
    v_xor_b32 v3, 64, v2
    v_bfe_u32 v10, v1, 2, 2
    v_lshl_add_u32 v11, v26, 3, v10
    v_lshlrev_b32 v11, 8, v11
    v_and_b32 v16, 3, v1
    v_lshl_add_u32 v11, v16, 3, v11
    v_add_u32 v11, 65536, v11
    v_bfe_u32 v10, v1, 2, 3
    s_lshl_b32 s3, s83, 2
    v_xor_b32 v10, s3, v10
    v_lshl_add_u32 v4, v10, 5, v11
    v_xor_b32 v5, 32, v4
    v_xor_b32 v6, 64, v4
    v_xor_b32 v7, 96, v4
    s_lshl_b32 s3, s84, 1
    s_add_u32 s3, s3, s27
    s_lshl_b32 s3, s3, 9
    v_lshlrev_b32 v16, 11, v26
    v_lshl_add_u32 v16, v27, 4, v16
    v_add_u32 v24, s3, v16
    v_xor_b32 v25, 512, v24
    v_lshlrev_b32 v16, 2, v26
    v_sub_u32 v16, v27, v16
    v_and_b32 v17, 1, v16
    v_lshlrev_b32 v17, 4, v17
    v_lshlrev_b32 v17, v17, v22
    v_lshrrev_b32 v16, 1, v16
    v_cmp_eq_u32 vcc, 0, v16
    s_nop 1
    v_cndmask_b32 v192, 0, v17, vcc
    v_cmp_eq_u32 vcc, 1, v16
    s_nop 1
    v_cndmask_b32 v193, 0, v17, vcc
    v_lshl_add_u32 v20, v9, 4, v27
    v_lshlrev_b32 v20, 4, v20
    v_and_b32 v21, 1, v26
    s_lshl_b32 s3, s81, 4
    s_add_u32 s3, s3, s80
    s_lshl_b32 s3, s3, 4
    s_add_u32 s3, s3, 8192
    v_mov_b32 v30, s3
    s_mul_i32 s3, s81, 52
    s_lshr_b32 s3, s3, 8
    s_mul_i32 s85, s3, 5
    s_sub_u32 s85, s81, s85
    s_lshl_b32 s85, s85, 7
    s_lshl_b32 s3, s3, 8
    s_sub_u32 s3, s3, 256
    s_cselect_b32 s3, 512, s3
    s_lshl_b32 s82, s80, 3
    s_add_u32 s3, s3, s82
    s_add_u32 s3, s3, 524288
    s_mul_i32 s82, s85, 3277
    s_lshr_b32 s82, s82, 16
    v_add_u32 v16, s82, v1
    v_lshl_add_u32 v30, v16, 10, s3
    v_mul_u32_u24 v16, 20, v16
    v_cmp_gt_u32 vcc, s85, v16
    v_mov_b32 v17, 128
    s_nop 0
    v_cndmask_b32 v17, 0, v17, vcc
    v_add_u32 v30, v30, v17
    s_add_u32 s85, s85, 128
    v_cmp_gt_u32 vcc, s85, v16
    v_mov_b32 v17, 0x80000000
    s_nop 0
    v_cndmask_b32 v30, v17, v30, vcc
    s_mov_b32 s28, 0x3f803f80
    v_mov_b32 v16, 0
    v_mov_b32 v17, 0
    v_mov_b32 v18, 0
    v_mov_b32 v19, 0
    s_waitcnt lgkmcnt(0)
    s_mul_i32 s74, s72, 1664525
    s_add_u32 s74, s74, 1013904223
    s_mul_i32 s75, s73, 22695477
    s_add_u32 s75, s75, 0x3c6ef35f
    v_mov_b32 v28, s74
    v_mov_b32 v29, s75
    s_lshl_b32 s30, s78, 2
    s_lshr_b32 s33, s79, 3
    s_add_u32 s30, s30, s33
    s_and_b32 s31, s79, 7
    s_mul_i32 s23, s77, 33792
    v_lshrrev_b32 v230, 4, v1
    v_and_b32 v231, 15, v1
    s_mul_i32 s85, s77, 1572864
    s_lshl_b32 s3, s30, 7
    s_add_u32 s3, s3, s85
    v_lshrrev_b32 v180, 3, v1
    v_lshlrev_b32 v180, 12, v180
    v_lshlrev_b32 v181, 1, v230
    v_and_b32 v182, 7, v1
    v_xor_b32 v181, v181, v182
    v_lshlrev_b32 v181, 4, v181
    v_add3_u32 v224, v180, v181, s3
    v_add_u32 v225, 31744, v224
    v_add_u32 v226, 63488, v224
    v_add_u32 v227, 95232, v224
    v_bfe_u32 v180, v1, 2, 3
    v_lshl_add_u32 v181, v9, 4, v180
    v_lshlrev_b32 v181, 7, v181
    v_and_b32 v182, 3, v1
    v_lshlrev_b32 v182, 3, v182
    v_add3_u32 v181, v181, v182, s23
    v_lshrrev_b32 v183, 1, v180
    v_xor_b32 v183, s77, v183
    v_lshl_add_u32 v245, v183, 5, v181
    v_xor_b32 v247, 32, v245
    v_xor_b32 v249, 64, v245
    v_xor_b32 v251, 96, v245
    v_mul_u32_u24 v181, 20, v9
    v_add_u32 v181, v180, v181
    v_mul_u32_u24 v181, 160, v181
    v_add3_u32 v253, v181, v182, s23
    v_bfe_u32 v180, v1, 2, 2
    v_mul_u32_u24 v181, 20, v230
    v_add3_u32 v180, v180, v181, 16
    v_mul_u32_u24 v180, 160, v180
    v_add3_u32 v0, v180, v182, s23
    s_mul_i32 s85, s77, 491520
    s_mul_i32 s3, s31, 1280
    s_add_u32 s3, s3, s85
    s_add_u32 s3, s3, 11239424
    v_mul_u32_u24 v180, 10240, v230
    v_lshlrev_b32 v181, 4, v231
    v_add3_u32 v228, v180, v181, s3
    s_lshl_b32 s3, s33, 1
    s_add_u32 s3, s3, s31
    s_mul_i32 s3, s3, 3
    s_lshr_b32 s3, s3, 1
    s_sub_u32 s85, s3, 12
    s_cmp_ge_u32 s3, 12
    s_cselect_b32 s3, s85, s3
    s_lshl_b32 s34, s3, 17
    s_mul_i32 s35, s3, 40960
    v_mul_u32_u24 v180, 43, v1
    v_lshrrev_b32 v180, 9, v180
    v_mul_u32_u24 v181, 12, v180
    v_sub_u32 v181, v1, v181
    v_min_u32 v180, 2, v180
    s_mul_i32 s3, s31, 80
    s_lshr_b32 s3, s3, 5
    v_add_u32 v180, s3, v180
    v_mul_u32_u24 v180, 48, v180
    s_mul_i32 s3, s77, 12
    v_add3_u32 v180, v180, v181, s3
    v_lshlrev_b32 v180, 4, v180
    v_add_u32 v229, 393216, v180
    s_mul_i32 s85, s77, 204800
    s_mul_i32 s3, s31, 160
    s_add_u32 s3, s3, s85
    v_add_u32 v180, 0, v1
    v_mul_u32_u24 v181, 205, v180
    v_lshrrev_b32 v181, 11, v181
    v_mul_u32_u24 v181, 1120, v181
    v_lshlrev_b32 v180, 4, v1
    v_add3_u32 v232, v180, v181, s3
    v_add_u32 v180, 64, v1
    v_mul_u32_u24 v181, 205, v180
    v_lshrrev_b32 v181, 11, v181
    v_mul_u32_u24 v181, 1120, v181
    v_lshlrev_b32 v180, 4, v1
    v_add3_u32 v233, v180, v181, s3
    v_add_u32 v180, 128, v1
    v_mul_u32_u24 v181, 205, v180
    v_lshrrev_b32 v181, 11, v181
    v_mul_u32_u24 v181, 1120, v181
    v_lshlrev_b32 v180, 4, v1
    v_add3_u32 v234, v180, v181, s3
    v_add_u32 v180, 192, v1
    v_mul_u32_u24 v181, 205, v180
    v_lshrrev_b32 v181, 11, v181
    v_mul_u32_u24 v181, 1120, v181
    v_lshlrev_b32 v180, 4, v1
    v_add3_u32 v235, v180, v181, s3
    v_add_u32 v180, 256, v1
    v_mul_u32_u24 v181, 205, v180
    v_lshrrev_b32 v181, 11, v181
    v_mul_u32_u24 v181, 1120, v181
    v_lshlrev_b32 v180, 4, v180
    v_add3_u32 v236, v180, v181, s3
    v_lshrrev_b32 v180, 3, v231
    v_lshlrev_b32 v180, 7, v180
    v_and_b32 v181, 7, v231
    v_lshl_add_u32 v237, v181, 2, v180
    v_lshlrev_b32 v238, 1, v231
    s_waitcnt vmcnt(5)
    v_dot2_f32_bf16 v16, v200, s28, v16
    v_dot2_f32_bf16 v16, v201, s28, v16
    v_dot2_f32_bf16 v16, v202, s28, v16
    v_dot2_f32_bf16 v16, v203, s28, v16
    v_dot2_f32_bf16 v16, v204, s28, v16
    v_dot2_f32_bf16 v16, v205, s28, v16
    v_dot2_f32_bf16 v16, v206, s28, v16
    v_dot2_f32_bf16 v16, v207, s28, v16
    v_dot2_f32_bf16 v16, v208, s28, v16
    v_dot2_f32_bf16 v16, v209, s28, v16
    v_lshlrev_b32 v160, 16, v200
    v_and_b32 v161, 0xffff0000, v200
    v_lshlrev_b32 v162, 16, v201
    v_and_b32 v163, 0xffff0000, v201
    v_lshlrev_b32 v164, 16, v202
    v_and_b32 v165, 0xffff0000, v202
    v_lshlrev_b32 v166, 16, v203
    v_and_b32 v167, 0xffff0000, v203
    v_lshlrev_b32 v168, 16, v204
    v_and_b32 v169, 0xffff0000, v204
    v_lshlrev_b32 v170, 16, v205
    v_and_b32 v171, 0xffff0000, v205
    v_lshlrev_b32 v172, 16, v206
    v_and_b32 v173, 0xffff0000, v206
    v_lshlrev_b32 v174, 16, v207
    v_and_b32 v175, 0xffff0000, v207
    v_lshlrev_b32 v176, 16, v208
    v_and_b32 v177, 0xffff0000, v208
    v_lshlrev_b32 v178, 16, v209
    v_and_b32 v179, 0xffff0000, v209
    s_waitcnt vmcnt(2)
    v_dot2_f32_bf16 v17, v200, v210, v17
    v_dot2_f32_bf16 v17, v201, v211, v17
    v_dot2_f32_bf16 v17, v202, v212, v17
    v_dot2_f32_bf16 v17, v203, v213, v17
    v_dot2_f32_bf16 v17, v204, v214, v17
    v_dot2_f32_bf16 v17, v205, v215, v17
    v_dot2_f32_bf16 v17, v206, v216, v17
    v_dot2_f32_bf16 v17, v207, v217, v17
    v_dot2_f32_bf16 v17, v208, v218, v17
    v_dot2_f32_bf16 v17, v209, v219, v17
    v_add_f32_dpp v16, v16, v16 row_ror:8 row_mask:0xf bank_mask:0xf
    s_nop 1
    v_add_f32_dpp v17, v17, v17 row_ror:8 row_mask:0xf bank_mask:0xf
    v_add_f32_dpp v16, v16, v16 row_ror:4 row_mask:0xf bank_mask:0xf
    s_nop 0
    v_add_f32_dpp v17, v17, v17 row_ror:4 row_mask:0xf bank_mask:0xf
    v_add_f32_dpp v16, v16, v16 row_ror:2 row_mask:0xf bank_mask:0xf
    s_nop 0
    v_add_f32_dpp v17, v17, v17 row_ror:2 row_mask:0xf bank_mask:0xf
    v_add_f32_dpp v16, v16, v16 row_ror:1 row_mask:0xf bank_mask:0xf
    s_nop 0
    v_add_f32_dpp v17, v17, v17 row_ror:1 row_mask:0xf bank_mask:0xf
    v_mov_b32 v10, v16
    v_mov_b32 v11, v17
    s_nop 0
    v_permlane16_swap_b32 v10, v16
    v_permlane16_swap_b32 v11, v17
    v_add_f32 v16, v16, v10
    v_add_f32 v17, v17, v11
    v_mul_f32 v16, 0xbacccccd, v16
    v_mul_f32 v17, 0xbfb8aa3b, v17
    v_exp_f32 v31, v17
    v_pk_add_f32 v[160:161], v[160:161], v[16:17] op_sel_hi:[1,0]
    v_pk_add_f32 v[162:163], v[162:163], v[16:17] op_sel_hi:[1,0]
    v_pk_add_f32 v[164:165], v[164:165], v[16:17] op_sel_hi:[1,0]
    v_pk_add_f32 v[166:167], v[166:167], v[16:17] op_sel_hi:[1,0]
    v_pk_add_f32 v[168:169], v[168:169], v[16:17] op_sel_hi:[1,0]
    v_pk_add_f32 v[170:171], v[170:171], v[16:17] op_sel_hi:[1,0]
    v_pk_add_f32 v[172:173], v[172:173], v[16:17] op_sel_hi:[1,0]
    v_pk_add_f32 v[174:175], v[174:175], v[16:17] op_sel_hi:[1,0]
    v_pk_add_f32 v[176:177], v[176:177], v[16:17] op_sel_hi:[1,0]
    v_pk_add_f32 v[178:179], v[178:179], v[16:17] op_sel_hi:[1,0]
    v_pk_fma_f32 v[18:19], v[160:161], v[160:161], v[18:19]
    v_pk_fma_f32 v[18:19], v[162:163], v[162:163], v[18:19]
    v_pk_fma_f32 v[18:19], v[164:165], v[164:165], v[18:19]
    v_pk_fma_f32 v[18:19], v[166:167], v[166:167], v[18:19]
    v_pk_fma_f32 v[18:19], v[168:169], v[168:169], v[18:19]
    v_pk_fma_f32 v[18:19], v[170:171], v[170:171], v[18:19]
    v_pk_fma_f32 v[18:19], v[172:173], v[172:173], v[18:19]
    v_pk_fma_f32 v[18:19], v[174:175], v[174:175], v[18:19]
    v_pk_fma_f32 v[18:19], v[176:177], v[176:177], v[18:19]
    v_pk_fma_f32 v[18:19], v[178:179], v[178:179], v[18:19]
    v_add_f32 v31, 1.0, v31
    v_add_f32 v18, v18, v19
    v_rcp_f32 v31, v31
    s_nop 0
    v_add_f32_dpp v18, v18, v18 row_ror:8 row_mask:0xf bank_mask:0xf
    s_nop 1
    v_add_f32_dpp v18, v18, v18 row_ror:4 row_mask:0xf bank_mask:0xf
    s_nop 1
    v_add_f32_dpp v18, v18, v18 row_ror:2 row_mask:0xf bank_mask:0xf
    s_nop 1
    v_add_f32_dpp v18, v18, v18 row_ror:1 row_mask:0xf bank_mask:0xf
    v_mov_b32 v10, v18
    s_nop 1
    v_permlane16_swap_b32 v10, v18
    v_add_f32 v18, v18, v10
    v_mov_b32 v16, 0x3727c5ac
    v_fmac_f32 v16, 0x3acccccd, v18
    v_rsq_f32 v16, v16
    s_lshl_b32 s82, s78, 5
    s_add_u32 s82, s82, s79
    s_lshl_b32 s3, s82, 7
    s_lshl_b32 s85, s77, 3
    s_add_u32 s85, s85, s3
    s_add_u32 s85, s85, 229376
    v_lshlrev_b32 v10, 2, v9
    v_pk_mul_f32 v[160:161], v[160:161], v[16:17] op_sel_hi:[1,0]
    v_pk_mul_f32 v[162:163], v[162:163], v[16:17] op_sel_hi:[1,0]
    v_pk_mul_f32 v[164:165], v[164:165], v[16:17] op_sel_hi:[1,0]
    v_pk_mul_f32 v[166:167], v[166:167], v[16:17] op_sel_hi:[1,0]
    v_pk_mul_f32 v[168:169], v[168:169], v[16:17] op_sel_hi:[1,0]
    v_pk_mul_f32 v[170:171], v[170:171], v[16:17] op_sel_hi:[1,0]
    v_pk_mul_f32 v[172:173], v[172:173], v[16:17] op_sel_hi:[1,0]
    v_pk_mul_f32 v[174:175], v[174:175], v[16:17] op_sel_hi:[1,0]
    v_pk_mul_f32 v[176:177], v[176:177], v[16:17] op_sel_hi:[1,0]
    v_pk_mul_f32 v[178:179], v[178:179], v[16:17] op_sel_hi:[1,0]
    v_cvt_pk_bf16_f32 v200, v160, v161
    v_cvt_pk_bf16_f32 v201, v162, v163
    v_cvt_pk_bf16_f32 v202, v164, v165
    v_cvt_pk_bf16_f32 v203, v166, v167
    v_cvt_pk_bf16_f32 v204, v168, v169
    v_cvt_pk_bf16_f32 v205, v170, v171
    v_cvt_pk_bf16_f32 v206, v172, v173
    v_cvt_pk_bf16_f32 v207, v174, v175
    v_cvt_pk_bf16_f32 v208, v176, v177
    v_cvt_pk_bf16_f32 v209, v178, v179
    ds_write_b128 v12, v[200:203]
    ds_write_b128 v12, v[204:207] offset:512
    ds_write_b64 v13, v[208:209] offset:1024
    s_mov_b32 exec_lo, 1
    s_mov_b32 exec_hi, 1
    buffer_store_dword v31, v10, s[12:15], s85 offen sc1
    s_mov_b64 exec, -1
    v_bfe_u32 v12, v1, 2, 2
    v_mul_u32_u24 v12, 1280, v12
    v_lshrrev_b32 v13, 4, v1
    v_lshl_add_u32 v12, v13, 5, v12
    v_and_b32 v13, 3, v1
    v_lshl_add_u32 v12, v13, 3, v12
    s_lshl_b32 s3, s77, 7
    s_add_u32 s3, s3, 135168
    v_add_u32 v12, s3, v12
    s_lshl_b32 s82, s78, 5
    s_add_u32 s82, s82, s79
    v_lshlrev_b32 v13, 4, v1
    s_mul_i32 s8, s82, 10240
    s_lshl_b32 s3, s77, 10
    s_add_u32 s8, s8, s3
    s_add_u32 s8, s8, 8617984
    s_add_u32 s9, s8, 4096
    s_add_u32 s10, s8, 8192
    s_cmp_lt_u32 s77, 2
    s_cselect_b32 s10, s10, 0x80000000
    s_lshl_b32 s11, s82, 4
    s_add_u32 s11, s11, 4096
    s_waitcnt lgkmcnt(0)
    s_setprio 1
    s_barrier
    s_cmp_ge_u32 s79, 30
    s_cbranch_scc1 L_M_idle
    s_cmp_ge_u32 s81, 10
    s_cbranch_scc1 L_M_v
    v_lshl_add_u32 v15, v9, 15, v14
    s_lshl_b32 s3, s81, 1
    s_add_u32 s3, s3, s83
    s_lshl_b32 s3, s3, 18
    s_lshl_b32 s16, s80, 1
    s_add_u32 s16, s16, s84
    s_lshl_b32 s16, s16, 10
    s_add_u32 s16, s16, s3
    s_add_u32 s16, s16, 589824
    s_cmp_lt_u32 s81, 5
    s_cselect_b32 s72, 1051011932, 1.0
    s_mov_b32 s73, s72
    s_cbranch_scc1 L_nokone_12
    s_cmp_lg_u32 s77, 0
    s_cbranch_scc1 L_nokone_12
    s_lshl_b32 s85, s81, 15
    s_lshl_b32 s3, s80, 11
    s_add_u32 s85, s85, s3
    s_add_u32 s85, s85, 15663104
    v_lshrrev_b32 v11, 4, v1
    v_lshlrev_b32 v11, 9, v11
    v_and_b32 v10, 15, v1
    v_lshl_add_u32 v11, v10, 3, v11
    v_mov_b32 v184, 0x3f803f80
    v_mov_b32 v185, 0x3f803f80
    buffer_store_dwordx2 v[184:185], v11, s[12:15], s85 offen sc1
L_nokone_12:
    ds_read_b64_tr_b16 v[32:33], v4 offset:0
    ds_read_b64_tr_b16 v[34:35], v4 offset:1024
    ds_read_b128 v[48:51], v2 offset:0
    ds_read_b128 v[52:55], v2 offset:2048
    ds_read_b128 v[56:59], v2 offset:4096
    ds_read_b128 v[60:63], v2 offset:6144
    ds_read_b64_tr_b16 v[36:37], v5 offset:0
    ds_read_b64_tr_b16 v[38:39], v5 offset:1024
    ds_read_b64_tr_b16 v[40:41], v6 offset:0
    ds_read_b64_tr_b16 v[42:43], v6 offset:1024
    ds_read_b64_tr_b16 v[44:45], v7 offset:0
    ds_read_b64_tr_b16 v[46:47], v7 offset:1024
    s_waitcnt lgkmcnt(6)
    v_mfma_f32_16x16x32_bf16 v[64:67], v[32:35], v[48:51], 0
    ds_read_b64_tr_b16 v[200:201], v12 offset:0
    ds_read_b64_tr_b16 v[202:203], v12 offset:5120
    v_mfma_f32_16x16x32_bf16 v[68:71], v[32:35], v[52:55], 0
    ds_read_b64_tr_b16 v[204:205], v12 offset:512
    ds_read_b64_tr_b16 v[206:207], v12 offset:5632
    v_mfma_f32_16x16x32_bf16 v[72:75], v[32:35], v[56:59], 0
    ds_read_b64_tr_b16 v[208:209], v12 offset:1024
    ds_read_b64_tr_b16 v[210:211], v12 offset:6144
    v_mfma_f32_16x16x32_bf16 v[76:79], v[32:35], v[60:63], 0
    s_waitcnt lgkmcnt(10)
    v_mfma_f32_16x16x32_bf16 v[80:83], v[36:39], v[48:51], 0
    v_mfma_f32_16x16x32_bf16 v[84:87], v[36:39], v[52:55], 0
    v_mfma_f32_16x16x32_bf16 v[88:91], v[36:39], v[56:59], 0
    v_mfma_f32_16x16x32_bf16 v[92:95], v[36:39], v[60:63], 0
    ds_read_b64_tr_b16 v[128:129], v4 offset:8192
    s_waitcnt lgkmcnt(9)
    v_mfma_f32_16x16x32_bf16 v[96:99], v[40:43], v[48:51], 0
    ds_read_b64_tr_b16 v[130:131], v4 offset:9216
    v_mfma_f32_16x16x32_bf16 v[100:103], v[40:43], v[52:55], 0
    ds_read_b128 v[144:147], v3 offset:0
    v_mfma_f32_16x16x32_bf16 v[104:107], v[40:43], v[56:59], 0
    ds_read_b128 v[148:151], v3 offset:2048
    v_mfma_f32_16x16x32_bf16 v[108:111], v[40:43], v[60:63], 0
    ds_read_b128 v[152:155], v3 offset:4096
    s_waitcnt lgkmcnt(11)
    v_mfma_f32_16x16x32_bf16 v[112:115], v[44:47], v[48:51], 0
    ds_read_b128 v[156:159], v3 offset:6144
    v_mfma_f32_16x16x32_bf16 v[116:119], v[44:47], v[52:55], 0
    ds_read_b64_tr_b16 v[132:133], v5 offset:8192
    v_mfma_f32_16x16x32_bf16 v[120:123], v[44:47], v[56:59], 0
    ds_read_b64_tr_b16 v[134:135], v5 offset:9216
    v_mfma_f32_16x16x32_bf16 v[124:127], v[44:47], v[60:63], 0
    ds_read_b64_tr_b16 v[136:137], v6 offset:8192
    s_waitcnt lgkmcnt(3)
    v_mfma_f32_16x16x32_bf16 v[64:67], v[128:131], v[144:147], v[64:67]
    ds_read_b64_tr_b16 v[138:139], v6 offset:9216
    v_mfma_f32_16x16x32_bf16 v[68:71], v[128:131], v[148:151], v[68:71]
    ds_read_b64_tr_b16 v[140:141], v7 offset:8192
    v_mfma_f32_16x16x32_bf16 v[72:75], v[128:131], v[152:155], v[72:75]
    ds_read_b64_tr_b16 v[142:143], v7 offset:9216
    buffer_store_dwordx4 v[200:203], v13, s[12:15], s8 offen sc1
    v_mfma_f32_16x16x32_bf16 v[76:79], v[128:131], v[156:159], v[76:79]
    s_waitcnt lgkmcnt(4)
    v_mfma_f32_16x16x32_bf16 v[80:83], v[132:135], v[144:147], v[80:83]
    v_mfma_f32_16x16x32_bf16 v[84:87], v[132:135], v[148:151], v[84:87]
    v_mfma_f32_16x16x32_bf16 v[88:91], v[132:135], v[152:155], v[88:91]
    v_mfma_f32_16x16x32_bf16 v[92:95], v[132:135], v[156:159], v[92:95]
    s_barrier
    ds_read_b64_tr_b16 v[32:33], v4 offset:16384
    s_waitcnt lgkmcnt(3)
    v_mfma_f32_16x16x32_bf16 v[96:99], v[136:139], v[144:147], v[96:99]
    ds_read_b64_tr_b16 v[34:35], v4 offset:17408
    v_mfma_f32_16x16x32_bf16 v[100:103], v[136:139], v[148:151], v[100:103]
    ds_read_b128 v[48:51], v2 offset:16384
    v_mfma_f32_16x16x32_bf16 v[104:107], v[136:139], v[152:155], v[104:107]
    ds_read_b128 v[52:55], v2 offset:18432
    v_mfma_f32_16x16x32_bf16 v[108:111], v[136:139], v[156:159], v[108:111]
    ds_read_b128 v[56:59], v2 offset:20480
    s_waitcnt lgkmcnt(5)
    v_mfma_f32_16x16x32_bf16 v[112:115], v[140:143], v[144:147], v[112:115]
    ds_read_b128 v[60:63], v2 offset:22528
    v_mfma_f32_16x16x32_bf16 v[116:119], v[140:143], v[148:151], v[116:119]
    ds_read_b64_tr_b16 v[36:37], v5 offset:16384
    v_mfma_f32_16x16x32_bf16 v[120:123], v[140:143], v[152:155], v[120:123]
    ds_read_b64_tr_b16 v[38:39], v5 offset:17408
    v_mfma_f32_16x16x32_bf16 v[124:127], v[140:143], v[156:159], v[124:127]
    ds_read_b64_tr_b16 v[40:41], v6 offset:16384
    s_waitcnt lgkmcnt(3)
    v_mfma_f32_16x16x32_bf16 v[64:67], v[32:35], v[48:51], v[64:67]
    ds_read_b64_tr_b16 v[42:43], v6 offset:17408
    v_mfma_f32_16x16x32_bf16 v[68:71], v[32:35], v[52:55], v[68:71]
    ds_read_b64_tr_b16 v[44:45], v7 offset:16384
    v_mfma_f32_16x16x32_bf16 v[72:75], v[32:35], v[56:59], v[72:75]
    ds_read_b64_tr_b16 v[46:47], v7 offset:17408
    buffer_store_dwordx4 v[204:207], v13, s[12:15], s9 offen sc1
    v_mfma_f32_16x16x32_bf16 v[76:79], v[32:35], v[60:63], v[76:79]
    s_waitcnt lgkmcnt(4)
    v_mfma_f32_16x16x32_bf16 v[80:83], v[36:39], v[48:51], v[80:83]
    v_mfma_f32_16x16x32_bf16 v[84:87], v[36:39], v[52:55], v[84:87]
    v_mfma_f32_16x16x32_bf16 v[88:91], v[36:39], v[56:59], v[88:91]
    v_mfma_f32_16x16x32_bf16 v[92:95], v[36:39], v[60:63], v[92:95]
    ds_read_b64_tr_b16 v[128:129], v4 offset:24576
    s_waitcnt lgkmcnt(3)
    v_mfma_f32_16x16x32_bf16 v[96:99], v[40:43], v[48:51], v[96:99]
    ds_read_b64_tr_b16 v[130:131], v4 offset:25600
    v_mfma_f32_16x16x32_bf16 v[100:103], v[40:43], v[52:55], v[100:103]
    ds_read_b128 v[144:147], v3 offset:16384
    v_mfma_f32_16x16x32_bf16 v[104:107], v[40:43], v[56:59], v[104:107]
    ds_read_b128 v[148:151], v3 offset:18432
    v_mfma_f32_16x16x32_bf16 v[108:111], v[40:43], v[60:63], v[108:111]
    ds_read_b128 v[152:155], v3 offset:20480
    s_waitcnt lgkmcnt(5)
    v_mfma_f32_16x16x32_bf16 v[112:115], v[44:47], v[48:51], v[112:115]
    ds_read_b128 v[156:159], v3 offset:22528
    v_mfma_f32_16x16x32_bf16 v[116:119], v[44:47], v[52:55], v[116:119]
    ds_read_b64_tr_b16 v[132:133], v5 offset:24576
    v_mfma_f32_16x16x32_bf16 v[120:123], v[44:47], v[56:59], v[120:123]
    ds_read_b64_tr_b16 v[134:135], v5 offset:25600
    v_mfma_f32_16x16x32_bf16 v[124:127], v[44:47], v[60:63], v[124:127]
    ds_read_b64_tr_b16 v[136:137], v6 offset:24576
    s_waitcnt lgkmcnt(3)
    v_mfma_f32_16x16x32_bf16 v[64:67], v[128:131], v[144:147], v[64:67]
    ds_read_b64_tr_b16 v[138:139], v6 offset:25600
    v_mfma_f32_16x16x32_bf16 v[68:71], v[128:131], v[148:151], v[68:71]
    ds_read_b64_tr_b16 v[140:141], v7 offset:24576
    v_mfma_f32_16x16x32_bf16 v[72:75], v[128:131], v[152:155], v[72:75]
    ds_read_b64_tr_b16 v[142:143], v7 offset:25600
    buffer_store_dwordx4 v[208:211], v13, s[12:15], s10 offen sc1
    v_mfma_f32_16x16x32_bf16 v[76:79], v[128:131], v[156:159], v[76:79]
    s_waitcnt lgkmcnt(4)
    v_mfma_f32_16x16x32_bf16 v[80:83], v[132:135], v[144:147], v[80:83]
    v_mfma_f32_16x16x32_bf16 v[84:87], v[132:135], v[148:151], v[84:87]
    v_mfma_f32_16x16x32_bf16 v[88:91], v[132:135], v[152:155], v[88:91]
    v_mfma_f32_16x16x32_bf16 v[92:95], v[132:135], v[156:159], v[92:95]
    s_barrier
    ds_read_b64_tr_b16 v[32:33], v4 offset:32768
    s_waitcnt lgkmcnt(3)
    v_mfma_f32_16x16x32_bf16 v[96:99], v[136:139], v[144:147], v[96:99]
    ds_read_b64_tr_b16 v[34:35], v4 offset:33792
    v_mfma_f32_16x16x32_bf16 v[100:103], v[136:139], v[148:151], v[100:103]
    ds_read_b128 v[48:51], v2 offset:32768
    v_mfma_f32_16x16x32_bf16 v[104:107], v[136:139], v[152:155], v[104:107]
    ds_read_b128 v[52:55], v2 offset:34816
    v_mfma_f32_16x16x32_bf16 v[108:111], v[136:139], v[156:159], v[108:111]
    ds_read_b128 v[56:59], v2 offset:36864
    s_waitcnt lgkmcnt(5)
    v_mfma_f32_16x16x32_bf16 v[112:115], v[140:143], v[144:147], v[112:115]
    ds_read_b128 v[60:63], v2 offset:38912
    v_mfma_f32_16x16x32_bf16 v[116:119], v[140:143], v[148:151], v[116:119]
    ds_read_b64_tr_b16 v[36:37], v5 offset:32768
    v_mfma_f32_16x16x32_bf16 v[120:123], v[140:143], v[152:155], v[120:123]
    ds_read_b64_tr_b16 v[38:39], v5 offset:33792
    v_mfma_f32_16x16x32_bf16 v[124:127], v[140:143], v[156:159], v[124:127]
    ds_read_b64_tr_b16 v[40:41], v6 offset:32768
    s_waitcnt lgkmcnt(3)
    v_mfma_f32_16x16x32_bf16 v[64:67], v[32:35], v[48:51], v[64:67]
    ds_read_b64_tr_b16 v[42:43], v6 offset:33792
    v_mfma_f32_16x16x32_bf16 v[68:71], v[32:35], v[52:55], v[68:71]
    ds_read_b64_tr_b16 v[44:45], v7 offset:32768
    v_mfma_f32_16x16x32_bf16 v[72:75], v[32:35], v[56:59], v[72:75]
    ds_read_b64_tr_b16 v[46:47], v7 offset:33792
    v_mfma_f32_16x16x32_bf16 v[76:79], v[32:35], v[60:63], v[76:79]
    s_waitcnt lgkmcnt(4)
    v_mfma_f32_16x16x32_bf16 v[80:83], v[36:39], v[48:51], v[80:83]
    v_mfma_f32_16x16x32_bf16 v[84:87], v[36:39], v[52:55], v[84:87]
    v_mfma_f32_16x16x32_bf16 v[88:91], v[36:39], v[56:59], v[88:91]
    v_mfma_f32_16x16x32_bf16 v[92:95], v[36:39], v[60:63], v[92:95]
    ds_read_b64_tr_b16 v[128:129], v4 offset:40960
    s_waitcnt lgkmcnt(3)
    v_mfma_f32_16x16x32_bf16 v[96:99], v[40:43], v[48:51], v[96:99]
    ds_read_b64_tr_b16 v[130:131], v4 offset:41984
    v_mfma_f32_16x16x32_bf16 v[100:103], v[40:43], v[52:55], v[100:103]
    ds_read_b128 v[144:147], v3 offset:32768
    v_mfma_f32_16x16x32_bf16 v[104:107], v[40:43], v[56:59], v[104:107]
    ds_read_b128 v[148:151], v3 offset:34816
    v_mfma_f32_16x16x32_bf16 v[108:111], v[40:43], v[60:63], v[108:111]
    ds_read_b128 v[152:155], v3 offset:36864
    s_waitcnt lgkmcnt(5)
    v_mfma_f32_16x16x32_bf16 v[112:115], v[44:47], v[48:51], v[112:115]
    ds_read_b128 v[156:159], v3 offset:38912
    v_mfma_f32_16x16x32_bf16 v[116:119], v[44:47], v[52:55], v[116:119]
    ds_read_b64_tr_b16 v[132:133], v5 offset:40960
    v_mfma_f32_16x16x32_bf16 v[120:123], v[44:47], v[56:59], v[120:123]
    ds_read_b64_tr_b16 v[134:135], v5 offset:41984
    v_mfma_f32_16x16x32_bf16 v[124:127], v[44:47], v[60:63], v[124:127]
    ds_read_b64_tr_b16 v[136:137], v6 offset:40960
    s_waitcnt lgkmcnt(3)
    v_mfma_f32_16x16x32_bf16 v[64:67], v[128:131], v[144:147], v[64:67]
    ds_read_b64_tr_b16 v[138:139], v6 offset:41984
    v_mfma_f32_16x16x32_bf16 v[68:71], v[128:131], v[148:151], v[68:71]
    ds_read_b64_tr_b16 v[140:141], v7 offset:40960
    v_mfma_f32_16x16x32_bf16 v[72:75], v[128:131], v[152:155], v[72:75]
    ds_read_b64_tr_b16 v[142:143], v7 offset:41984
    v_mfma_f32_16x16x32_bf16 v[76:79], v[128:131], v[156:159], v[76:79]
    s_waitcnt lgkmcnt(4)
    v_mfma_f32_16x16x32_bf16 v[80:83], v[132:135], v[144:147], v[80:83]
    v_mfma_f32_16x16x32_bf16 v[84:87], v[132:135], v[148:151], v[84:87]
    v_mfma_f32_16x16x32_bf16 v[88:91], v[132:135], v[152:155], v[88:91]
    v_mfma_f32_16x16x32_bf16 v[92:95], v[132:135], v[156:159], v[92:95]
    s_waitcnt vmcnt(0)
    s_barrier
    ds_read_b64_tr_b16 v[32:33], v4 offset:49152
    s_waitcnt lgkmcnt(3)
    v_mfma_f32_16x16x32_bf16 v[96:99], v[136:139], v[144:147], v[96:99]
    ds_read_b64_tr_b16 v[34:35], v4 offset:50176
    v_mfma_f32_16x16x32_bf16 v[100:103], v[136:139], v[148:151], v[100:103]
    ds_read_b128 v[48:51], v2 offset:49152
    v_mfma_f32_16x16x32_bf16 v[104:107], v[136:139], v[152:155], v[104:107]
    ds_read_b128 v[52:55], v2 offset:51200
    v_mfma_f32_16x16x32_bf16 v[108:111], v[136:139], v[156:159], v[108:111]
    ds_read_b128 v[56:59], v2 offset:53248
    s_waitcnt lgkmcnt(5)
    v_mfma_f32_16x16x32_bf16 v[112:115], v[140:143], v[144:147], v[112:115]
    ds_read_b128 v[60:63], v2 offset:55296
    v_mfma_f32_16x16x32_bf16 v[116:119], v[140:143], v[148:151], v[116:119]
    ds_read_b64_tr_b16 v[36:37], v5 offset:49152
    v_mfma_f32_16x16x32_bf16 v[120:123], v[140:143], v[152:155], v[120:123]
    ds_read_b64_tr_b16 v[38:39], v5 offset:50176
    v_mfma_f32_16x16x32_bf16 v[124:127], v[140:143], v[156:159], v[124:127]
    ds_read_b64_tr_b16 v[40:41], v6 offset:49152
    s_waitcnt lgkmcnt(3)
    v_mfma_f32_16x16x32_bf16 v[64:67], v[32:35], v[48:51], v[64:67]
    ds_read_b64_tr_b16 v[42:43], v6 offset:50176
    v_mfma_f32_16x16x32_bf16 v[68:71], v[32:35], v[52:55], v[68:71]
    ds_read_b64_tr_b16 v[44:45], v7 offset:49152
    v_mfma_f32_16x16x32_bf16 v[72:75], v[32:35], v[56:59], v[72:75]
    ds_read_b64_tr_b16 v[46:47], v7 offset:50176
    s_cmp_lg_u32 s77, 0
    s_cbranch_scc1 L_nf_13
    s_mov_b64 exec, 1
    buffer_store_dwordx2 v[28:29], v13, s[12:15], s11 offen sc1
    s_mov_b64 exec, -1
L_nf_13:
    v_mfma_f32_16x16x32_bf16 v[76:79], v[32:35], v[60:63], v[76:79]
    s_waitcnt lgkmcnt(4)
    v_mfma_f32_16x16x32_bf16 v[80:83], v[36:39], v[48:51], v[80:83]
    v_mfma_f32_16x16x32_bf16 v[84:87], v[36:39], v[52:55], v[84:87]
    v_mfma_f32_16x16x32_bf16 v[88:91], v[36:39], v[56:59], v[88:91]
    v_mfma_f32_16x16x32_bf16 v[92:95], v[36:39], v[60:63], v[92:95]
    ds_read_b64_tr_b16 v[128:129], v4 offset:57344
    s_waitcnt lgkmcnt(3)
    v_mfma_f32_16x16x32_bf16 v[96:99], v[40:43], v[48:51], v[96:99]
    ds_read_b64_tr_b16 v[130:131], v4 offset:58368
    v_mfma_f32_16x16x32_bf16 v[100:103], v[40:43], v[52:55], v[100:103]
    ds_read_b128 v[144:147], v3 offset:49152
    v_mfma_f32_16x16x32_bf16 v[104:107], v[40:43], v[56:59], v[104:107]
    ds_read_b128 v[148:151], v3 offset:51200
    v_mfma_f32_16x16x32_bf16 v[108:111], v[40:43], v[60:63], v[108:111]
    ds_read_b128 v[152:155], v3 offset:53248
    s_waitcnt lgkmcnt(5)
    v_mfma_f32_16x16x32_bf16 v[112:115], v[44:47], v[48:51], v[112:115]
    ds_read_b128 v[156:159], v3 offset:55296
    v_mfma_f32_16x16x32_bf16 v[116:119], v[44:47], v[52:55], v[116:119]
    ds_read_b64_tr_b16 v[132:133], v5 offset:57344
    v_mfma_f32_16x16x32_bf16 v[120:123], v[44:47], v[56:59], v[120:123]
    ds_read_b64_tr_b16 v[134:135], v5 offset:58368
    v_mfma_f32_16x16x32_bf16 v[124:127], v[44:47], v[60:63], v[124:127]
    ds_read_b64_tr_b16 v[136:137], v6 offset:57344
    s_waitcnt lgkmcnt(3)
    v_mfma_f32_16x16x32_bf16 v[64:67], v[128:131], v[144:147], v[64:67]
    ds_read_b64_tr_b16 v[138:139], v6 offset:58368
    v_mfma_f32_16x16x32_bf16 v[68:71], v[128:131], v[148:151], v[68:71]
    ds_read_b64_tr_b16 v[140:141], v7 offset:57344
    v_mfma_f32_16x16x32_bf16 v[72:75], v[128:131], v[152:155], v[72:75]
    ds_read_b64_tr_b16 v[142:143], v7 offset:58368
    v_mfma_f32_16x16x32_bf16 v[76:79], v[128:131], v[156:159], v[76:79]
    s_waitcnt lgkmcnt(4)
    v_mfma_f32_16x16x32_bf16 v[80:83], v[132:135], v[144:147], v[80:83]
    v_mfma_f32_16x16x32_bf16 v[84:87], v[132:135], v[148:151], v[84:87]
    v_mfma_f32_16x16x32_bf16 v[88:91], v[132:135], v[152:155], v[88:91]
    v_mfma_f32_16x16x32_bf16 v[92:95], v[132:135], v[156:159], v[92:95]
    s_barrier
    ds_read_b64_tr_b16 v[32:33], v4 offset:0
    s_waitcnt lgkmcnt(3)
    v_mfma_f32_16x16x32_bf16 v[96:99], v[136:139], v[144:147], v[96:99]
    ds_read_b64_tr_b16 v[34:35], v4 offset:1024
    v_mfma_f32_16x16x32_bf16 v[100:103], v[136:139], v[148:151], v[100:103]
    ds_read_b128 v[48:51], v2 offset:0
    v_mfma_f32_16x16x32_bf16 v[104:107], v[136:139], v[152:155], v[104:107]
    ds_read_b128 v[52:55], v2 offset:2048
    v_mfma_f32_16x16x32_bf16 v[108:111], v[136:139], v[156:159], v[108:111]
    ds_read_b128 v[56:59], v2 offset:4096
    s_waitcnt lgkmcnt(5)
    v_mfma_f32_16x16x32_bf16 v[112:115], v[140:143], v[144:147], v[112:115]
    ds_read_b128 v[60:63], v2 offset:6144
    v_mfma_f32_16x16x32_bf16 v[116:119], v[140:143], v[148:151], v[116:119]
    ds_read_b64_tr_b16 v[36:37], v5 offset:0
    v_mfma_f32_16x16x32_bf16 v[120:123], v[140:143], v[152:155], v[120:123]
    ds_read_b64_tr_b16 v[38:39], v5 offset:1024
    v_mfma_f32_16x16x32_bf16 v[124:127], v[140:143], v[156:159], v[124:127]
    ds_read_b64_tr_b16 v[40:41], v6 offset:0
    s_waitcnt lgkmcnt(3)
    v_mfma_f32_16x16x32_bf16 v[64:67], v[32:35], v[48:51], v[64:67]
    ds_read_b64_tr_b16 v[42:43], v6 offset:1024
    v_mfma_f32_16x16x32_bf16 v[68:71], v[32:35], v[52:55], v[68:71]
    ds_read_b64_tr_b16 v[44:45], v7 offset:0
    v_mfma_f32_16x16x32_bf16 v[72:75], v[32:35], v[56:59], v[72:75]
    ds_read_b64_tr_b16 v[46:47], v7 offset:1024
    v_mfma_f32_16x16x32_bf16 v[76:79], v[32:35], v[60:63], v[76:79]
    s_waitcnt lgkmcnt(4)
    v_mfma_f32_16x16x32_bf16 v[80:83], v[36:39], v[48:51], v[80:83]
    v_mfma_f32_16x16x32_bf16 v[84:87], v[36:39], v[52:55], v[84:87]
    v_mfma_f32_16x16x32_bf16 v[88:91], v[36:39], v[56:59], v[88:91]
    v_mfma_f32_16x16x32_bf16 v[92:95], v[36:39], v[60:63], v[92:95]
    ds_read_b64_tr_b16 v[128:129], v4 offset:8192
    s_waitcnt lgkmcnt(3)
    v_mfma_f32_16x16x32_bf16 v[96:99], v[40:43], v[48:51], v[96:99]
    ds_read_b64_tr_b16 v[130:131], v4 offset:9216
    v_mfma_f32_16x16x32_bf16 v[100:103], v[40:43], v[52:55], v[100:103]
    ds_read_b128 v[144:147], v3 offset:0
    v_mfma_f32_16x16x32_bf16 v[104:107], v[40:43], v[56:59], v[104:107]
    ds_read_b128 v[148:151], v3 offset:2048
    v_mfma_f32_16x16x32_bf16 v[108:111], v[40:43], v[60:63], v[108:111]
    ds_read_b128 v[152:155], v3 offset:4096
    s_waitcnt lgkmcnt(5)
    v_mfma_f32_16x16x32_bf16 v[112:115], v[44:47], v[48:51], v[112:115]
    ds_read_b128 v[156:159], v3 offset:6144
    v_mfma_f32_16x16x32_bf16 v[116:119], v[44:47], v[52:55], v[116:119]
    ds_read_b64_tr_b16 v[132:133], v5 offset:8192
    v_mfma_f32_16x16x32_bf16 v[120:123], v[44:47], v[56:59], v[120:123]
    ds_read_b64_tr_b16 v[134:135], v5 offset:9216
    v_mfma_f32_16x16x32_bf16 v[124:127], v[44:47], v[60:63], v[124:127]
    ds_read_b64_tr_b16 v[136:137], v6 offset:8192
    s_waitcnt lgkmcnt(3)
    v_mfma_f32_16x16x32_bf16 v[64:67], v[128:131], v[144:147], v[64:67]
    ds_read_b64_tr_b16 v[138:139], v6 offset:9216
    v_mfma_f32_16x16x32_bf16 v[68:71], v[128:131], v[148:151], v[68:71]
    ds_read_b64_tr_b16 v[140:141], v7 offset:8192
    v_mfma_f32_16x16x32_bf16 v[72:75], v[128:131], v[152:155], v[72:75]
    ds_read_b64_tr_b16 v[142:143], v7 offset:9216
    v_mfma_f32_16x16x32_bf16 v[76:79], v[128:131], v[156:159], v[76:79]
    s_waitcnt lgkmcnt(4)
    v_mfma_f32_16x16x32_bf16 v[80:83], v[132:135], v[144:147], v[80:83]
    v_mfma_f32_16x16x32_bf16 v[84:87], v[132:135], v[148:151], v[84:87]
    v_mfma_f32_16x16x32_bf16 v[88:91], v[132:135], v[152:155], v[88:91]
    v_mfma_f32_16x16x32_bf16 v[92:95], v[132:135], v[156:159], v[92:95]
    s_barrier
    ds_read_b64_tr_b16 v[32:33], v4 offset:16384
    s_waitcnt lgkmcnt(3)
    v_mfma_f32_16x16x32_bf16 v[96:99], v[136:139], v[144:147], v[96:99]
    ds_read_b64_tr_b16 v[34:35], v4 offset:17408
    v_mfma_f32_16x16x32_bf16 v[100:103], v[136:139], v[148:151], v[100:103]
    ds_read_b128 v[48:51], v2 offset:16384
    v_mfma_f32_16x16x32_bf16 v[104:107], v[136:139], v[152:155], v[104:107]
    ds_read_b128 v[52:55], v2 offset:18432
    v_mfma_f32_16x16x32_bf16 v[108:111], v[136:139], v[156:159], v[108:111]
    ds_read_b128 v[56:59], v2 offset:20480
    s_waitcnt lgkmcnt(5)
    v_mfma_f32_16x16x32_bf16 v[112:115], v[140:143], v[144:147], v[112:115]
    ds_read_b128 v[60:63], v2 offset:22528
    v_mfma_f32_16x16x32_bf16 v[116:119], v[140:143], v[148:151], v[116:119]
    ds_read_b64_tr_b16 v[36:37], v5 offset:16384
    v_mfma_f32_16x16x32_bf16 v[120:123], v[140:143], v[152:155], v[120:123]
    ds_read_b64_tr_b16 v[38:39], v5 offset:17408
    v_mfma_f32_16x16x32_bf16 v[124:127], v[140:143], v[156:159], v[124:127]
    ds_read_b64_tr_b16 v[40:41], v6 offset:16384
    s_waitcnt lgkmcnt(3)
    v_mfma_f32_16x16x32_bf16 v[64:67], v[32:35], v[48:51], v[64:67]
    ds_read_b64_tr_b16 v[42:43], v6 offset:17408
    v_mfma_f32_16x16x32_bf16 v[68:71], v[32:35], v[52:55], v[68:71]
    ds_read_b64_tr_b16 v[44:45], v7 offset:16384
    v_mfma_f32_16x16x32_bf16 v[72:75], v[32:35], v[56:59], v[72:75]
    ds_read_b64_tr_b16 v[46:47], v7 offset:17408
    v_mfma_f32_16x16x32_bf16 v[76:79], v[32:35], v[60:63], v[76:79]
    s_waitcnt lgkmcnt(4)
    v_mfma_f32_16x16x32_bf16 v[80:83], v[36:39], v[48:51], v[80:83]
    v_mfma_f32_16x16x32_bf16 v[84:87], v[36:39], v[52:55], v[84:87]
    v_mfma_f32_16x16x32_bf16 v[88:91], v[36:39], v[56:59], v[88:91]
    v_mfma_f32_16x16x32_bf16 v[92:95], v[36:39], v[60:63], v[92:95]
    ds_read_b64_tr_b16 v[128:129], v4 offset:24576
    s_waitcnt lgkmcnt(3)
    v_mfma_f32_16x16x32_bf16 v[96:99], v[40:43], v[48:51], v[96:99]
    ds_read_b64_tr_b16 v[130:131], v4 offset:25600
    v_mfma_f32_16x16x32_bf16 v[100:103], v[40:43], v[52:55], v[100:103]
    ds_read_b128 v[144:147], v3 offset:16384
    v_mfma_f32_16x16x32_bf16 v[104:107], v[40:43], v[56:59], v[104:107]
    ds_read_b128 v[148:151], v3 offset:18432
    v_mfma_f32_16x16x32_bf16 v[108:111], v[40:43], v[60:63], v[108:111]
    ds_read_b128 v[152:155], v3 offset:20480
    s_waitcnt lgkmcnt(5)
    v_mfma_f32_16x16x32_bf16 v[112:115], v[44:47], v[48:51], v[112:115]
    ds_read_b128 v[156:159], v3 offset:22528
    v_mfma_f32_16x16x32_bf16 v[116:119], v[44:47], v[52:55], v[116:119]
    ds_read_b64_tr_b16 v[132:133], v5 offset:24576
    v_mfma_f32_16x16x32_bf16 v[120:123], v[44:47], v[56:59], v[120:123]
    ds_read_b64_tr_b16 v[134:135], v5 offset:25600
    v_mfma_f32_16x16x32_bf16 v[124:127], v[44:47], v[60:63], v[124:127]
    ds_read_b64_tr_b16 v[136:137], v6 offset:24576
    s_waitcnt lgkmcnt(3)
    v_mfma_f32_16x16x32_bf16 v[64:67], v[128:131], v[144:147], v[64:67]
    ds_read_b64_tr_b16 v[138:139], v6 offset:25600
    v_mfma_f32_16x16x32_bf16 v[68:71], v[128:131], v[148:151], v[68:71]
    ds_read_b64_tr_b16 v[140:141], v7 offset:24576
    v_mfma_f32_16x16x32_bf16 v[72:75], v[128:131], v[152:155], v[72:75]
    ds_read_b64_tr_b16 v[142:143], v7 offset:25600
    v_mfma_f32_16x16x32_bf16 v[76:79], v[128:131], v[156:159], v[76:79]
    s_waitcnt lgkmcnt(4)
    v_mfma_f32_16x16x32_bf16 v[80:83], v[132:135], v[144:147], v[80:83]
    v_mfma_f32_16x16x32_bf16 v[84:87], v[132:135], v[148:151], v[84:87]
    v_mfma_f32_16x16x32_bf16 v[88:91], v[132:135], v[152:155], v[88:91]
    v_mfma_f32_16x16x32_bf16 v[92:95], v[132:135], v[156:159], v[92:95]
    s_barrier
    ds_read_b64_tr_b16 v[32:33], v4 offset:32768
    s_waitcnt lgkmcnt(3)
    v_mfma_f32_16x16x32_bf16 v[96:99], v[136:139], v[144:147], v[96:99]
    ds_read_b64_tr_b16 v[34:35], v4 offset:33792
    v_mfma_f32_16x16x32_bf16 v[100:103], v[136:139], v[148:151], v[100:103]
    ds_read_b128 v[48:51], v2 offset:32768
    v_mfma_f32_16x16x32_bf16 v[104:107], v[136:139], v[152:155], v[104:107]
    ds_read_b128 v[52:55], v2 offset:34816
    v_mfma_f32_16x16x32_bf16 v[108:111], v[136:139], v[156:159], v[108:111]
    ds_read_b128 v[56:59], v2 offset:36864
    s_waitcnt lgkmcnt(5)
    v_mfma_f32_16x16x32_bf16 v[112:115], v[140:143], v[144:147], v[112:115]
    ds_read_b128 v[60:63], v2 offset:38912
    v_mfma_f32_16x16x32_bf16 v[116:119], v[140:143], v[148:151], v[116:119]
    ds_read_b64_tr_b16 v[36:37], v5 offset:32768
    v_mfma_f32_16x16x32_bf16 v[120:123], v[140:143], v[152:155], v[120:123]
    ds_read_b64_tr_b16 v[38:39], v5 offset:33792
    v_mfma_f32_16x16x32_bf16 v[124:127], v[140:143], v[156:159], v[124:127]
    ds_read_b64_tr_b16 v[40:41], v6 offset:32768
    s_waitcnt lgkmcnt(3)
    v_mfma_f32_16x16x32_bf16 v[64:67], v[32:35], v[48:51], v[64:67]
    ds_read_b64_tr_b16 v[42:43], v6 offset:33792
    v_mfma_f32_16x16x32_bf16 v[68:71], v[32:35], v[52:55], v[68:71]
    ds_read_b64_tr_b16 v[44:45], v7 offset:32768
    v_mfma_f32_16x16x32_bf16 v[72:75], v[32:35], v[56:59], v[72:75]
    ds_read_b64_tr_b16 v[46:47], v7 offset:33792
    v_mfma_f32_16x16x32_bf16 v[76:79], v[32:35], v[60:63], v[76:79]
    s_waitcnt lgkmcnt(4)
    v_mfma_f32_16x16x32_bf16 v[80:83], v[36:39], v[48:51], v[80:83]
    v_mfma_f32_16x16x32_bf16 v[84:87], v[36:39], v[52:55], v[84:87]
    v_mfma_f32_16x16x32_bf16 v[88:91], v[36:39], v[56:59], v[88:91]
    v_mfma_f32_16x16x32_bf16 v[92:95], v[36:39], v[60:63], v[92:95]
    ds_read_b64_tr_b16 v[128:129], v4 offset:40960
    s_waitcnt lgkmcnt(3)
    v_mfma_f32_16x16x32_bf16 v[96:99], v[40:43], v[48:51], v[96:99]
    ds_read_b64_tr_b16 v[130:131], v4 offset:41984
    v_mfma_f32_16x16x32_bf16 v[100:103], v[40:43], v[52:55], v[100:103]
    ds_read_b128 v[144:147], v3 offset:32768
    v_mfma_f32_16x16x32_bf16 v[104:107], v[40:43], v[56:59], v[104:107]
    ds_read_b128 v[148:151], v3 offset:34816
    v_mfma_f32_16x16x32_bf16 v[108:111], v[40:43], v[60:63], v[108:111]
    ds_read_b128 v[152:155], v3 offset:36864
    s_waitcnt lgkmcnt(5)
    v_mfma_f32_16x16x32_bf16 v[112:115], v[44:47], v[48:51], v[112:115]
    ds_read_b128 v[156:159], v3 offset:38912
    v_mfma_f32_16x16x32_bf16 v[116:119], v[44:47], v[52:55], v[116:119]
    ds_read_b64_tr_b16 v[132:133], v5 offset:40960
    v_mfma_f32_16x16x32_bf16 v[120:123], v[44:47], v[56:59], v[120:123]
    ds_read_b64_tr_b16 v[134:135], v5 offset:41984
    v_mfma_f32_16x16x32_bf16 v[124:127], v[44:47], v[60:63], v[124:127]
    ds_read_b64_tr_b16 v[136:137], v6 offset:40960
    s_waitcnt lgkmcnt(3)
    v_mfma_f32_16x16x32_bf16 v[64:67], v[128:131], v[144:147], v[64:67]
    ds_read_b64_tr_b16 v[138:139], v6 offset:41984
    v_mfma_f32_16x16x32_bf16 v[68:71], v[128:131], v[148:151], v[68:71]
    ds_read_b64_tr_b16 v[140:141], v7 offset:40960
    v_mfma_f32_16x16x32_bf16 v[72:75], v[128:131], v[152:155], v[72:75]
    ds_read_b64_tr_b16 v[142:143], v7 offset:41984
    v_mfma_f32_16x16x32_bf16 v[76:79], v[128:131], v[156:159], v[76:79]
    s_waitcnt lgkmcnt(4)
    v_mfma_f32_16x16x32_bf16 v[80:83], v[132:135], v[144:147], v[80:83]
    v_mfma_f32_16x16x32_bf16 v[84:87], v[132:135], v[148:151], v[84:87]
    v_mfma_f32_16x16x32_bf16 v[88:91], v[132:135], v[152:155], v[88:91]
    v_mfma_f32_16x16x32_bf16 v[92:95], v[132:135], v[156:159], v[92:95]
    s_barrier
    ds_read_b64_tr_b16 v[32:33], v4 offset:49152
    s_waitcnt lgkmcnt(3)
    v_mfma_f32_16x16x32_bf16 v[96:99], v[136:139], v[144:147], v[96:99]
    ds_read_b64_tr_b16 v[34:35], v4 offset:50176
    v_mfma_f32_16x16x32_bf16 v[100:103], v[136:139], v[148:151], v[100:103]
    ds_read_b128 v[48:51], v2 offset:49152
    v_mfma_f32_16x16x32_bf16 v[104:107], v[136:139], v[152:155], v[104:107]
    ds_read_b128 v[52:55], v2 offset:51200
    v_mfma_f32_16x16x32_bf16 v[108:111], v[136:139], v[156:159], v[108:111]
    ds_read_b128 v[56:59], v2 offset:53248
    s_waitcnt lgkmcnt(5)
    v_mfma_f32_16x16x32_bf16 v[112:115], v[140:143], v[144:147], v[112:115]
    ds_read_b128 v[60:63], v2 offset:55296
    v_mfma_f32_16x16x32_bf16 v[116:119], v[140:143], v[148:151], v[116:119]
    ds_read_b64_tr_b16 v[36:37], v5 offset:49152
    v_mfma_f32_16x16x32_bf16 v[120:123], v[140:143], v[152:155], v[120:123]
    ds_read_b64_tr_b16 v[38:39], v5 offset:50176
    v_mfma_f32_16x16x32_bf16 v[124:127], v[140:143], v[156:159], v[124:127]
    ds_read_b64_tr_b16 v[40:41], v6 offset:49152
    s_waitcnt lgkmcnt(3)
    v_mfma_f32_16x16x32_bf16 v[64:67], v[32:35], v[48:51], v[64:67]
    ds_read_b64_tr_b16 v[42:43], v6 offset:50176
    v_mfma_f32_16x16x32_bf16 v[68:71], v[32:35], v[52:55], v[68:71]
    ds_read_b64_tr_b16 v[44:45], v7 offset:49152
    v_mfma_f32_16x16x32_bf16 v[72:75], v[32:35], v[56:59], v[72:75]
    ds_read_b64_tr_b16 v[46:47], v7 offset:50176
    v_mfma_f32_16x16x32_bf16 v[76:79], v[32:35], v[60:63], v[76:79]
    s_waitcnt lgkmcnt(4)
    v_mfma_f32_16x16x32_bf16 v[80:83], v[36:39], v[48:51], v[80:83]
    v_mfma_f32_16x16x32_bf16 v[84:87], v[36:39], v[52:55], v[84:87]
    v_mfma_f32_16x16x32_bf16 v[88:91], v[36:39], v[56:59], v[88:91]
    v_mfma_f32_16x16x32_bf16 v[92:95], v[36:39], v[60:63], v[92:95]
    ds_read_b64_tr_b16 v[128:129], v4 offset:57344
    s_waitcnt lgkmcnt(3)
    v_mfma_f32_16x16x32_bf16 v[96:99], v[40:43], v[48:51], v[96:99]
    ds_read_b64_tr_b16 v[130:131], v4 offset:58368
    v_mfma_f32_16x16x32_bf16 v[100:103], v[40:43], v[52:55], v[100:103]
    ds_read_b128 v[144:147], v3 offset:49152
    v_mfma_f32_16x16x32_bf16 v[104:107], v[40:43], v[56:59], v[104:107]
    ds_read_b128 v[148:151], v3 offset:51200
    v_mfma_f32_16x16x32_bf16 v[108:111], v[40:43], v[60:63], v[108:111]
    ds_read_b128 v[152:155], v3 offset:53248
    s_waitcnt lgkmcnt(5)
    v_mfma_f32_16x16x32_bf16 v[112:115], v[44:47], v[48:51], v[112:115]
    ds_read_b128 v[156:159], v3 offset:55296
    v_mfma_f32_16x16x32_bf16 v[116:119], v[44:47], v[52:55], v[116:119]
    ds_read_b64_tr_b16 v[132:133], v5 offset:57344
    v_mfma_f32_16x16x32_bf16 v[120:123], v[44:47], v[56:59], v[120:123]
    ds_read_b64_tr_b16 v[134:135], v5 offset:58368
    v_mfma_f32_16x16x32_bf16 v[124:127], v[44:47], v[60:63], v[124:127]
    ds_read_b64_tr_b16 v[136:137], v6 offset:57344
    s_waitcnt lgkmcnt(3)
    v_mfma_f32_16x16x32_bf16 v[64:67], v[128:131], v[144:147], v[64:67]
    ds_read_b64_tr_b16 v[138:139], v6 offset:58368
    v_mfma_f32_16x16x32_bf16 v[68:71], v[128:131], v[148:151], v[68:71]
    ds_read_b64_tr_b16 v[140:141], v7 offset:57344
    v_mfma_f32_16x16x32_bf16 v[72:75], v[128:131], v[152:155], v[72:75]
    ds_read_b64_tr_b16 v[142:143], v7 offset:58368
    v_mfma_f32_16x16x32_bf16 v[76:79], v[128:131], v[156:159], v[76:79]
    s_waitcnt lgkmcnt(4)
    v_mfma_f32_16x16x32_bf16 v[80:83], v[132:135], v[144:147], v[80:83]
    v_mfma_f32_16x16x32_bf16 v[84:87], v[132:135], v[148:151], v[84:87]
    v_mfma_f32_16x16x32_bf16 v[88:91], v[132:135], v[152:155], v[88:91]
    v_mfma_f32_16x16x32_bf16 v[92:95], v[132:135], v[156:159], v[92:95]
    s_barrier
    ds_read_b64_tr_b16 v[32:33], v4 offset:0
    s_waitcnt lgkmcnt(3)
    v_mfma_f32_16x16x32_bf16 v[96:99], v[136:139], v[144:147], v[96:99]
    ds_read_b64_tr_b16 v[34:35], v4 offset:1024
    v_mfma_f32_16x16x32_bf16 v[100:103], v[136:139], v[148:151], v[100:103]
    ds_read_b128 v[48:51], v2 offset:0
    v_mfma_f32_16x16x32_bf16 v[104:107], v[136:139], v[152:155], v[104:107]
    ds_read_b128 v[52:55], v2 offset:2048
    v_mfma_f32_16x16x32_bf16 v[108:111], v[136:139], v[156:159], v[108:111]
    ds_read_b128 v[56:59], v2 offset:4096
    s_waitcnt lgkmcnt(5)
    v_mfma_f32_16x16x32_bf16 v[112:115], v[140:143], v[144:147], v[112:115]
    ds_read_b128 v[60:63], v2 offset:6144
    v_mfma_f32_16x16x32_bf16 v[116:119], v[140:143], v[148:151], v[116:119]
    ds_read_b64_tr_b16 v[36:37], v5 offset:0
    v_mfma_f32_16x16x32_bf16 v[120:123], v[140:143], v[152:155], v[120:123]
    ds_read_b64_tr_b16 v[38:39], v5 offset:1024
    v_mfma_f32_16x16x32_bf16 v[124:127], v[140:143], v[156:159], v[124:127]
    ds_read_b64_tr_b16 v[40:41], v6 offset:0
    s_waitcnt lgkmcnt(3)
    v_mfma_f32_16x16x32_bf16 v[64:67], v[32:35], v[48:51], v[64:67]
    ds_read_b64_tr_b16 v[42:43], v6 offset:1024
    v_mfma_f32_16x16x32_bf16 v[68:71], v[32:35], v[52:55], v[68:71]
    ds_read_b64_tr_b16 v[44:45], v7 offset:0
    v_mfma_f32_16x16x32_bf16 v[72:75], v[32:35], v[56:59], v[72:75]
    ds_read_b64_tr_b16 v[46:47], v7 offset:1024
    v_mfma_f32_16x16x32_bf16 v[76:79], v[32:35], v[60:63], v[76:79]
    s_waitcnt lgkmcnt(4)
    v_mfma_f32_16x16x32_bf16 v[80:83], v[36:39], v[48:51], v[80:83]
    v_mfma_f32_16x16x32_bf16 v[84:87], v[36:39], v[52:55], v[84:87]
    v_mfma_f32_16x16x32_bf16 v[88:91], v[36:39], v[56:59], v[88:91]
    v_mfma_f32_16x16x32_bf16 v[92:95], v[36:39], v[60:63], v[92:95]
    ds_read_b64_tr_b16 v[128:129], v4 offset:8192
    s_waitcnt lgkmcnt(3)
    v_mfma_f32_16x16x32_bf16 v[96:99], v[40:43], v[48:51], v[96:99]
    ds_read_b64_tr_b16 v[130:131], v4 offset:9216
    v_mfma_f32_16x16x32_bf16 v[100:103], v[40:43], v[52:55], v[100:103]
    ds_read_b128 v[144:147], v3 offset:0
    v_mfma_f32_16x16x32_bf16 v[104:107], v[40:43], v[56:59], v[104:107]
    ds_read_b128 v[148:151], v3 offset:2048
    v_mfma_f32_16x16x32_bf16 v[108:111], v[40:43], v[60:63], v[108:111]
    ds_read_b128 v[152:155], v3 offset:4096
    s_waitcnt lgkmcnt(5)
    v_mfma_f32_16x16x32_bf16 v[112:115], v[44:47], v[48:51], v[112:115]
    ds_read_b128 v[156:159], v3 offset:6144
    v_mfma_f32_16x16x32_bf16 v[116:119], v[44:47], v[52:55], v[116:119]
    ds_read_b64_tr_b16 v[132:133], v5 offset:8192
    v_mfma_f32_16x16x32_bf16 v[120:123], v[44:47], v[56:59], v[120:123]
    ds_read_b64_tr_b16 v[134:135], v5 offset:9216
    v_mfma_f32_16x16x32_bf16 v[124:127], v[44:47], v[60:63], v[124:127]
    ds_read_b64_tr_b16 v[136:137], v6 offset:8192
    s_waitcnt lgkmcnt(3)
    v_mfma_f32_16x16x32_bf16 v[64:67], v[128:131], v[144:147], v[64:67]
    ds_read_b64_tr_b16 v[138:139], v6 offset:9216
    v_mfma_f32_16x16x32_bf16 v[68:71], v[128:131], v[148:151], v[68:71]
    ds_read_b64_tr_b16 v[140:141], v7 offset:8192
    v_mfma_f32_16x16x32_bf16 v[72:75], v[128:131], v[152:155], v[72:75]
    ds_read_b64_tr_b16 v[142:143], v7 offset:9216
    v_mfma_f32_16x16x32_bf16 v[76:79], v[128:131], v[156:159], v[76:79]
    s_waitcnt lgkmcnt(4)
    v_mfma_f32_16x16x32_bf16 v[80:83], v[132:135], v[144:147], v[80:83]
    v_mfma_f32_16x16x32_bf16 v[84:87], v[132:135], v[148:151], v[84:87]
    v_mfma_f32_16x16x32_bf16 v[88:91], v[132:135], v[152:155], v[88:91]
    v_mfma_f32_16x16x32_bf16 v[92:95], v[132:135], v[156:159], v[92:95]
    s_barrier
    ds_read_b64_tr_b16 v[32:33], v4 offset:16384
    s_waitcnt lgkmcnt(3)
    v_mfma_f32_16x16x32_bf16 v[96:99], v[136:139], v[144:147], v[96:99]
    ds_read_b64_tr_b16 v[34:35], v4 offset:17408
    v_mfma_f32_16x16x32_bf16 v[100:103], v[136:139], v[148:151], v[100:103]
    ds_read_b128 v[48:51], v2 offset:16384
    v_mfma_f32_16x16x32_bf16 v[104:107], v[136:139], v[152:155], v[104:107]
    ds_read_b128 v[52:55], v2 offset:18432
    v_mfma_f32_16x16x32_bf16 v[108:111], v[136:139], v[156:159], v[108:111]
    ds_read_b128 v[56:59], v2 offset:20480
    s_waitcnt lgkmcnt(5)
    v_mfma_f32_16x16x32_bf16 v[112:115], v[140:143], v[144:147], v[112:115]
    ds_read_b128 v[60:63], v2 offset:22528
    v_mfma_f32_16x16x32_bf16 v[116:119], v[140:143], v[148:151], v[116:119]
    ds_read_b64_tr_b16 v[36:37], v5 offset:16384
    v_mfma_f32_16x16x32_bf16 v[120:123], v[140:143], v[152:155], v[120:123]
    ds_read_b64_tr_b16 v[38:39], v5 offset:17408
    v_mfma_f32_16x16x32_bf16 v[124:127], v[140:143], v[156:159], v[124:127]
    ds_read_b64_tr_b16 v[40:41], v6 offset:16384
    s_waitcnt lgkmcnt(3)
    v_mfma_f32_16x16x32_bf16 v[64:67], v[32:35], v[48:51], v[64:67]
    ds_read_b64_tr_b16 v[42:43], v6 offset:17408
    v_mfma_f32_16x16x32_bf16 v[68:71], v[32:35], v[52:55], v[68:71]
    ds_read_b64_tr_b16 v[44:45], v7 offset:16384
    v_mfma_f32_16x16x32_bf16 v[72:75], v[32:35], v[56:59], v[72:75]
    ds_read_b64_tr_b16 v[46:47], v7 offset:17408
    v_mfma_f32_16x16x32_bf16 v[76:79], v[32:35], v[60:63], v[76:79]
    s_waitcnt lgkmcnt(4)
    v_mfma_f32_16x16x32_bf16 v[80:83], v[36:39], v[48:51], v[80:83]
    v_mfma_f32_16x16x32_bf16 v[84:87], v[36:39], v[52:55], v[84:87]
    v_mfma_f32_16x16x32_bf16 v[88:91], v[36:39], v[56:59], v[88:91]
    v_mfma_f32_16x16x32_bf16 v[92:95], v[36:39], v[60:63], v[92:95]
    ds_read_b64_tr_b16 v[128:129], v4 offset:24576
    s_waitcnt lgkmcnt(3)
    v_mfma_f32_16x16x32_bf16 v[96:99], v[40:43], v[48:51], v[96:99]
    ds_read_b64_tr_b16 v[130:131], v4 offset:25600
    v_mfma_f32_16x16x32_bf16 v[100:103], v[40:43], v[52:55], v[100:103]
    ds_read_b128 v[144:147], v3 offset:16384
    v_mfma_f32_16x16x32_bf16 v[104:107], v[40:43], v[56:59], v[104:107]
    ds_read_b128 v[148:151], v3 offset:18432
    v_mfma_f32_16x16x32_bf16 v[108:111], v[40:43], v[60:63], v[108:111]
    ds_read_b128 v[152:155], v3 offset:20480
    s_waitcnt lgkmcnt(5)
    v_mfma_f32_16x16x32_bf16 v[112:115], v[44:47], v[48:51], v[112:115]
    ds_read_b128 v[156:159], v3 offset:22528
    v_mfma_f32_16x16x32_bf16 v[116:119], v[44:47], v[52:55], v[116:119]
    ds_read_b64_tr_b16 v[132:133], v5 offset:24576
    v_mfma_f32_16x16x32_bf16 v[120:123], v[44:47], v[56:59], v[120:123]
    ds_read_b64_tr_b16 v[134:135], v5 offset:25600
    v_mfma_f32_16x16x32_bf16 v[124:127], v[44:47], v[60:63], v[124:127]
    ds_read_b64_tr_b16 v[136:137], v6 offset:24576
    s_waitcnt lgkmcnt(3)
    v_mfma_f32_16x16x32_bf16 v[64:67], v[128:131], v[144:147], v[64:67]
    ds_read_b64_tr_b16 v[138:139], v6 offset:25600
    v_mfma_f32_16x16x32_bf16 v[68:71], v[128:131], v[148:151], v[68:71]
    ds_read_b64_tr_b16 v[140:141], v7 offset:24576
    v_mfma_f32_16x16x32_bf16 v[72:75], v[128:131], v[152:155], v[72:75]
    ds_read_b64_tr_b16 v[142:143], v7 offset:25600
    v_mfma_f32_16x16x32_bf16 v[76:79], v[128:131], v[156:159], v[76:79]
    s_waitcnt lgkmcnt(4)
    v_mfma_f32_16x16x32_bf16 v[80:83], v[132:135], v[144:147], v[80:83]
    v_mfma_f32_16x16x32_bf16 v[84:87], v[132:135], v[148:151], v[84:87]
    v_mfma_f32_16x16x32_bf16 v[88:91], v[132:135], v[152:155], v[88:91]
    v_mfma_f32_16x16x32_bf16 v[92:95], v[132:135], v[156:159], v[92:95]
    s_waitcnt lgkmcnt(2)
    v_mfma_f32_16x16x32_bf16 v[96:99], v[136:139], v[144:147], v[96:99]
    v_mfma_f32_16x16x32_bf16 v[100:103], v[136:139], v[148:151], v[100:103]
    v_mfma_f32_16x16x32_bf16 v[104:107], v[136:139], v[152:155], v[104:107]
    v_mfma_f32_16x16x32_bf16 v[108:111], v[136:139], v[156:159], v[108:111]
    s_waitcnt lgkmcnt(0)
    v_mfma_f32_16x16x32_bf16 v[112:115], v[140:143], v[144:147], v[112:115]
    v_mfma_f32_16x16x32_bf16 v[116:119], v[140:143], v[148:151], v[116:119]
    v_mfma_f32_16x16x32_bf16 v[120:123], v[140:143], v[152:155], v[120:123]
    v_mfma_f32_16x16x32_bf16 v[124:127], v[140:143], v[156:159], v[124:127]
    s_cmp_lt_u32 s81, 5
    s_cbranch_scc1 L_M_q
    v_cvt_pk_bf16_f32 v64, v64, v65
    v_cvt_pk_bf16_f32 v65, v66, v67
    v_cvt_pk_bf16_f32 v66, v68, v69
    v_cvt_pk_bf16_f32 v67, v70, v71
    s_nop 0
    v_permlane16_swap_b32 v64, v66
    v_permlane16_swap_b32 v65, v67
    v_cvt_pk_bf16_f32 v72, v72, v73
    v_cvt_pk_bf16_f32 v73, v74, v75
    v_cvt_pk_bf16_f32 v74, v76, v77
    v_cvt_pk_bf16_f32 v75, v78, v79
    buffer_store_dwordx4 v[64:67], v15, s[12:15], s16 offen offset:0 sc1
    v_permlane16_swap_b32 v72, v74
    v_permlane16_swap_b32 v73, v75
    v_cvt_pk_bf16_f32 v80, v80, v81
    v_cvt_pk_bf16_f32 v81, v82, v83
    v_cvt_pk_bf16_f32 v82, v84, v85
    v_cvt_pk_bf16_f32 v83, v86, v87
    buffer_store_dwordx4 v[72:75], v15, s[12:15], s16 offen offset:512 sc1
    s_add_u32 s16, s16, 65536
    v_permlane16_swap_b32 v80, v82
    v_permlane16_swap_b32 v81, v83
    v_cvt_pk_bf16_f32 v88, v88, v89
    v_cvt_pk_bf16_f32 v89, v90, v91
    v_cvt_pk_bf16_f32 v90, v92, v93
    v_cvt_pk_bf16_f32 v91, v94, v95
    buffer_store_dwordx4 v[80:83], v15, s[12:15], s16 offen offset:0 sc1
    v_permlane16_swap_b32 v88, v90
    v_permlane16_swap_b32 v89, v91
    v_cvt_pk_bf16_f32 v96, v96, v97
    v_cvt_pk_bf16_f32 v97, v98, v99
    v_cvt_pk_bf16_f32 v98, v100, v101
    v_cvt_pk_bf16_f32 v99, v102, v103
    buffer_store_dwordx4 v[88:91], v15, s[12:15], s16 offen offset:512 sc1
    s_add_u32 s16, s16, 65536
    v_permlane16_swap_b32 v96, v98
    v_permlane16_swap_b32 v97, v99
    v_cvt_pk_bf16_f32 v104, v104, v105
    v_cvt_pk_bf16_f32 v105, v106, v107
    v_cvt_pk_bf16_f32 v106, v108, v109
    v_cvt_pk_bf16_f32 v107, v110, v111
    buffer_store_dwordx4 v[96:99], v15, s[12:15], s16 offen offset:0 sc1
    v_permlane16_swap_b32 v104, v106
    v_permlane16_swap_b32 v105, v107
    v_cvt_pk_bf16_f32 v112, v112, v113
    v_cvt_pk_bf16_f32 v113, v114, v115
    v_cvt_pk_bf16_f32 v114, v116, v117
    v_cvt_pk_bf16_f32 v115, v118, v119
    s_waitcnt vmcnt(4)
    buffer_store_dwordx4 v[104:107], v15, s[12:15], s16 offen offset:512 sc1
    s_add_u32 s16, s16, 65536
    v_permlane16_swap_b32 v112, v114
    v_permlane16_swap_b32 v113, v115
    v_cvt_pk_bf16_f32 v120, v120, v121
    v_cvt_pk_bf16_f32 v121, v122, v123
    v_cvt_pk_bf16_f32 v122, v124, v125
    v_cvt_pk_bf16_f32 v123, v126, v127
    s_waitcnt vmcnt(4)
    buffer_store_dwordx4 v[112:115], v15, s[12:15], s16 offen offset:0 sc1
    v_permlane16_swap_b32 v120, v122
    v_permlane16_swap_b32 v121, v123
    s_waitcnt vmcnt(4)
    buffer_store_dwordx4 v[120:123], v15, s[12:15], s16 offen offset:512 sc1
    s_add_u32 s16, s16, 65536
    s_branch L_M_g1
L_M_q:
    v_pk_mul_f32 v[64:65], v[64:65], s[72:73]
    v_pk_mul_f32 v[66:67], v[66:67], s[72:73]
    v_pk_mul_f32 v[68:69], v[68:69], s[72:73]
    v_pk_mul_f32 v[70:71], v[70:71], s[72:73]
    v_cvt_pk_bf16_f32 v64, v64, v65
    v_cvt_pk_bf16_f32 v65, v66, v67
    v_cvt_pk_bf16_f32 v66, v68, v69
    v_cvt_pk_bf16_f32 v67, v70, v71
    s_nop 0
    v_permlane16_swap_b32 v64, v66
    v_permlane16_swap_b32 v65, v67
    v_pk_mul_f32 v[72:73], v[72:73], s[72:73]
    v_pk_mul_f32 v[74:75], v[74:75], s[72:73]
    v_pk_mul_f32 v[76:77], v[76:77], s[72:73]
    v_pk_mul_f32 v[78:79], v[78:79], s[72:73]
    v_cvt_pk_bf16_f32 v72, v72, v73
    v_cvt_pk_bf16_f32 v73, v74, v75
    v_cvt_pk_bf16_f32 v74, v76, v77
    v_cvt_pk_bf16_f32 v75, v78, v79
    buffer_store_dwordx4 v[64:67], v15, s[12:15], s16 offen offset:0 sc1
    v_permlane16_swap_b32 v72, v74
    v_permlane16_swap_b32 v73, v75
    v_pk_mul_f32 v[80:81], v[80:81], s[72:73]
    v_pk_mul_f32 v[82:83], v[82:83], s[72:73]
    v_pk_mul_f32 v[84:85], v[84:85], s[72:73]
    v_pk_mul_f32 v[86:87], v[86:87], s[72:73]
    v_cvt_pk_bf16_f32 v80, v80, v81
    v_cvt_pk_bf16_f32 v81, v82, v83
    v_cvt_pk_bf16_f32 v82, v84, v85
    v_cvt_pk_bf16_f32 v83, v86, v87
    buffer_store_dwordx4 v[72:75], v15, s[12:15], s16 offen offset:512 sc1
    s_add_u32 s16, s16, 65536
    v_permlane16_swap_b32 v80, v82
    v_permlane16_swap_b32 v81, v83
    v_pk_mul_f32 v[88:89], v[88:89], s[72:73]
    v_pk_mul_f32 v[90:91], v[90:91], s[72:73]
    v_pk_mul_f32 v[92:93], v[92:93], s[72:73]
    v_pk_mul_f32 v[94:95], v[94:95], s[72:73]
    v_cvt_pk_bf16_f32 v88, v88, v89
    v_cvt_pk_bf16_f32 v89, v90, v91
    v_cvt_pk_bf16_f32 v90, v92, v93
    v_cvt_pk_bf16_f32 v91, v94, v95
    buffer_store_dwordx4 v[80:83], v15, s[12:15], s16 offen offset:0 sc1
    v_permlane16_swap_b32 v88, v90
    v_permlane16_swap_b32 v89, v91
    v_pk_mul_f32 v[96:97], v[96:97], s[72:73]
    v_pk_mul_f32 v[98:99], v[98:99], s[72:73]
    v_pk_mul_f32 v[100:101], v[100:101], s[72:73]
    v_pk_mul_f32 v[102:103], v[102:103], s[72:73]
    v_cvt_pk_bf16_f32 v96, v96, v97
    v_cvt_pk_bf16_f32 v97, v98, v99
    v_cvt_pk_bf16_f32 v98, v100, v101
    v_cvt_pk_bf16_f32 v99, v102, v103
    buffer_store_dwordx4 v[88:91], v15, s[12:15], s16 offen offset:512 sc1
    s_add_u32 s16, s16, 65536
    v_permlane16_swap_b32 v96, v98
    v_permlane16_swap_b32 v97, v99
    v_pk_mul_f32 v[104:105], v[104:105], s[72:73]
    v_pk_mul_f32 v[106:107], v[106:107], s[72:73]
    v_pk_mul_f32 v[108:109], v[108:109], s[72:73]
    v_pk_mul_f32 v[110:111], v[110:111], s[72:73]
    v_cvt_pk_bf16_f32 v104, v104, v105
    v_cvt_pk_bf16_f32 v105, v106, v107
    v_cvt_pk_bf16_f32 v106, v108, v109
    v_cvt_pk_bf16_f32 v107, v110, v111
    buffer_store_dwordx4 v[96:99], v15, s[12:15], s16 offen offset:0 sc1
    v_permlane16_swap_b32 v104, v106
    v_permlane16_swap_b32 v105, v107
    v_pk_mul_f32 v[112:113], v[112:113], s[72:73]
    v_pk_mul_f32 v[114:115], v[114:115], s[72:73]
    v_pk_mul_f32 v[116:117], v[116:117], s[72:73]
    v_pk_mul_f32 v[118:119], v[118:119], s[72:73]
    v_cvt_pk_bf16_f32 v112, v112, v113
    v_cvt_pk_bf16_f32 v113, v114, v115
    v_cvt_pk_bf16_f32 v114, v116, v117
    v_cvt_pk_bf16_f32 v115, v118, v119
    s_waitcnt vmcnt(4)
    buffer_store_dwordx4 v[104:107], v15, s[12:15], s16 offen offset:512 sc1
    s_add_u32 s16, s16, 65536
    v_permlane16_swap_b32 v112, v114
    v_permlane16_swap_b32 v113, v115
    v_pk_mul_f32 v[120:121], v[120:121], s[72:73]
    v_pk_mul_f32 v[122:123], v[122:123], s[72:73]
    v_pk_mul_f32 v[124:125], v[124:125], s[72:73]
    v_pk_mul_f32 v[126:127], v[126:127], s[72:73]
    v_cvt_pk_bf16_f32 v120, v120, v121
    v_cvt_pk_bf16_f32 v121, v122, v123
    v_cvt_pk_bf16_f32 v122, v124, v125
    v_cvt_pk_bf16_f32 v123, v126, v127
    s_waitcnt vmcnt(4)
    buffer_store_dwordx4 v[112:115], v15, s[12:15], s16 offen offset:0 sc1
    v_permlane16_swap_b32 v120, v122
    v_permlane16_swap_b32 v121, v123
    s_waitcnt vmcnt(4)
    buffer_store_dwordx4 v[120:123], v15, s[12:15], s16 offen offset:512 sc1
    s_add_u32 s16, s16, 65536
    s_branch L_M_g1
L_M_v:
    v_mul_u32_u24 v15, 4352, v21
    s_lshl_b32 s3, s83, 10
    v_add3_u32 v15, v15, v20, s3
    s_lshl_b32 s16, s81, 5
    s_lshl_b32 s3, s80, 1
    s_add_u32 s16, s16, s3
    s_add_u32 s16, s16, s84
    s_mul_i32 s16, s16, 17408
    s_add_u32 s16, s16, 262144
    s_add_u32 s17, s16, 8704
    s_cmp_lg_u32 s83, 0
    s_cbranch_scc1 L_noones_14
    v_lshrrev_b32 v11, 3, v1
    v_mul_u32_u24 v11, 2176, v11
    v_and_b32 v10, 7, v1
    v_lshl_add_u32 v11, v10, 4, v11
    v_mov_b32 v184, 0x3f803f80
    v_mov_b32 v185, 0x3f803f80
    v_mov_b32 v186, 0x3f803f80
    v_mov_b32 v187, 0x3f803f80
    buffer_store_dwordx4 v[184:187], v11, s[12:15], s16 offen offset:2048 sc1
L_noones_14:
    ds_read_b64_tr_b16 v[32:33], v4 offset:0
    ds_read_b64_tr_b16 v[34:35], v4 offset:1024
    ds_read_b128 v[48:51], v2 offset:0
    ds_read_b128 v[52:55], v2 offset:2048
    ds_read_b128 v[56:59], v2 offset:4096
    ds_read_b128 v[60:63], v2 offset:6144
    ds_read_b64_tr_b16 v[36:37], v5 offset:0
    ds_read_b64_tr_b16 v[38:39], v5 offset:1024
    ds_read_b64_tr_b16 v[40:41], v6 offset:0
    ds_read_b64_tr_b16 v[42:43], v6 offset:1024
    ds_read_b64_tr_b16 v[44:45], v7 offset:0
    ds_read_b64_tr_b16 v[46:47], v7 offset:1024
    s_waitcnt lgkmcnt(6)
    v_mfma_f32_16x16x32_bf16 v[64:67], v[48:51], v[32:35], 0
    ds_read_b64_tr_b16 v[200:201], v12 offset:0
    ds_read_b64_tr_b16 v[202:203], v12 offset:5120
    v_mfma_f32_16x16x32_bf16 v[72:75], v[52:55], v[32:35], 0
    ds_read_b64_tr_b16 v[204:205], v12 offset:512
    ds_read_b64_tr_b16 v[206:207], v12 offset:5632
    v_mfma_f32_16x16x32_bf16 v[80:83], v[56:59], v[32:35], 0
    ds_read_b64_tr_b16 v[208:209], v12 offset:1024
    ds_read_b64_tr_b16 v[210:211], v12 offset:6144
    v_mfma_f32_16x16x32_bf16 v[88:91], v[60:63], v[32:35], 0
    s_waitcnt lgkmcnt(10)
    v_mfma_f32_16x16x32_bf16 v[68:71], v[48:51], v[36:39], 0
    v_mfma_f32_16x16x32_bf16 v[76:79], v[52:55], v[36:39], 0
    v_mfma_f32_16x16x32_bf16 v[84:87], v[56:59], v[36:39], 0
    v_mfma_f32_16x16x32_bf16 v[92:95], v[60:63], v[36:39], 0
    ds_read_b64_tr_b16 v[128:129], v4 offset:8192
    s_waitcnt lgkmcnt(9)
    v_mfma_f32_16x16x32_bf16 v[96:99], v[48:51], v[40:43], 0
    ds_read_b64_tr_b16 v[130:131], v4 offset:9216
    v_mfma_f32_16x16x32_bf16 v[104:107], v[52:55], v[40:43], 0
    ds_read_b128 v[144:147], v3 offset:0
    v_mfma_f32_16x16x32_bf16 v[112:115], v[56:59], v[40:43], 0
    ds_read_b128 v[148:151], v3 offset:2048
    v_mfma_f32_16x16x32_bf16 v[120:123], v[60:63], v[40:43], 0
    ds_read_b128 v[152:155], v3 offset:4096
    s_waitcnt lgkmcnt(11)
    v_mfma_f32_16x16x32_bf16 v[100:103], v[48:51], v[44:47], 0
    ds_read_b128 v[156:159], v3 offset:6144
    v_mfma_f32_16x16x32_bf16 v[108:111], v[52:55], v[44:47], 0
    ds_read_b64_tr_b16 v[132:133], v5 offset:8192
    v_mfma_f32_16x16x32_bf16 v[116:119], v[56:59], v[44:47], 0
    ds_read_b64_tr_b16 v[134:135], v5 offset:9216
    v_mfma_f32_16x16x32_bf16 v[124:127], v[60:63], v[44:47], 0
    ds_read_b64_tr_b16 v[136:137], v6 offset:8192
    s_waitcnt lgkmcnt(3)
    v_mfma_f32_16x16x32_bf16 v[64:67], v[144:147], v[128:131], v[64:67]
    ds_read_b64_tr_b16 v[138:139], v6 offset:9216
    v_mfma_f32_16x16x32_bf16 v[72:75], v[148:151], v[128:131], v[72:75]
    ds_read_b64_tr_b16 v[140:141], v7 offset:8192
    v_mfma_f32_16x16x32_bf16 v[80:83], v[152:155], v[128:131], v[80:83]
    ds_read_b64_tr_b16 v[142:143], v7 offset:9216
    buffer_store_dwordx4 v[200:203], v13, s[12:15], s8 offen sc1
    v_mfma_f32_16x16x32_bf16 v[88:91], v[156:159], v[128:131], v[88:91]
    s_waitcnt lgkmcnt(4)
    v_mfma_f32_16x16x32_bf16 v[68:71], v[144:147], v[132:135], v[68:71]
    v_mfma_f32_16x16x32_bf16 v[76:79], v[148:151], v[132:135], v[76:79]
    v_mfma_f32_16x16x32_bf16 v[84:87], v[152:155], v[132:135], v[84:87]
    v_mfma_f32_16x16x32_bf16 v[92:95], v[156:159], v[132:135], v[92:95]
    s_barrier
    ds_read_b64_tr_b16 v[32:33], v4 offset:16384
    s_waitcnt lgkmcnt(3)
    v_mfma_f32_16x16x32_bf16 v[96:99], v[144:147], v[136:139], v[96:99]
    ds_read_b64_tr_b16 v[34:35], v4 offset:17408
    v_mfma_f32_16x16x32_bf16 v[104:107], v[148:151], v[136:139], v[104:107]
    ds_read_b128 v[48:51], v2 offset:16384
    v_mfma_f32_16x16x32_bf16 v[112:115], v[152:155], v[136:139], v[112:115]
    ds_read_b128 v[52:55], v2 offset:18432
    v_mfma_f32_16x16x32_bf16 v[120:123], v[156:159], v[136:139], v[120:123]
    ds_read_b128 v[56:59], v2 offset:20480
    s_waitcnt lgkmcnt(5)
    v_mfma_f32_16x16x32_bf16 v[100:103], v[144:147], v[140:143], v[100:103]
    ds_read_b128 v[60:63], v2 offset:22528
    v_mfma_f32_16x16x32_bf16 v[108:111], v[148:151], v[140:143], v[108:111]
    ds_read_b64_tr_b16 v[36:37], v5 offset:16384
    v_mfma_f32_16x16x32_bf16 v[116:119], v[152:155], v[140:143], v[116:119]
    ds_read_b64_tr_b16 v[38:39], v5 offset:17408
    v_mfma_f32_16x16x32_bf16 v[124:127], v[156:159], v[140:143], v[124:127]
    ds_read_b64_tr_b16 v[40:41], v6 offset:16384
    s_waitcnt lgkmcnt(3)
    v_mfma_f32_16x16x32_bf16 v[64:67], v[48:51], v[32:35], v[64:67]
    ds_read_b64_tr_b16 v[42:43], v6 offset:17408
    v_mfma_f32_16x16x32_bf16 v[72:75], v[52:55], v[32:35], v[72:75]
    ds_read_b64_tr_b16 v[44:45], v7 offset:16384
    v_mfma_f32_16x16x32_bf16 v[80:83], v[56:59], v[32:35], v[80:83]
    ds_read_b64_tr_b16 v[46:47], v7 offset:17408
    buffer_store_dwordx4 v[204:207], v13, s[12:15], s9 offen sc1
    v_mfma_f32_16x16x32_bf16 v[88:91], v[60:63], v[32:35], v[88:91]
    s_waitcnt lgkmcnt(4)
    v_mfma_f32_16x16x32_bf16 v[68:71], v[48:51], v[36:39], v[68:71]
    v_mfma_f32_16x16x32_bf16 v[76:79], v[52:55], v[36:39], v[76:79]
    v_mfma_f32_16x16x32_bf16 v[84:87], v[56:59], v[36:39], v[84:87]
    v_mfma_f32_16x16x32_bf16 v[92:95], v[60:63], v[36:39], v[92:95]
    ds_read_b64_tr_b16 v[128:129], v4 offset:24576
    s_waitcnt lgkmcnt(3)
    v_mfma_f32_16x16x32_bf16 v[96:99], v[48:51], v[40:43], v[96:99]
    ds_read_b64_tr_b16 v[130:131], v4 offset:25600
    v_mfma_f32_16x16x32_bf16 v[104:107], v[52:55], v[40:43], v[104:107]
    ds_read_b128 v[144:147], v3 offset:16384
    v_mfma_f32_16x16x32_bf16 v[112:115], v[56:59], v[40:43], v[112:115]
    ds_read_b128 v[148:151], v3 offset:18432
    v_mfma_f32_16x16x32_bf16 v[120:123], v[60:63], v[40:43], v[120:123]
    ds_read_b128 v[152:155], v3 offset:20480
    s_waitcnt lgkmcnt(5)
    v_mfma_f32_16x16x32_bf16 v[100:103], v[48:51], v[44:47], v[100:103]
    ds_read_b128 v[156:159], v3 offset:22528
    v_mfma_f32_16x16x32_bf16 v[108:111], v[52:55], v[44:47], v[108:111]
    ds_read_b64_tr_b16 v[132:133], v5 offset:24576
    v_mfma_f32_16x16x32_bf16 v[116:119], v[56:59], v[44:47], v[116:119]
    ds_read_b64_tr_b16 v[134:135], v5 offset:25600
    v_mfma_f32_16x16x32_bf16 v[124:127], v[60:63], v[44:47], v[124:127]
    ds_read_b64_tr_b16 v[136:137], v6 offset:24576
    s_waitcnt lgkmcnt(3)
    v_mfma_f32_16x16x32_bf16 v[64:67], v[144:147], v[128:131], v[64:67]
    ds_read_b64_tr_b16 v[138:139], v6 offset:25600
    v_mfma_f32_16x16x32_bf16 v[72:75], v[148:151], v[128:131], v[72:75]
    ds_read_b64_tr_b16 v[140:141], v7 offset:24576
    v_mfma_f32_16x16x32_bf16 v[80:83], v[152:155], v[128:131], v[80:83]
    ds_read_b64_tr_b16 v[142:143], v7 offset:25600
    buffer_store_dwordx4 v[208:211], v13, s[12:15], s10 offen sc1
    v_mfma_f32_16x16x32_bf16 v[88:91], v[156:159], v[128:131], v[88:91]
    s_waitcnt lgkmcnt(4)
    v_mfma_f32_16x16x32_bf16 v[68:71], v[144:147], v[132:135], v[68:71]
    v_mfma_f32_16x16x32_bf16 v[76:79], v[148:151], v[132:135], v[76:79]
    v_mfma_f32_16x16x32_bf16 v[84:87], v[152:155], v[132:135], v[84:87]
    v_mfma_f32_16x16x32_bf16 v[92:95], v[156:159], v[132:135], v[92:95]
    s_barrier
    ds_read_b64_tr_b16 v[32:33], v4 offset:32768
    s_waitcnt lgkmcnt(3)
    v_mfma_f32_16x16x32_bf16 v[96:99], v[144:147], v[136:139], v[96:99]
    ds_read_b64_tr_b16 v[34:35], v4 offset:33792
    v_mfma_f32_16x16x32_bf16 v[104:107], v[148:151], v[136:139], v[104:107]
    ds_read_b128 v[48:51], v2 offset:32768
    v_mfma_f32_16x16x32_bf16 v[112:115], v[152:155], v[136:139], v[112:115]
    ds_read_b128 v[52:55], v2 offset:34816
    v_mfma_f32_16x16x32_bf16 v[120:123], v[156:159], v[136:139], v[120:123]
    ds_read_b128 v[56:59], v2 offset:36864
    s_waitcnt lgkmcnt(5)
    v_mfma_f32_16x16x32_bf16 v[100:103], v[144:147], v[140:143], v[100:103]
    ds_read_b128 v[60:63], v2 offset:38912
    v_mfma_f32_16x16x32_bf16 v[108:111], v[148:151], v[140:143], v[108:111]
    ds_read_b64_tr_b16 v[36:37], v5 offset:32768
    v_mfma_f32_16x16x32_bf16 v[116:119], v[152:155], v[140:143], v[116:119]
    ds_read_b64_tr_b16 v[38:39], v5 offset:33792
    v_mfma_f32_16x16x32_bf16 v[124:127], v[156:159], v[140:143], v[124:127]
    ds_read_b64_tr_b16 v[40:41], v6 offset:32768
    s_waitcnt lgkmcnt(3)
    v_mfma_f32_16x16x32_bf16 v[64:67], v[48:51], v[32:35], v[64:67]
    ds_read_b64_tr_b16 v[42:43], v6 offset:33792
    v_mfma_f32_16x16x32_bf16 v[72:75], v[52:55], v[32:35], v[72:75]
    ds_read_b64_tr_b16 v[44:45], v7 offset:32768
    v_mfma_f32_16x16x32_bf16 v[80:83], v[56:59], v[32:35], v[80:83]
    ds_read_b64_tr_b16 v[46:47], v7 offset:33792
    v_mfma_f32_16x16x32_bf16 v[88:91], v[60:63], v[32:35], v[88:91]
    s_waitcnt lgkmcnt(4)
    v_mfma_f32_16x16x32_bf16 v[68:71], v[48:51], v[36:39], v[68:71]
    v_mfma_f32_16x16x32_bf16 v[76:79], v[52:55], v[36:39], v[76:79]
    v_mfma_f32_16x16x32_bf16 v[84:87], v[56:59], v[36:39], v[84:87]
    v_mfma_f32_16x16x32_bf16 v[92:95], v[60:63], v[36:39], v[92:95]
    ds_read_b64_tr_b16 v[128:129], v4 offset:40960
    s_waitcnt lgkmcnt(3)
    v_mfma_f32_16x16x32_bf16 v[96:99], v[48:51], v[40:43], v[96:99]
    ds_read_b64_tr_b16 v[130:131], v4 offset:41984
    v_mfma_f32_16x16x32_bf16 v[104:107], v[52:55], v[40:43], v[104:107]
    ds_read_b128 v[144:147], v3 offset:32768
    v_mfma_f32_16x16x32_bf16 v[112:115], v[56:59], v[40:43], v[112:115]
    ds_read_b128 v[148:151], v3 offset:34816
    v_mfma_f32_16x16x32_bf16 v[120:123], v[60:63], v[40:43], v[120:123]
    ds_read_b128 v[152:155], v3 offset:36864
    s_waitcnt lgkmcnt(5)
    v_mfma_f32_16x16x32_bf16 v[100:103], v[48:51], v[44:47], v[100:103]
    ds_read_b128 v[156:159], v3 offset:38912
    v_mfma_f32_16x16x32_bf16 v[108:111], v[52:55], v[44:47], v[108:111]
    ds_read_b64_tr_b16 v[132:133], v5 offset:40960
    v_mfma_f32_16x16x32_bf16 v[116:119], v[56:59], v[44:47], v[116:119]
    ds_read_b64_tr_b16 v[134:135], v5 offset:41984
    v_mfma_f32_16x16x32_bf16 v[124:127], v[60:63], v[44:47], v[124:127]
    ds_read_b64_tr_b16 v[136:137], v6 offset:40960
    s_waitcnt lgkmcnt(3)
    v_mfma_f32_16x16x32_bf16 v[64:67], v[144:147], v[128:131], v[64:67]
    ds_read_b64_tr_b16 v[138:139], v6 offset:41984
    v_mfma_f32_16x16x32_bf16 v[72:75], v[148:151], v[128:131], v[72:75]
    ds_read_b64_tr_b16 v[140:141], v7 offset:40960
    v_mfma_f32_16x16x32_bf16 v[80:83], v[152:155], v[128:131], v[80:83]
    ds_read_b64_tr_b16 v[142:143], v7 offset:41984
    v_mfma_f32_16x16x32_bf16 v[88:91], v[156:159], v[128:131], v[88:91]
    s_waitcnt lgkmcnt(4)
    v_mfma_f32_16x16x32_bf16 v[68:71], v[144:147], v[132:135], v[68:71]
    v_mfma_f32_16x16x32_bf16 v[76:79], v[148:151], v[132:135], v[76:79]
    v_mfma_f32_16x16x32_bf16 v[84:87], v[152:155], v[132:135], v[84:87]
    v_mfma_f32_16x16x32_bf16 v[92:95], v[156:159], v[132:135], v[92:95]
    s_waitcnt vmcnt(0)
    s_barrier
    ds_read_b64_tr_b16 v[32:33], v4 offset:49152
    s_waitcnt lgkmcnt(3)
    v_mfma_f32_16x16x32_bf16 v[96:99], v[144:147], v[136:139], v[96:99]
    ds_read_b64_tr_b16 v[34:35], v4 offset:50176
    v_mfma_f32_16x16x32_bf16 v[104:107], v[148:151], v[136:139], v[104:107]
    ds_read_b128 v[48:51], v2 offset:49152
    v_mfma_f32_16x16x32_bf16 v[112:115], v[152:155], v[136:139], v[112:115]
    ds_read_b128 v[52:55], v2 offset:51200
    v_mfma_f32_16x16x32_bf16 v[120:123], v[156:159], v[136:139], v[120:123]
    ds_read_b128 v[56:59], v2 offset:53248
    s_waitcnt lgkmcnt(5)
    v_mfma_f32_16x16x32_bf16 v[100:103], v[144:147], v[140:143], v[100:103]
    ds_read_b128 v[60:63], v2 offset:55296
    v_mfma_f32_16x16x32_bf16 v[108:111], v[148:151], v[140:143], v[108:111]
    ds_read_b64_tr_b16 v[36:37], v5 offset:49152
    v_mfma_f32_16x16x32_bf16 v[116:119], v[152:155], v[140:143], v[116:119]
    ds_read_b64_tr_b16 v[38:39], v5 offset:50176
    v_mfma_f32_16x16x32_bf16 v[124:127], v[156:159], v[140:143], v[124:127]
    ds_read_b64_tr_b16 v[40:41], v6 offset:49152
    s_waitcnt lgkmcnt(3)
    v_mfma_f32_16x16x32_bf16 v[64:67], v[48:51], v[32:35], v[64:67]
    ds_read_b64_tr_b16 v[42:43], v6 offset:50176
    v_mfma_f32_16x16x32_bf16 v[72:75], v[52:55], v[32:35], v[72:75]
    ds_read_b64_tr_b16 v[44:45], v7 offset:49152
    v_mfma_f32_16x16x32_bf16 v[80:83], v[56:59], v[32:35], v[80:83]
    ds_read_b64_tr_b16 v[46:47], v7 offset:50176
    s_cmp_lg_u32 s77, 0
    s_cbranch_scc1 L_nf_15
    s_mov_b64 exec, 1
    buffer_store_dwordx2 v[28:29], v13, s[12:15], s11 offen sc1
    s_mov_b64 exec, -1
L_nf_15:
    v_mfma_f32_16x16x32_bf16 v[88:91], v[60:63], v[32:35], v[88:91]
    s_waitcnt lgkmcnt(4)
    v_mfma_f32_16x16x32_bf16 v[68:71], v[48:51], v[36:39], v[68:71]
    v_mfma_f32_16x16x32_bf16 v[76:79], v[52:55], v[36:39], v[76:79]
    v_mfma_f32_16x16x32_bf16 v[84:87], v[56:59], v[36:39], v[84:87]
    v_mfma_f32_16x16x32_bf16 v[92:95], v[60:63], v[36:39], v[92:95]
    ds_read_b64_tr_b16 v[128:129], v4 offset:57344
    s_waitcnt lgkmcnt(3)
    v_mfma_f32_16x16x32_bf16 v[96:99], v[48:51], v[40:43], v[96:99]
    ds_read_b64_tr_b16 v[130:131], v4 offset:58368
    v_mfma_f32_16x16x32_bf16 v[104:107], v[52:55], v[40:43], v[104:107]
    ds_read_b128 v[144:147], v3 offset:49152
    v_mfma_f32_16x16x32_bf16 v[112:115], v[56:59], v[40:43], v[112:115]
    ds_read_b128 v[148:151], v3 offset:51200
    v_mfma_f32_16x16x32_bf16 v[120:123], v[60:63], v[40:43], v[120:123]
    ds_read_b128 v[152:155], v3 offset:53248
    s_waitcnt lgkmcnt(5)
    v_mfma_f32_16x16x32_bf16 v[100:103], v[48:51], v[44:47], v[100:103]
    ds_read_b128 v[156:159], v3 offset:55296
    v_mfma_f32_16x16x32_bf16 v[108:111], v[52:55], v[44:47], v[108:111]
    ds_read_b64_tr_b16 v[132:133], v5 offset:57344
    v_mfma_f32_16x16x32_bf16 v[116:119], v[56:59], v[44:47], v[116:119]
    ds_read_b64_tr_b16 v[134:135], v5 offset:58368
    v_mfma_f32_16x16x32_bf16 v[124:127], v[60:63], v[44:47], v[124:127]
    ds_read_b64_tr_b16 v[136:137], v6 offset:57344
    s_waitcnt lgkmcnt(3)
    v_mfma_f32_16x16x32_bf16 v[64:67], v[144:147], v[128:131], v[64:67]
    ds_read_b64_tr_b16 v[138:139], v6 offset:58368
    v_mfma_f32_16x16x32_bf16 v[72:75], v[148:151], v[128:131], v[72:75]
    ds_read_b64_tr_b16 v[140:141], v7 offset:57344
    v_mfma_f32_16x16x32_bf16 v[80:83], v[152:155], v[128:131], v[80:83]
    ds_read_b64_tr_b16 v[142:143], v7 offset:58368
    v_mfma_f32_16x16x32_bf16 v[88:91], v[156:159], v[128:131], v[88:91]
    s_waitcnt lgkmcnt(4)
    v_mfma_f32_16x16x32_bf16 v[68:71], v[144:147], v[132:135], v[68:71]
    v_mfma_f32_16x16x32_bf16 v[76:79], v[148:151], v[132:135], v[76:79]
    v_mfma_f32_16x16x32_bf16 v[84:87], v[152:155], v[132:135], v[84:87]
    v_mfma_f32_16x16x32_bf16 v[92:95], v[156:159], v[132:135], v[92:95]
    s_barrier
    ds_read_b64_tr_b16 v[32:33], v4 offset:0
    s_waitcnt lgkmcnt(3)
    v_mfma_f32_16x16x32_bf16 v[96:99], v[144:147], v[136:139], v[96:99]
    ds_read_b64_tr_b16 v[34:35], v4 offset:1024
    v_mfma_f32_16x16x32_bf16 v[104:107], v[148:151], v[136:139], v[104:107]
    ds_read_b128 v[48:51], v2 offset:0
    v_mfma_f32_16x16x32_bf16 v[112:115], v[152:155], v[136:139], v[112:115]
    ds_read_b128 v[52:55], v2 offset:2048
    v_mfma_f32_16x16x32_bf16 v[120:123], v[156:159], v[136:139], v[120:123]
    ds_read_b128 v[56:59], v2 offset:4096
    s_waitcnt lgkmcnt(5)
    v_mfma_f32_16x16x32_bf16 v[100:103], v[144:147], v[140:143], v[100:103]
    ds_read_b128 v[60:63], v2 offset:6144
    v_mfma_f32_16x16x32_bf16 v[108:111], v[148:151], v[140:143], v[108:111]
    ds_read_b64_tr_b16 v[36:37], v5 offset:0
    v_mfma_f32_16x16x32_bf16 v[116:119], v[152:155], v[140:143], v[116:119]
    ds_read_b64_tr_b16 v[38:39], v5 offset:1024
    v_mfma_f32_16x16x32_bf16 v[124:127], v[156:159], v[140:143], v[124:127]
    ds_read_b64_tr_b16 v[40:41], v6 offset:0
    s_waitcnt lgkmcnt(3)
    v_mfma_f32_16x16x32_bf16 v[64:67], v[48:51], v[32:35], v[64:67]
    ds_read_b64_tr_b16 v[42:43], v6 offset:1024
    v_mfma_f32_16x16x32_bf16 v[72:75], v[52:55], v[32:35], v[72:75]
    ds_read_b64_tr_b16 v[44:45], v7 offset:0
    v_mfma_f32_16x16x32_bf16 v[80:83], v[56:59], v[32:35], v[80:83]
    ds_read_b64_tr_b16 v[46:47], v7 offset:1024
    v_mfma_f32_16x16x32_bf16 v[88:91], v[60:63], v[32:35], v[88:91]
    s_waitcnt lgkmcnt(4)
    v_mfma_f32_16x16x32_bf16 v[68:71], v[48:51], v[36:39], v[68:71]
    v_mfma_f32_16x16x32_bf16 v[76:79], v[52:55], v[36:39], v[76:79]
    v_mfma_f32_16x16x32_bf16 v[84:87], v[56:59], v[36:39], v[84:87]
    v_mfma_f32_16x16x32_bf16 v[92:95], v[60:63], v[36:39], v[92:95]
    ds_read_b64_tr_b16 v[128:129], v4 offset:8192
    s_waitcnt lgkmcnt(3)
    v_mfma_f32_16x16x32_bf16 v[96:99], v[48:51], v[40:43], v[96:99]
    ds_read_b64_tr_b16 v[130:131], v4 offset:9216
    v_mfma_f32_16x16x32_bf16 v[104:107], v[52:55], v[40:43], v[104:107]
    ds_read_b128 v[144:147], v3 offset:0
    v_mfma_f32_16x16x32_bf16 v[112:115], v[56:59], v[40:43], v[112:115]
    ds_read_b128 v[148:151], v3 offset:2048
    v_mfma_f32_16x16x32_bf16 v[120:123], v[60:63], v[40:43], v[120:123]
    ds_read_b128 v[152:155], v3 offset:4096
    s_waitcnt lgkmcnt(5)
    v_mfma_f32_16x16x32_bf16 v[100:103], v[48:51], v[44:47], v[100:103]
    ds_read_b128 v[156:159], v3 offset:6144
    v_mfma_f32_16x16x32_bf16 v[108:111], v[52:55], v[44:47], v[108:111]
    ds_read_b64_tr_b16 v[132:133], v5 offset:8192
    v_mfma_f32_16x16x32_bf16 v[116:119], v[56:59], v[44:47], v[116:119]
    ds_read_b64_tr_b16 v[134:135], v5 offset:9216
    v_mfma_f32_16x16x32_bf16 v[124:127], v[60:63], v[44:47], v[124:127]
    ds_read_b64_tr_b16 v[136:137], v6 offset:8192
    s_waitcnt lgkmcnt(3)
    v_mfma_f32_16x16x32_bf16 v[64:67], v[144:147], v[128:131], v[64:67]
    ds_read_b64_tr_b16 v[138:139], v6 offset:9216
    v_mfma_f32_16x16x32_bf16 v[72:75], v[148:151], v[128:131], v[72:75]
    ds_read_b64_tr_b16 v[140:141], v7 offset:8192
    v_mfma_f32_16x16x32_bf16 v[80:83], v[152:155], v[128:131], v[80:83]
    ds_read_b64_tr_b16 v[142:143], v7 offset:9216
    v_mfma_f32_16x16x32_bf16 v[88:91], v[156:159], v[128:131], v[88:91]
    s_waitcnt lgkmcnt(4)
    v_mfma_f32_16x16x32_bf16 v[68:71], v[144:147], v[132:135], v[68:71]
    v_mfma_f32_16x16x32_bf16 v[76:79], v[148:151], v[132:135], v[76:79]
    v_mfma_f32_16x16x32_bf16 v[84:87], v[152:155], v[132:135], v[84:87]
    v_mfma_f32_16x16x32_bf16 v[92:95], v[156:159], v[132:135], v[92:95]
    s_barrier
    ds_read_b64_tr_b16 v[32:33], v4 offset:16384
    s_waitcnt lgkmcnt(3)
    v_mfma_f32_16x16x32_bf16 v[96:99], v[144:147], v[136:139], v[96:99]
    ds_read_b64_tr_b16 v[34:35], v4 offset:17408
    v_mfma_f32_16x16x32_bf16 v[104:107], v[148:151], v[136:139], v[104:107]
    ds_read_b128 v[48:51], v2 offset:16384
    v_mfma_f32_16x16x32_bf16 v[112:115], v[152:155], v[136:139], v[112:115]
    ds_read_b128 v[52:55], v2 offset:18432
    v_mfma_f32_16x16x32_bf16 v[120:123], v[156:159], v[136:139], v[120:123]
    ds_read_b128 v[56:59], v2 offset:20480
    s_waitcnt lgkmcnt(5)
    v_mfma_f32_16x16x32_bf16 v[100:103], v[144:147], v[140:143], v[100:103]
    ds_read_b128 v[60:63], v2 offset:22528
    v_mfma_f32_16x16x32_bf16 v[108:111], v[148:151], v[140:143], v[108:111]
    ds_read_b64_tr_b16 v[36:37], v5 offset:16384
    v_mfma_f32_16x16x32_bf16 v[116:119], v[152:155], v[140:143], v[116:119]
    ds_read_b64_tr_b16 v[38:39], v5 offset:17408
    v_mfma_f32_16x16x32_bf16 v[124:127], v[156:159], v[140:143], v[124:127]
    ds_read_b64_tr_b16 v[40:41], v6 offset:16384
    s_waitcnt lgkmcnt(3)
    v_mfma_f32_16x16x32_bf16 v[64:67], v[48:51], v[32:35], v[64:67]
    ds_read_b64_tr_b16 v[42:43], v6 offset:17408
    v_mfma_f32_16x16x32_bf16 v[72:75], v[52:55], v[32:35], v[72:75]
    ds_read_b64_tr_b16 v[44:45], v7 offset:16384
    v_mfma_f32_16x16x32_bf16 v[80:83], v[56:59], v[32:35], v[80:83]
    ds_read_b64_tr_b16 v[46:47], v7 offset:17408
    v_mfma_f32_16x16x32_bf16 v[88:91], v[60:63], v[32:35], v[88:91]
    s_waitcnt lgkmcnt(4)
    v_mfma_f32_16x16x32_bf16 v[68:71], v[48:51], v[36:39], v[68:71]
    v_mfma_f32_16x16x32_bf16 v[76:79], v[52:55], v[36:39], v[76:79]
    v_mfma_f32_16x16x32_bf16 v[84:87], v[56:59], v[36:39], v[84:87]
    v_mfma_f32_16x16x32_bf16 v[92:95], v[60:63], v[36:39], v[92:95]
    ds_read_b64_tr_b16 v[128:129], v4 offset:24576
    s_waitcnt lgkmcnt(3)
    v_mfma_f32_16x16x32_bf16 v[96:99], v[48:51], v[40:43], v[96:99]
    ds_read_b64_tr_b16 v[130:131], v4 offset:25600
    v_mfma_f32_16x16x32_bf16 v[104:107], v[52:55], v[40:43], v[104:107]
    ds_read_b128 v[144:147], v3 offset:16384
    v_mfma_f32_16x16x32_bf16 v[112:115], v[56:59], v[40:43], v[112:115]
    ds_read_b128 v[148:151], v3 offset:18432
    v_mfma_f32_16x16x32_bf16 v[120:123], v[60:63], v[40:43], v[120:123]
    ds_read_b128 v[152:155], v3 offset:20480
    s_waitcnt lgkmcnt(5)
    v_mfma_f32_16x16x32_bf16 v[100:103], v[48:51], v[44:47], v[100:103]
    ds_read_b128 v[156:159], v3 offset:22528
    v_mfma_f32_16x16x32_bf16 v[108:111], v[52:55], v[44:47], v[108:111]
    ds_read_b64_tr_b16 v[132:133], v5 offset:24576
    v_mfma_f32_16x16x32_bf16 v[116:119], v[56:59], v[44:47], v[116:119]
    ds_read_b64_tr_b16 v[134:135], v5 offset:25600
    v_mfma_f32_16x16x32_bf16 v[124:127], v[60:63], v[44:47], v[124:127]
    ds_read_b64_tr_b16 v[136:137], v6 offset:24576
    s_waitcnt lgkmcnt(3)
    v_mfma_f32_16x16x32_bf16 v[64:67], v[144:147], v[128:131], v[64:67]
    ds_read_b64_tr_b16 v[138:139], v6 offset:25600
    v_mfma_f32_16x16x32_bf16 v[72:75], v[148:151], v[128:131], v[72:75]
    ds_read_b64_tr_b16 v[140:141], v7 offset:24576
    v_mfma_f32_16x16x32_bf16 v[80:83], v[152:155], v[128:131], v[80:83]
    ds_read_b64_tr_b16 v[142:143], v7 offset:25600
    v_mfma_f32_16x16x32_bf16 v[88:91], v[156:159], v[128:131], v[88:91]
    s_waitcnt lgkmcnt(4)
    v_mfma_f32_16x16x32_bf16 v[68:71], v[144:147], v[132:135], v[68:71]
    v_mfma_f32_16x16x32_bf16 v[76:79], v[148:151], v[132:135], v[76:79]
    v_mfma_f32_16x16x32_bf16 v[84:87], v[152:155], v[132:135], v[84:87]
    v_mfma_f32_16x16x32_bf16 v[92:95], v[156:159], v[132:135], v[92:95]
    s_barrier
    ds_read_b64_tr_b16 v[32:33], v4 offset:32768
    s_waitcnt lgkmcnt(3)
    v_mfma_f32_16x16x32_bf16 v[96:99], v[144:147], v[136:139], v[96:99]
    ds_read_b64_tr_b16 v[34:35], v4 offset:33792
    v_mfma_f32_16x16x32_bf16 v[104:107], v[148:151], v[136:139], v[104:107]
    ds_read_b128 v[48:51], v2 offset:32768
    v_mfma_f32_16x16x32_bf16 v[112:115], v[152:155], v[136:139], v[112:115]
    ds_read_b128 v[52:55], v2 offset:34816
    v_mfma_f32_16x16x32_bf16 v[120:123], v[156:159], v[136:139], v[120:123]
    ds_read_b128 v[56:59], v2 offset:36864
    s_waitcnt lgkmcnt(5)
    v_mfma_f32_16x16x32_bf16 v[100:103], v[144:147], v[140:143], v[100:103]
    ds_read_b128 v[60:63], v2 offset:38912
    v_mfma_f32_16x16x32_bf16 v[108:111], v[148:151], v[140:143], v[108:111]
    ds_read_b64_tr_b16 v[36:37], v5 offset:32768
    v_mfma_f32_16x16x32_bf16 v[116:119], v[152:155], v[140:143], v[116:119]
    ds_read_b64_tr_b16 v[38:39], v5 offset:33792
    v_mfma_f32_16x16x32_bf16 v[124:127], v[156:159], v[140:143], v[124:127]
    ds_read_b64_tr_b16 v[40:41], v6 offset:32768
    s_waitcnt lgkmcnt(3)
    v_mfma_f32_16x16x32_bf16 v[64:67], v[48:51], v[32:35], v[64:67]
    ds_read_b64_tr_b16 v[42:43], v6 offset:33792
    v_mfma_f32_16x16x32_bf16 v[72:75], v[52:55], v[32:35], v[72:75]
    ds_read_b64_tr_b16 v[44:45], v7 offset:32768
    v_mfma_f32_16x16x32_bf16 v[80:83], v[56:59], v[32:35], v[80:83]
    ds_read_b64_tr_b16 v[46:47], v7 offset:33792
    v_mfma_f32_16x16x32_bf16 v[88:91], v[60:63], v[32:35], v[88:91]
    s_waitcnt lgkmcnt(4)
    v_mfma_f32_16x16x32_bf16 v[68:71], v[48:51], v[36:39], v[68:71]
    v_mfma_f32_16x16x32_bf16 v[76:79], v[52:55], v[36:39], v[76:79]
    v_mfma_f32_16x16x32_bf16 v[84:87], v[56:59], v[36:39], v[84:87]
    v_mfma_f32_16x16x32_bf16 v[92:95], v[60:63], v[36:39], v[92:95]
    ds_read_b64_tr_b16 v[128:129], v4 offset:40960
    s_waitcnt lgkmcnt(3)
    v_mfma_f32_16x16x32_bf16 v[96:99], v[48:51], v[40:43], v[96:99]
    ds_read_b64_tr_b16 v[130:131], v4 offset:41984
    v_mfma_f32_16x16x32_bf16 v[104:107], v[52:55], v[40:43], v[104:107]
    ds_read_b128 v[144:147], v3 offset:32768
    v_mfma_f32_16x16x32_bf16 v[112:115], v[56:59], v[40:43], v[112:115]
    ds_read_b128 v[148:151], v3 offset:34816
    v_mfma_f32_16x16x32_bf16 v[120:123], v[60:63], v[40:43], v[120:123]
    ds_read_b128 v[152:155], v3 offset:36864
    s_waitcnt lgkmcnt(5)
    v_mfma_f32_16x16x32_bf16 v[100:103], v[48:51], v[44:47], v[100:103]
    ds_read_b128 v[156:159], v3 offset:38912
    v_mfma_f32_16x16x32_bf16 v[108:111], v[52:55], v[44:47], v[108:111]
    ds_read_b64_tr_b16 v[132:133], v5 offset:40960
    v_mfma_f32_16x16x32_bf16 v[116:119], v[56:59], v[44:47], v[116:119]
    ds_read_b64_tr_b16 v[134:135], v5 offset:41984
    v_mfma_f32_16x16x32_bf16 v[124:127], v[60:63], v[44:47], v[124:127]
    ds_read_b64_tr_b16 v[136:137], v6 offset:40960
    s_waitcnt lgkmcnt(3)
    v_mfma_f32_16x16x32_bf16 v[64:67], v[144:147], v[128:131], v[64:67]
    ds_read_b64_tr_b16 v[138:139], v6 offset:41984
    v_mfma_f32_16x16x32_bf16 v[72:75], v[148:151], v[128:131], v[72:75]
    ds_read_b64_tr_b16 v[140:141], v7 offset:40960
    v_mfma_f32_16x16x32_bf16 v[80:83], v[152:155], v[128:131], v[80:83]
    ds_read_b64_tr_b16 v[142:143], v7 offset:41984
    v_mfma_f32_16x16x32_bf16 v[88:91], v[156:159], v[128:131], v[88:91]
    s_waitcnt lgkmcnt(4)
    v_mfma_f32_16x16x32_bf16 v[68:71], v[144:147], v[132:135], v[68:71]
    v_mfma_f32_16x16x32_bf16 v[76:79], v[148:151], v[132:135], v[76:79]
    v_mfma_f32_16x16x32_bf16 v[84:87], v[152:155], v[132:135], v[84:87]
    v_mfma_f32_16x16x32_bf16 v[92:95], v[156:159], v[132:135], v[92:95]
    s_barrier
    ds_read_b64_tr_b16 v[32:33], v4 offset:49152
    s_waitcnt lgkmcnt(3)
    v_mfma_f32_16x16x32_bf16 v[96:99], v[144:147], v[136:139], v[96:99]
    ds_read_b64_tr_b16 v[34:35], v4 offset:50176
    v_mfma_f32_16x16x32_bf16 v[104:107], v[148:151], v[136:139], v[104:107]
    ds_read_b128 v[48:51], v2 offset:49152
    v_mfma_f32_16x16x32_bf16 v[112:115], v[152:155], v[136:139], v[112:115]
    ds_read_b128 v[52:55], v2 offset:51200
    v_mfma_f32_16x16x32_bf16 v[120:123], v[156:159], v[136:139], v[120:123]
    ds_read_b128 v[56:59], v2 offset:53248
    s_waitcnt lgkmcnt(5)
    v_mfma_f32_16x16x32_bf16 v[100:103], v[144:147], v[140:143], v[100:103]
    ds_read_b128 v[60:63], v2 offset:55296
    v_mfma_f32_16x16x32_bf16 v[108:111], v[148:151], v[140:143], v[108:111]
    ds_read_b64_tr_b16 v[36:37], v5 offset:49152
    v_mfma_f32_16x16x32_bf16 v[116:119], v[152:155], v[140:143], v[116:119]
    ds_read_b64_tr_b16 v[38:39], v5 offset:50176
    v_mfma_f32_16x16x32_bf16 v[124:127], v[156:159], v[140:143], v[124:127]
    ds_read_b64_tr_b16 v[40:41], v6 offset:49152
    s_waitcnt lgkmcnt(3)
    v_mfma_f32_16x16x32_bf16 v[64:67], v[48:51], v[32:35], v[64:67]
    ds_read_b64_tr_b16 v[42:43], v6 offset:50176
    v_mfma_f32_16x16x32_bf16 v[72:75], v[52:55], v[32:35], v[72:75]
    ds_read_b64_tr_b16 v[44:45], v7 offset:49152
    v_mfma_f32_16x16x32_bf16 v[80:83], v[56:59], v[32:35], v[80:83]
    ds_read_b64_tr_b16 v[46:47], v7 offset:50176
    v_mfma_f32_16x16x32_bf16 v[88:91], v[60:63], v[32:35], v[88:91]
    s_waitcnt lgkmcnt(4)
    v_mfma_f32_16x16x32_bf16 v[68:71], v[48:51], v[36:39], v[68:71]
    v_mfma_f32_16x16x32_bf16 v[76:79], v[52:55], v[36:39], v[76:79]
    v_mfma_f32_16x16x32_bf16 v[84:87], v[56:59], v[36:39], v[84:87]
    v_mfma_f32_16x16x32_bf16 v[92:95], v[60:63], v[36:39], v[92:95]
    ds_read_b64_tr_b16 v[128:129], v4 offset:57344
    s_waitcnt lgkmcnt(3)
    v_mfma_f32_16x16x32_bf16 v[96:99], v[48:51], v[40:43], v[96:99]
    ds_read_b64_tr_b16 v[130:131], v4 offset:58368
    v_mfma_f32_16x16x32_bf16 v[104:107], v[52:55], v[40:43], v[104:107]
    ds_read_b128 v[144:147], v3 offset:49152
    v_mfma_f32_16x16x32_bf16 v[112:115], v[56:59], v[40:43], v[112:115]
    ds_read_b128 v[148:151], v3 offset:51200
    v_mfma_f32_16x16x32_bf16 v[120:123], v[60:63], v[40:43], v[120:123]
    ds_read_b128 v[152:155], v3 offset:53248
    s_waitcnt lgkmcnt(5)
    v_mfma_f32_16x16x32_bf16 v[100:103], v[48:51], v[44:47], v[100:103]
    ds_read_b128 v[156:159], v3 offset:55296
    v_mfma_f32_16x16x32_bf16 v[108:111], v[52:55], v[44:47], v[108:111]
    ds_read_b64_tr_b16 v[132:133], v5 offset:57344
    v_mfma_f32_16x16x32_bf16 v[116:119], v[56:59], v[44:47], v[116:119]
    ds_read_b64_tr_b16 v[134:135], v5 offset:58368
    v_mfma_f32_16x16x32_bf16 v[124:127], v[60:63], v[44:47], v[124:127]
    ds_read_b64_tr_b16 v[136:137], v6 offset:57344
    s_waitcnt lgkmcnt(3)
    v_mfma_f32_16x16x32_bf16 v[64:67], v[144:147], v[128:131], v[64:67]
    ds_read_b64_tr_b16 v[138:139], v6 offset:58368
    v_mfma_f32_16x16x32_bf16 v[72:75], v[148:151], v[128:131], v[72:75]
    ds_read_b64_tr_b16 v[140:141], v7 offset:57344
    v_mfma_f32_16x16x32_bf16 v[80:83], v[152:155], v[128:131], v[80:83]
    ds_read_b64_tr_b16 v[142:143], v7 offset:58368
    v_mfma_f32_16x16x32_bf16 v[88:91], v[156:159], v[128:131], v[88:91]
    s_waitcnt lgkmcnt(4)
    v_mfma_f32_16x16x32_bf16 v[68:71], v[144:147], v[132:135], v[68:71]
    v_mfma_f32_16x16x32_bf16 v[76:79], v[148:151], v[132:135], v[76:79]
    v_mfma_f32_16x16x32_bf16 v[84:87], v[152:155], v[132:135], v[84:87]
    v_mfma_f32_16x16x32_bf16 v[92:95], v[156:159], v[132:135], v[92:95]
    s_barrier
    ds_read_b64_tr_b16 v[32:33], v4 offset:0
    s_waitcnt lgkmcnt(3)
    v_mfma_f32_16x16x32_bf16 v[96:99], v[144:147], v[136:139], v[96:99]
    ds_read_b64_tr_b16 v[34:35], v4 offset:1024
    v_mfma_f32_16x16x32_bf16 v[104:107], v[148:151], v[136:139], v[104:107]
    ds_read_b128 v[48:51], v2 offset:0
    v_mfma_f32_16x16x32_bf16 v[112:115], v[152:155], v[136:139], v[112:115]
    ds_read_b128 v[52:55], v2 offset:2048
    v_mfma_f32_16x16x32_bf16 v[120:123], v[156:159], v[136:139], v[120:123]
    ds_read_b128 v[56:59], v2 offset:4096
    s_waitcnt lgkmcnt(5)
    v_mfma_f32_16x16x32_bf16 v[100:103], v[144:147], v[140:143], v[100:103]
    ds_read_b128 v[60:63], v2 offset:6144
    v_mfma_f32_16x16x32_bf16 v[108:111], v[148:151], v[140:143], v[108:111]
    ds_read_b64_tr_b16 v[36:37], v5 offset:0
    v_mfma_f32_16x16x32_bf16 v[116:119], v[152:155], v[140:143], v[116:119]
    ds_read_b64_tr_b16 v[38:39], v5 offset:1024
    v_mfma_f32_16x16x32_bf16 v[124:127], v[156:159], v[140:143], v[124:127]
    ds_read_b64_tr_b16 v[40:41], v6 offset:0
    s_waitcnt lgkmcnt(3)
    v_mfma_f32_16x16x32_bf16 v[64:67], v[48:51], v[32:35], v[64:67]
    ds_read_b64_tr_b16 v[42:43], v6 offset:1024
    v_mfma_f32_16x16x32_bf16 v[72:75], v[52:55], v[32:35], v[72:75]
    ds_read_b64_tr_b16 v[44:45], v7 offset:0
    v_mfma_f32_16x16x32_bf16 v[80:83], v[56:59], v[32:35], v[80:83]
    ds_read_b64_tr_b16 v[46:47], v7 offset:1024
    v_mfma_f32_16x16x32_bf16 v[88:91], v[60:63], v[32:35], v[88:91]
    s_waitcnt lgkmcnt(4)
    v_mfma_f32_16x16x32_bf16 v[68:71], v[48:51], v[36:39], v[68:71]
    v_mfma_f32_16x16x32_bf16 v[76:79], v[52:55], v[36:39], v[76:79]
    v_mfma_f32_16x16x32_bf16 v[84:87], v[56:59], v[36:39], v[84:87]
    v_mfma_f32_16x16x32_bf16 v[92:95], v[60:63], v[36:39], v[92:95]
    ds_read_b64_tr_b16 v[128:129], v4 offset:8192
    s_waitcnt lgkmcnt(3)
    v_mfma_f32_16x16x32_bf16 v[96:99], v[48:51], v[40:43], v[96:99]
    ds_read_b64_tr_b16 v[130:131], v4 offset:9216
    v_mfma_f32_16x16x32_bf16 v[104:107], v[52:55], v[40:43], v[104:107]
    ds_read_b128 v[144:147], v3 offset:0
    v_mfma_f32_16x16x32_bf16 v[112:115], v[56:59], v[40:43], v[112:115]
    ds_read_b128 v[148:151], v3 offset:2048
    v_mfma_f32_16x16x32_bf16 v[120:123], v[60:63], v[40:43], v[120:123]
    ds_read_b128 v[152:155], v3 offset:4096
    s_waitcnt lgkmcnt(5)
    v_mfma_f32_16x16x32_bf16 v[100:103], v[48:51], v[44:47], v[100:103]
    ds_read_b128 v[156:159], v3 offset:6144
    v_mfma_f32_16x16x32_bf16 v[108:111], v[52:55], v[44:47], v[108:111]
    ds_read_b64_tr_b16 v[132:133], v5 offset:8192
    v_mfma_f32_16x16x32_bf16 v[116:119], v[56:59], v[44:47], v[116:119]
    ds_read_b64_tr_b16 v[134:135], v5 offset:9216
    v_mfma_f32_16x16x32_bf16 v[124:127], v[60:63], v[44:47], v[124:127]
    ds_read_b64_tr_b16 v[136:137], v6 offset:8192
    s_waitcnt lgkmcnt(3)
    v_mfma_f32_16x16x32_bf16 v[64:67], v[144:147], v[128:131], v[64:67]
    ds_read_b64_tr_b16 v[138:139], v6 offset:9216
    v_mfma_f32_16x16x32_bf16 v[72:75], v[148:151], v[128:131], v[72:75]
    ds_read_b64_tr_b16 v[140:141], v7 offset:8192
    v_mfma_f32_16x16x32_bf16 v[80:83], v[152:155], v[128:131], v[80:83]
    ds_read_b64_tr_b16 v[142:143], v7 offset:9216
    v_mfma_f32_16x16x32_bf16 v[88:91], v[156:159], v[128:131], v[88:91]
    s_waitcnt lgkmcnt(4)
    v_mfma_f32_16x16x32_bf16 v[68:71], v[144:147], v[132:135], v[68:71]
    v_mfma_f32_16x16x32_bf16 v[76:79], v[148:151], v[132:135], v[76:79]
    v_mfma_f32_16x16x32_bf16 v[84:87], v[152:155], v[132:135], v[84:87]
    v_mfma_f32_16x16x32_bf16 v[92:95], v[156:159], v[132:135], v[92:95]
    s_barrier
    ds_read_b64_tr_b16 v[32:33], v4 offset:16384
    s_waitcnt lgkmcnt(3)
    v_mfma_f32_16x16x32_bf16 v[96:99], v[144:147], v[136:139], v[96:99]
    ds_read_b64_tr_b16 v[34:35], v4 offset:17408
    v_mfma_f32_16x16x32_bf16 v[104:107], v[148:151], v[136:139], v[104:107]
    ds_read_b128 v[48:51], v2 offset:16384
    v_mfma_f32_16x16x32_bf16 v[112:115], v[152:155], v[136:139], v[112:115]
    ds_read_b128 v[52:55], v2 offset:18432
    v_mfma_f32_16x16x32_bf16 v[120:123], v[156:159], v[136:139], v[120:123]
    ds_read_b128 v[56:59], v2 offset:20480
    s_waitcnt lgkmcnt(5)
    v_mfma_f32_16x16x32_bf16 v[100:103], v[144:147], v[140:143], v[100:103]
    ds_read_b128 v[60:63], v2 offset:22528
    v_mfma_f32_16x16x32_bf16 v[108:111], v[148:151], v[140:143], v[108:111]
    ds_read_b64_tr_b16 v[36:37], v5 offset:16384
    v_mfma_f32_16x16x32_bf16 v[116:119], v[152:155], v[140:143], v[116:119]
    ds_read_b64_tr_b16 v[38:39], v5 offset:17408
    v_mfma_f32_16x16x32_bf16 v[124:127], v[156:159], v[140:143], v[124:127]
    ds_read_b64_tr_b16 v[40:41], v6 offset:16384
    s_waitcnt lgkmcnt(3)
    v_mfma_f32_16x16x32_bf16 v[64:67], v[48:51], v[32:35], v[64:67]
    ds_read_b64_tr_b16 v[42:43], v6 offset:17408
    v_mfma_f32_16x16x32_bf16 v[72:75], v[52:55], v[32:35], v[72:75]
    ds_read_b64_tr_b16 v[44:45], v7 offset:16384
    v_mfma_f32_16x16x32_bf16 v[80:83], v[56:59], v[32:35], v[80:83]
    ds_read_b64_tr_b16 v[46:47], v7 offset:17408
    v_mfma_f32_16x16x32_bf16 v[88:91], v[60:63], v[32:35], v[88:91]
    s_waitcnt lgkmcnt(4)
    v_mfma_f32_16x16x32_bf16 v[68:71], v[48:51], v[36:39], v[68:71]
    v_mfma_f32_16x16x32_bf16 v[76:79], v[52:55], v[36:39], v[76:79]
    v_mfma_f32_16x16x32_bf16 v[84:87], v[56:59], v[36:39], v[84:87]
    v_mfma_f32_16x16x32_bf16 v[92:95], v[60:63], v[36:39], v[92:95]
    ds_read_b64_tr_b16 v[128:129], v4 offset:24576
    s_waitcnt lgkmcnt(3)
    v_mfma_f32_16x16x32_bf16 v[96:99], v[48:51], v[40:43], v[96:99]
    ds_read_b64_tr_b16 v[130:131], v4 offset:25600
    v_mfma_f32_16x16x32_bf16 v[104:107], v[52:55], v[40:43], v[104:107]
    ds_read_b128 v[144:147], v3 offset:16384
    v_mfma_f32_16x16x32_bf16 v[112:115], v[56:59], v[40:43], v[112:115]
    ds_read_b128 v[148:151], v3 offset:18432
    v_mfma_f32_16x16x32_bf16 v[120:123], v[60:63], v[40:43], v[120:123]
    ds_read_b128 v[152:155], v3 offset:20480
    s_waitcnt lgkmcnt(5)
    v_mfma_f32_16x16x32_bf16 v[100:103], v[48:51], v[44:47], v[100:103]
    ds_read_b128 v[156:159], v3 offset:22528
    v_mfma_f32_16x16x32_bf16 v[108:111], v[52:55], v[44:47], v[108:111]
    ds_read_b64_tr_b16 v[132:133], v5 offset:24576
    v_mfma_f32_16x16x32_bf16 v[116:119], v[56:59], v[44:47], v[116:119]
    ds_read_b64_tr_b16 v[134:135], v5 offset:25600
    v_mfma_f32_16x16x32_bf16 v[124:127], v[60:63], v[44:47], v[124:127]
    ds_read_b64_tr_b16 v[136:137], v6 offset:24576
    s_waitcnt lgkmcnt(3)
    v_mfma_f32_16x16x32_bf16 v[64:67], v[144:147], v[128:131], v[64:67]
    ds_read_b64_tr_b16 v[138:139], v6 offset:25600
    v_mfma_f32_16x16x32_bf16 v[72:75], v[148:151], v[128:131], v[72:75]
    ds_read_b64_tr_b16 v[140:141], v7 offset:24576
    v_mfma_f32_16x16x32_bf16 v[80:83], v[152:155], v[128:131], v[80:83]
    ds_read_b64_tr_b16 v[142:143], v7 offset:25600
    v_mfma_f32_16x16x32_bf16 v[88:91], v[156:159], v[128:131], v[88:91]
    s_waitcnt lgkmcnt(4)
    v_mfma_f32_16x16x32_bf16 v[68:71], v[144:147], v[132:135], v[68:71]
    v_mfma_f32_16x16x32_bf16 v[76:79], v[148:151], v[132:135], v[76:79]
    v_mfma_f32_16x16x32_bf16 v[84:87], v[152:155], v[132:135], v[84:87]
    v_mfma_f32_16x16x32_bf16 v[92:95], v[156:159], v[132:135], v[92:95]
    s_waitcnt lgkmcnt(2)
    v_mfma_f32_16x16x32_bf16 v[96:99], v[144:147], v[136:139], v[96:99]
    v_mfma_f32_16x16x32_bf16 v[104:107], v[148:151], v[136:139], v[104:107]
    v_mfma_f32_16x16x32_bf16 v[112:115], v[152:155], v[136:139], v[112:115]
    v_mfma_f32_16x16x32_bf16 v[120:123], v[156:159], v[136:139], v[120:123]
    s_waitcnt lgkmcnt(0)
    v_mfma_f32_16x16x32_bf16 v[100:103], v[144:147], v[140:143], v[100:103]
    v_mfma_f32_16x16x32_bf16 v[108:111], v[148:151], v[140:143], v[108:111]
    v_mfma_f32_16x16x32_bf16 v[116:119], v[152:155], v[140:143], v[116:119]
    v_mfma_f32_16x16x32_bf16 v[124:127], v[156:159], v[140:143], v[124:127]
    v_cvt_pk_bf16_f32 v64, v64, v65
    v_cvt_pk_bf16_f32 v65, v66, v67
    v_cvt_pk_bf16_f32 v66, v68, v69
    v_cvt_pk_bf16_f32 v67, v70, v71
    s_nop 0
    v_permlane32_swap_b32 v64, v66
    v_permlane32_swap_b32 v65, v67
    v_cvt_pk_bf16_f32 v72, v72, v73
    v_cvt_pk_bf16_f32 v73, v74, v75
    v_cvt_pk_bf16_f32 v74, v76, v77
    v_cvt_pk_bf16_f32 v75, v78, v79
    buffer_store_dwordx4 v[64:67], v15, s[12:15], s16 offen offset:0 sc1
    v_permlane32_swap_b32 v72, v74
    v_permlane32_swap_b32 v73, v75
    v_cvt_pk_bf16_f32 v80, v80, v81
    v_cvt_pk_bf16_f32 v81, v82, v83
    v_cvt_pk_bf16_f32 v82, v84, v85
    v_cvt_pk_bf16_f32 v83, v86, v87
    buffer_store_dwordx4 v[72:75], v15, s[12:15], s16 offen offset:2176 sc1
    v_permlane32_swap_b32 v80, v82
    v_permlane32_swap_b32 v81, v83
    v_cvt_pk_bf16_f32 v88, v88, v89
    v_cvt_pk_bf16_f32 v89, v90, v91
    v_cvt_pk_bf16_f32 v90, v92, v93
    v_cvt_pk_bf16_f32 v91, v94, v95
    buffer_store_dwordx4 v[80:83], v15, s[12:15], s17 offen offset:0 sc1
    v_permlane32_swap_b32 v88, v90
    v_permlane32_swap_b32 v89, v91
    v_cvt_pk_bf16_f32 v96, v96, v97
    v_cvt_pk_bf16_f32 v97, v98, v99
    v_cvt_pk_bf16_f32 v98, v100, v101
    v_cvt_pk_bf16_f32 v99, v102, v103
    buffer_store_dwordx4 v[88:91], v15, s[12:15], s17 offen offset:2176 sc1
    v_permlane32_swap_b32 v96, v98
    v_permlane32_swap_b32 v97, v99
    v_cvt_pk_bf16_f32 v104, v104, v105
    v_cvt_pk_bf16_f32 v105, v106, v107
    v_cvt_pk_bf16_f32 v106, v108, v109
    v_cvt_pk_bf16_f32 v107, v110, v111
    buffer_store_dwordx4 v[96:99], v15, s[12:15], s16 offen offset:512 sc1
    v_permlane32_swap_b32 v104, v106
    v_permlane32_swap_b32 v105, v107
    v_cvt_pk_bf16_f32 v112, v112, v113
    v_cvt_pk_bf16_f32 v113, v114, v115
    v_cvt_pk_bf16_f32 v114, v116, v117
    v_cvt_pk_bf16_f32 v115, v118, v119
    s_waitcnt vmcnt(4)
    buffer_store_dwordx4 v[104:107], v15, s[12:15], s16 offen offset:2688 sc1
    v_permlane32_swap_b32 v112, v114
    v_permlane32_swap_b32 v113, v115
    v_cvt_pk_bf16_f32 v120, v120, v121
    v_cvt_pk_bf16_f32 v121, v122, v123
    v_cvt_pk_bf16_f32 v122, v124, v125
    v_cvt_pk_bf16_f32 v123, v126, v127
    s_waitcnt vmcnt(4)
    buffer_store_dwordx4 v[112:115], v15, s[12:15], s17 offen offset:512 sc1
    v_permlane32_swap_b32 v120, v122
    v_permlane32_swap_b32 v121, v123
    s_waitcnt vmcnt(4)
    buffer_store_dwordx4 v[120:123], v15, s[12:15], s17 offen offset:2688 sc1
L_M_g1:
    v_mfma_f32_16x16x16_bf16 v[128:131], v[194:195], v[22:23], 0
    v_mfma_f32_16x16x16_bf16 v[136:139], v[194:195], v[22:23], 0
    v_mfma_f32_16x16x16_bf16 v[132:135], v[196:197], v[22:23], 0
    v_mfma_f32_16x16x16_bf16 v[140:143], v[196:197], v[22:23], 0
    s_lshl_b32 s3, s26, 6
    v_xor_b32 v4, s3, v4
    v_xor_b32 v5, s3, v5
    v_xor_b32 v6, s3, v6
    v_xor_b32 v7, s3, v7
    s_barrier
    ds_read_b64_tr_b16 v[32:33], v4 offset:32768
    ds_read_b64_tr_b16 v[34:35], v4 offset:33792
    ds_read_b128 v[48:51], v24 offset:32768
    ds_read_b128 v[52:55], v24 offset:33024
    ds_read_b128 v[56:59], v25 offset:32768
    ds_read_b128 v[60:63], v25 offset:33024
    ds_read_b64_tr_b16 v[36:37], v5 offset:32768
    ds_read_b64_tr_b16 v[38:39], v5 offset:33792
    ds_read_b64_tr_b16 v[40:41], v6 offset:32768
    ds_read_b64_tr_b16 v[42:43], v6 offset:33792
    ds_read_b64_tr_b16 v[44:45], v7 offset:32768
    ds_read_b64_tr_b16 v[46:47], v7 offset:33792
    s_waitcnt lgkmcnt(6)
    v_mfma_f32_16x16x32_bf16 v[128:131], v[32:35], v[48:51], v[128:131]
    v_mfma_f32_16x16x32_bf16 v[136:139], v[32:35], v[52:55], v[136:139]
    v_mfma_f32_16x16x32_bf16 v[144:147], v[32:35], v[56:59], 0
    v_mfma_f32_16x16x32_bf16 v[152:155], v[32:35], v[60:63], 0
    s_waitcnt lgkmcnt(4)
    v_mfma_f32_16x16x32_bf16 v[132:135], v[36:39], v[48:51], v[132:135]
    v_mfma_f32_16x16x32_bf16 v[140:143], v[36:39], v[52:55], v[140:143]
    v_mfma_f32_16x16x32_bf16 v[148:151], v[36:39], v[56:59], 0
    v_mfma_f32_16x16x32_bf16 v[156:159], v[36:39], v[60:63], 0
    ds_read_b64_tr_b16 v[64:65], v4 offset:40960
    s_waitcnt lgkmcnt(3)
    v_mfma_f32_16x16x32_bf16 v[160:163], v[40:43], v[48:51], 0
    ds_read_b64_tr_b16 v[66:67], v4 offset:41984
    v_mfma_f32_16x16x32_bf16 v[168:171], v[40:43], v[52:55], 0
    ds_read_b128 v[80:83], v24 offset:40960
    v_mfma_f32_16x16x32_bf16 v[176:179], v[40:43], v[56:59], 0
    ds_read_b128 v[84:87], v24 offset:41216
    v_mfma_f32_16x16x32_bf16 v[184:187], v[40:43], v[60:63], 0
    ds_read_b128 v[88:91], v25 offset:40960
    s_waitcnt lgkmcnt(5)
    v_mfma_f32_16x16x32_bf16 v[164:167], v[44:47], v[48:51], 0
    ds_read_b128 v[92:95], v25 offset:41216
    v_mfma_f32_16x16x32_bf16 v[172:175], v[44:47], v[52:55], 0
    ds_read_b64_tr_b16 v[68:69], v5 offset:40960
    v_mfma_f32_16x16x32_bf16 v[180:183], v[44:47], v[56:59], 0
    ds_read_b64_tr_b16 v[70:71], v5 offset:41984
    v_mfma_f32_16x16x32_bf16 v[188:191], v[44:47], v[60:63], 0
    ds_read_b64_tr_b16 v[72:73], v6 offset:40960
    s_waitcnt lgkmcnt(3)
    v_mfma_f32_16x16x32_bf16 v[128:131], v[64:67], v[80:83], v[128:131]
    ds_read_b64_tr_b16 v[74:75], v6 offset:41984
    v_mfma_f32_16x16x32_bf16 v[136:139], v[64:67], v[84:87], v[136:139]
    ds_read_b64_tr_b16 v[76:77], v7 offset:40960
    v_mfma_f32_16x16x32_bf16 v[144:147], v[64:67], v[88:91], v[144:147]
    ds_read_b64_tr_b16 v[78:79], v7 offset:41984
    v_mfma_f32_16x16x32_bf16 v[152:155], v[64:67], v[92:95], v[152:155]
    s_waitcnt lgkmcnt(4)
    v_mfma_f32_16x16x32_bf16 v[132:135], v[68:71], v[80:83], v[132:135]
    v_mfma_f32_16x16x32_bf16 v[140:143], v[68:71], v[84:87], v[140:143]
    v_mfma_f32_16x16x32_bf16 v[148:151], v[68:71], v[88:91], v[148:151]
    v_mfma_f32_16x16x32_bf16 v[156:159], v[68:71], v[92:95], v[156:159]
    s_waitcnt vmcnt(0)
    s_barrier
    ds_read_b64_tr_b16 v[32:33], v4 offset:49152
    s_waitcnt lgkmcnt(3)
    v_mfma_f32_16x16x32_bf16 v[160:163], v[72:75], v[80:83], v[160:163]
    ds_read_b64_tr_b16 v[34:35], v4 offset:50176
    s_cmp_lg_u32 s77, 0
    s_cbranch_scc1 L_nf_16
    s_mov_b64 exec, 255
    buffer_store_dwordx2 v[28:29], v30, s[12:15], 0 offen sc1
    s_mov_b64 exec, -1
L_nf_16:
    v_mfma_f32_16x16x32_bf16 v[168:171], v[72:75], v[84:87], v[168:171]
    ds_read_b128 v[48:51], v24 offset:49152
    v_mfma_f32_16x16x32_bf16 v[176:179], v[72:75], v[88:91], v[176:179]
    ds_read_b128 v[52:55], v24 offset:49408
    v_mfma_f32_16x16x32_bf16 v[184:187], v[72:75], v[92:95], v[184:187]
    ds_read_b128 v[56:59], v25 offset:49152
    s_waitcnt lgkmcnt(5)
    v_mfma_f32_16x16x32_bf16 v[164:167], v[76:79], v[80:83], v[164:167]
    ds_read_b128 v[60:63], v25 offset:49408
    v_mfma_f32_16x16x32_bf16 v[172:175], v[76:79], v[84:87], v[172:175]
    ds_read_b64_tr_b16 v[36:37], v5 offset:49152
    v_mfma_f32_16x16x32_bf16 v[180:183], v[76:79], v[88:91], v[180:183]
    ds_read_b64_tr_b16 v[38:39], v5 offset:50176
    v_mfma_f32_16x16x32_bf16 v[188:191], v[76:79], v[92:95], v[188:191]
    ds_read_b64_tr_b16 v[40:41], v6 offset:49152
    s_waitcnt lgkmcnt(3)
    v_mfma_f32_16x16x32_bf16 v[128:131], v[32:35], v[48:51], v[128:131]
    ds_read_b64_tr_b16 v[42:43], v6 offset:50176
    v_mfma_f32_16x16x32_bf16 v[136:139], v[32:35], v[52:55], v[136:139]
    ds_read_b64_tr_b16 v[44:45], v7 offset:49152
    v_mfma_f32_16x16x32_bf16 v[144:147], v[32:35], v[56:59], v[144:147]
    ds_read_b64_tr_b16 v[46:47], v7 offset:50176
    v_mfma_f32_16x16x32_bf16 v[152:155], v[32:35], v[60:63], v[152:155]
    s_waitcnt lgkmcnt(4)
    v_mfma_f32_16x16x32_bf16 v[132:135], v[36:39], v[48:51], v[132:135]
    v_mfma_f32_16x16x32_bf16 v[140:143], v[36:39], v[52:55], v[140:143]
    v_mfma_f32_16x16x32_bf16 v[148:151], v[36:39], v[56:59], v[148:151]
    v_mfma_f32_16x16x32_bf16 v[156:159], v[36:39], v[60:63], v[156:159]
    ds_read_b64_tr_b16 v[64:65], v4 offset:57344
    s_waitcnt lgkmcnt(3)
    v_mfma_f32_16x16x32_bf16 v[160:163], v[40:43], v[48:51], v[160:163]
    ds_read_b64_tr_b16 v[66:67], v4 offset:58368
    v_mfma_f32_16x16x32_bf16 v[168:171], v[40:43], v[52:55], v[168:171]
    ds_read_b128 v[80:83], v24 offset:57344
    v_mfma_f32_16x16x32_bf16 v[176:179], v[40:43], v[56:59], v[176:179]
    ds_read_b128 v[84:87], v24 offset:57600
    v_mfma_f32_16x16x32_bf16 v[184:187], v[40:43], v[60:63], v[184:187]
    ds_read_b128 v[88:91], v25 offset:57344
    s_waitcnt lgkmcnt(5)
    v_mfma_f32_16x16x32_bf16 v[164:167], v[44:47], v[48:51], v[164:167]
    ds_read_b128 v[92:95], v25 offset:57600
    v_mfma_f32_16x16x32_bf16 v[172:175], v[44:47], v[52:55], v[172:175]
    ds_read_b64_tr_b16 v[68:69], v5 offset:57344
    v_mfma_f32_16x16x32_bf16 v[180:183], v[44:47], v[56:59], v[180:183]
    ds_read_b64_tr_b16 v[70:71], v5 offset:58368
    v_mfma_f32_16x16x32_bf16 v[188:191], v[44:47], v[60:63], v[188:191]
    ds_read_b64_tr_b16 v[72:73], v6 offset:57344
    s_waitcnt lgkmcnt(3)
    v_mfma_f32_16x16x32_bf16 v[128:131], v[64:67], v[80:83], v[128:131]
    ds_read_b64_tr_b16 v[74:75], v6 offset:58368
    v_mfma_f32_16x16x32_bf16 v[136:139], v[64:67], v[84:87], v[136:139]
    ds_read_b64_tr_b16 v[76:77], v7 offset:57344
    v_mfma_f32_16x16x32_bf16 v[144:147], v[64:67], v[88:91], v[144:147]
    ds_read_b64_tr_b16 v[78:79], v7 offset:58368
    v_mfma_f32_16x16x32_bf16 v[152:155], v[64:67], v[92:95], v[152:155]
    s_waitcnt lgkmcnt(4)
    v_mfma_f32_16x16x32_bf16 v[132:135], v[68:71], v[80:83], v[132:135]
    v_mfma_f32_16x16x32_bf16 v[140:143], v[68:71], v[84:87], v[140:143]
    v_mfma_f32_16x16x32_bf16 v[148:151], v[68:71], v[88:91], v[148:151]
    v_mfma_f32_16x16x32_bf16 v[156:159], v[68:71], v[92:95], v[156:159]
    s_barrier
    ds_read_b64_tr_b16 v[32:33], v4 offset:0
    s_waitcnt lgkmcnt(3)
    v_mfma_f32_16x16x32_bf16 v[160:163], v[72:75], v[80:83], v[160:163]
    ds_read_b64_tr_b16 v[34:35], v4 offset:1024
    v_mfma_f32_16x16x32_bf16 v[168:171], v[72:75], v[84:87], v[168:171]
    ds_read_b128 v[48:51], v24 offset:0
    v_mfma_f32_16x16x32_bf16 v[176:179], v[72:75], v[88:91], v[176:179]
    ds_read_b128 v[52:55], v24 offset:256
    v_mfma_f32_16x16x32_bf16 v[184:187], v[72:75], v[92:95], v[184:187]
    ds_read_b128 v[56:59], v25 offset:0
    s_waitcnt lgkmcnt(5)
    v_mfma_f32_16x16x32_bf16 v[164:167], v[76:79], v[80:83], v[164:167]
    ds_read_b128 v[60:63], v25 offset:256
    v_mfma_f32_16x16x32_bf16 v[172:175], v[76:79], v[84:87], v[172:175]
    ds_read_b64_tr_b16 v[36:37], v5 offset:0
    v_mfma_f32_16x16x32_bf16 v[180:183], v[76:79], v[88:91], v[180:183]
    ds_read_b64_tr_b16 v[38:39], v5 offset:1024
    v_mfma_f32_16x16x32_bf16 v[188:191], v[76:79], v[92:95], v[188:191]
    ds_read_b64_tr_b16 v[40:41], v6 offset:0
    s_waitcnt lgkmcnt(3)
    v_mfma_f32_16x16x32_bf16 v[128:131], v[32:35], v[48:51], v[128:131]
    ds_read_b64_tr_b16 v[42:43], v6 offset:1024
    v_mfma_f32_16x16x32_bf16 v[136:139], v[32:35], v[52:55], v[136:139]
    ds_read_b64_tr_b16 v[44:45], v7 offset:0
    v_mfma_f32_16x16x32_bf16 v[144:147], v[32:35], v[56:59], v[144:147]
    ds_read_b64_tr_b16 v[46:47], v7 offset:1024
    v_mfma_f32_16x16x32_bf16 v[152:155], v[32:35], v[60:63], v[152:155]
    s_waitcnt lgkmcnt(4)
    v_mfma_f32_16x16x32_bf16 v[132:135], v[36:39], v[48:51], v[132:135]
    v_mfma_f32_16x16x32_bf16 v[140:143], v[36:39], v[52:55], v[140:143]
    v_mfma_f32_16x16x32_bf16 v[148:151], v[36:39], v[56:59], v[148:151]
    v_mfma_f32_16x16x32_bf16 v[156:159], v[36:39], v[60:63], v[156:159]
    ds_read_b64_tr_b16 v[64:65], v4 offset:8192
    s_waitcnt lgkmcnt(3)
    v_mfma_f32_16x16x32_bf16 v[160:163], v[40:43], v[48:51], v[160:163]
    ds_read_b64_tr_b16 v[66:67], v4 offset:9216
    v_mfma_f32_16x16x32_bf16 v[168:171], v[40:43], v[52:55], v[168:171]
    ds_read_b128 v[80:83], v24 offset:8192
    v_mfma_f32_16x16x32_bf16 v[176:179], v[40:43], v[56:59], v[176:179]
    ds_read_b128 v[84:87], v24 offset:8448
    v_mfma_f32_16x16x32_bf16 v[184:187], v[40:43], v[60:63], v[184:187]
    ds_read_b128 v[88:91], v25 offset:8192
    s_waitcnt lgkmcnt(5)
    v_mfma_f32_16x16x32_bf16 v[164:167], v[44:47], v[48:51], v[164:167]
    ds_read_b128 v[92:95], v25 offset:8448
    v_mfma_f32_16x16x32_bf16 v[172:175], v[44:47], v[52:55], v[172:175]
    ds_read_b64_tr_b16 v[68:69], v5 offset:8192
    v_mfma_f32_16x16x32_bf16 v[180:183], v[44:47], v[56:59], v[180:183]
    ds_read_b64_tr_b16 v[70:71], v5 offset:9216
    v_mfma_f32_16x16x32_bf16 v[188:191], v[44:47], v[60:63], v[188:191]
    ds_read_b64_tr_b16 v[72:73], v6 offset:8192
    s_waitcnt lgkmcnt(3)
    v_mfma_f32_16x16x32_bf16 v[128:131], v[64:67], v[80:83], v[128:131]
    ds_read_b64_tr_b16 v[74:75], v6 offset:9216
    v_mfma_f32_16x16x32_bf16 v[136:139], v[64:67], v[84:87], v[136:139]
    ds_read_b64_tr_b16 v[76:77], v7 offset:8192
    v_mfma_f32_16x16x32_bf16 v[144:147], v[64:67], v[88:91], v[144:147]
    ds_read_b64_tr_b16 v[78:79], v7 offset:9216
    v_mfma_f32_16x16x32_bf16 v[152:155], v[64:67], v[92:95], v[152:155]
    s_waitcnt lgkmcnt(4)
    v_mfma_f32_16x16x32_bf16 v[132:135], v[68:71], v[80:83], v[132:135]
    v_mfma_f32_16x16x32_bf16 v[140:143], v[68:71], v[84:87], v[140:143]
    v_mfma_f32_16x16x32_bf16 v[148:151], v[68:71], v[88:91], v[148:151]
    v_mfma_f32_16x16x32_bf16 v[156:159], v[68:71], v[92:95], v[156:159]
    s_barrier
    ds_read_b64_tr_b16 v[32:33], v4 offset:16384
    s_waitcnt lgkmcnt(3)
    v_mfma_f32_16x16x32_bf16 v[160:163], v[72:75], v[80:83], v[160:163]
    ds_read_b64_tr_b16 v[34:35], v4 offset:17408
    v_mfma_f32_16x16x32_bf16 v[168:171], v[72:75], v[84:87], v[168:171]
    ds_read_b128 v[48:51], v24 offset:16384
    v_mfma_f32_16x16x32_bf16 v[176:179], v[72:75], v[88:91], v[176:179]
    ds_read_b128 v[52:55], v24 offset:16640
    v_mfma_f32_16x16x32_bf16 v[184:187], v[72:75], v[92:95], v[184:187]
    ds_read_b128 v[56:59], v25 offset:16384
    s_waitcnt lgkmcnt(5)
    v_mfma_f32_16x16x32_bf16 v[164:167], v[76:79], v[80:83], v[164:167]
    ds_read_b128 v[60:63], v25 offset:16640
    v_mfma_f32_16x16x32_bf16 v[172:175], v[76:79], v[84:87], v[172:175]
    ds_read_b64_tr_b16 v[36:37], v5 offset:16384
    v_mfma_f32_16x16x32_bf16 v[180:183], v[76:79], v[88:91], v[180:183]
    ds_read_b64_tr_b16 v[38:39], v5 offset:17408
    v_mfma_f32_16x16x32_bf16 v[188:191], v[76:79], v[92:95], v[188:191]
    ds_read_b64_tr_b16 v[40:41], v6 offset:16384
    s_waitcnt lgkmcnt(3)
    v_mfma_f32_16x16x32_bf16 v[128:131], v[32:35], v[48:51], v[128:131]
    ds_read_b64_tr_b16 v[42:43], v6 offset:17408
    v_mfma_f32_16x16x32_bf16 v[136:139], v[32:35], v[52:55], v[136:139]
    ds_read_b64_tr_b16 v[44:45], v7 offset:16384
    v_mfma_f32_16x16x32_bf16 v[144:147], v[32:35], v[56:59], v[144:147]
    ds_read_b64_tr_b16 v[46:47], v7 offset:17408
    v_mfma_f32_16x16x32_bf16 v[152:155], v[32:35], v[60:63], v[152:155]
    s_waitcnt lgkmcnt(4)
    v_mfma_f32_16x16x32_bf16 v[132:135], v[36:39], v[48:51], v[132:135]
    v_mfma_f32_16x16x32_bf16 v[140:143], v[36:39], v[52:55], v[140:143]
    v_mfma_f32_16x16x32_bf16 v[148:151], v[36:39], v[56:59], v[148:151]
    v_mfma_f32_16x16x32_bf16 v[156:159], v[36:39], v[60:63], v[156:159]
    ds_read_b64_tr_b16 v[64:65], v4 offset:24576
    s_waitcnt lgkmcnt(3)
    v_mfma_f32_16x16x32_bf16 v[160:163], v[40:43], v[48:51], v[160:163]
    ds_read_b64_tr_b16 v[66:67], v4 offset:25600
    v_mfma_f32_16x16x32_bf16 v[168:171], v[40:43], v[52:55], v[168:171]
    ds_read_b128 v[80:83], v24 offset:24576
    v_mfma_f32_16x16x32_bf16 v[176:179], v[40:43], v[56:59], v[176:179]
    ds_read_b128 v[84:87], v24 offset:24832
    v_mfma_f32_16x16x32_bf16 v[184:187], v[40:43], v[60:63], v[184:187]
    ds_read_b128 v[88:91], v25 offset:24576
    s_waitcnt lgkmcnt(5)
    v_mfma_f32_16x16x32_bf16 v[164:167], v[44:47], v[48:51], v[164:167]
    ds_read_b128 v[92:95], v25 offset:24832
    v_mfma_f32_16x16x32_bf16 v[172:175], v[44:47], v[52:55], v[172:175]
    ds_read_b64_tr_b16 v[68:69], v5 offset:24576
    v_mfma_f32_16x16x32_bf16 v[180:183], v[44:47], v[56:59], v[180:183]
    ds_read_b64_tr_b16 v[70:71], v5 offset:25600
    v_mfma_f32_16x16x32_bf16 v[188:191], v[44:47], v[60:63], v[188:191]
    ds_read_b64_tr_b16 v[72:73], v6 offset:24576
    s_waitcnt lgkmcnt(3)
    v_mfma_f32_16x16x32_bf16 v[128:131], v[64:67], v[80:83], v[128:131]
    ds_read_b64_tr_b16 v[74:75], v6 offset:25600
    v_mfma_f32_16x16x32_bf16 v[136:139], v[64:67], v[84:87], v[136:139]
    ds_read_b64_tr_b16 v[76:77], v7 offset:24576
    v_mfma_f32_16x16x32_bf16 v[144:147], v[64:67], v[88:91], v[144:147]
    ds_read_b64_tr_b16 v[78:79], v7 offset:25600
    v_mfma_f32_16x16x32_bf16 v[152:155], v[64:67], v[92:95], v[152:155]
    s_waitcnt lgkmcnt(4)
    v_mfma_f32_16x16x32_bf16 v[132:135], v[68:71], v[80:83], v[132:135]
    v_mfma_f32_16x16x32_bf16 v[140:143], v[68:71], v[84:87], v[140:143]
    v_mfma_f32_16x16x32_bf16 v[148:151], v[68:71], v[88:91], v[148:151]
    v_mfma_f32_16x16x32_bf16 v[156:159], v[68:71], v[92:95], v[156:159]
    s_barrier
    ds_read_b64_tr_b16 v[32:33], v4 offset:32768
    s_waitcnt lgkmcnt(3)
    v_mfma_f32_16x16x32_bf16 v[160:163], v[72:75], v[80:83], v[160:163]
    ds_read_b64_tr_b16 v[34:35], v4 offset:33792
    v_mfma_f32_16x16x32_bf16 v[168:171], v[72:75], v[84:87], v[168:171]
    ds_read_b128 v[48:51], v24 offset:32768
    v_mfma_f32_16x16x32_bf16 v[176:179], v[72:75], v[88:91], v[176:179]
    ds_read_b128 v[52:55], v24 offset:33024
    v_mfma_f32_16x16x32_bf16 v[184:187], v[72:75], v[92:95], v[184:187]
    ds_read_b128 v[56:59], v25 offset:32768
    s_waitcnt lgkmcnt(5)
    v_mfma_f32_16x16x32_bf16 v[164:167], v[76:79], v[80:83], v[164:167]
    ds_read_b128 v[60:63], v25 offset:33024
    v_mfma_f32_16x16x32_bf16 v[172:175], v[76:79], v[84:87], v[172:175]
    ds_read_b64_tr_b16 v[36:37], v5 offset:32768
    v_mfma_f32_16x16x32_bf16 v[180:183], v[76:79], v[88:91], v[180:183]
    ds_read_b64_tr_b16 v[38:39], v5 offset:33792
    v_mfma_f32_16x16x32_bf16 v[188:191], v[76:79], v[92:95], v[188:191]
    ds_read_b64_tr_b16 v[40:41], v6 offset:32768
    s_waitcnt lgkmcnt(3)
    v_mfma_f32_16x16x32_bf16 v[128:131], v[32:35], v[48:51], v[128:131]
    ds_read_b64_tr_b16 v[42:43], v6 offset:33792
    v_mfma_f32_16x16x32_bf16 v[136:139], v[32:35], v[52:55], v[136:139]
    ds_read_b64_tr_b16 v[44:45], v7 offset:32768
    v_mfma_f32_16x16x32_bf16 v[144:147], v[32:35], v[56:59], v[144:147]
    ds_read_b64_tr_b16 v[46:47], v7 offset:33792
    v_mfma_f32_16x16x32_bf16 v[152:155], v[32:35], v[60:63], v[152:155]
    s_waitcnt lgkmcnt(4)
    v_mfma_f32_16x16x32_bf16 v[132:135], v[36:39], v[48:51], v[132:135]
    v_mfma_f32_16x16x32_bf16 v[140:143], v[36:39], v[52:55], v[140:143]
    v_mfma_f32_16x16x32_bf16 v[148:151], v[36:39], v[56:59], v[148:151]
    v_mfma_f32_16x16x32_bf16 v[156:159], v[36:39], v[60:63], v[156:159]
    ds_read_b64_tr_b16 v[64:65], v4 offset:40960
    s_waitcnt lgkmcnt(3)
    v_mfma_f32_16x16x32_bf16 v[160:163], v[40:43], v[48:51], v[160:163]
    ds_read_b64_tr_b16 v[66:67], v4 offset:41984
    v_mfma_f32_16x16x32_bf16 v[168:171], v[40:43], v[52:55], v[168:171]
    ds_read_b128 v[80:83], v24 offset:40960
    v_mfma_f32_16x16x32_bf16 v[176:179], v[40:43], v[56:59], v[176:179]
    ds_read_b128 v[84:87], v24 offset:41216
    v_mfma_f32_16x16x32_bf16 v[184:187], v[40:43], v[60:63], v[184:187]
    ds_read_b128 v[88:91], v25 offset:40960
    s_waitcnt lgkmcnt(5)
    v_mfma_f32_16x16x32_bf16 v[164:167], v[44:47], v[48:51], v[164:167]
    ds_read_b128 v[92:95], v25 offset:41216
    v_mfma_f32_16x16x32_bf16 v[172:175], v[44:47], v[52:55], v[172:175]
    ds_read_b64_tr_b16 v[68:69], v5 offset:40960
    v_mfma_f32_16x16x32_bf16 v[180:183], v[44:47], v[56:59], v[180:183]
    ds_read_b64_tr_b16 v[70:71], v5 offset:41984
    v_mfma_f32_16x16x32_bf16 v[188:191], v[44:47], v[60:63], v[188:191]
    ds_read_b64_tr_b16 v[72:73], v6 offset:40960
    s_waitcnt lgkmcnt(3)
    v_mfma_f32_16x16x32_bf16 v[128:131], v[64:67], v[80:83], v[128:131]
    ds_read_b64_tr_b16 v[74:75], v6 offset:41984
    v_mfma_f32_16x16x32_bf16 v[136:139], v[64:67], v[84:87], v[136:139]
    ds_read_b64_tr_b16 v[76:77], v7 offset:40960
    v_mfma_f32_16x16x32_bf16 v[144:147], v[64:67], v[88:91], v[144:147]
    ds_read_b64_tr_b16 v[78:79], v7 offset:41984
    v_mfma_f32_16x16x32_bf16 v[152:155], v[64:67], v[92:95], v[152:155]
    s_waitcnt lgkmcnt(4)
    v_mfma_f32_16x16x32_bf16 v[132:135], v[68:71], v[80:83], v[132:135]
    v_mfma_f32_16x16x32_bf16 v[140:143], v[68:71], v[84:87], v[140:143]
    v_mfma_f32_16x16x32_bf16 v[148:151], v[68:71], v[88:91], v[148:151]
    v_mfma_f32_16x16x32_bf16 v[156:159], v[68:71], v[92:95], v[156:159]
    s_barrier
    ds_read_b64_tr_b16 v[32:33], v4 offset:49152
    s_waitcnt lgkmcnt(3)
    v_mfma_f32_16x16x32_bf16 v[160:163], v[72:75], v[80:83], v[160:163]
    ds_read_b64_tr_b16 v[34:35], v4 offset:50176
    v_mfma_f32_16x16x32_bf16 v[168:171], v[72:75], v[84:87], v[168:171]
    ds_read_b128 v[48:51], v24 offset:49152
    v_mfma_f32_16x16x32_bf16 v[176:179], v[72:75], v[88:91], v[176:179]
    ds_read_b128 v[52:55], v24 offset:49408
    v_mfma_f32_16x16x32_bf16 v[184:187], v[72:75], v[92:95], v[184:187]
    ds_read_b128 v[56:59], v25 offset:49152
    s_waitcnt lgkmcnt(5)
    v_mfma_f32_16x16x32_bf16 v[164:167], v[76:79], v[80:83], v[164:167]
    ds_read_b128 v[60:63], v25 offset:49408
    v_mfma_f32_16x16x32_bf16 v[172:175], v[76:79], v[84:87], v[172:175]
    ds_read_b64_tr_b16 v[36:37], v5 offset:49152
    v_mfma_f32_16x16x32_bf16 v[180:183], v[76:79], v[88:91], v[180:183]
    ds_read_b64_tr_b16 v[38:39], v5 offset:50176
    v_mfma_f32_16x16x32_bf16 v[188:191], v[76:79], v[92:95], v[188:191]
    ds_read_b64_tr_b16 v[40:41], v6 offset:49152
    s_waitcnt lgkmcnt(3)
    v_mfma_f32_16x16x32_bf16 v[128:131], v[32:35], v[48:51], v[128:131]
    ds_read_b64_tr_b16 v[42:43], v6 offset:50176
    v_mfma_f32_16x16x32_bf16 v[136:139], v[32:35], v[52:55], v[136:139]
    ds_read_b64_tr_b16 v[44:45], v7 offset:49152
    v_mfma_f32_16x16x32_bf16 v[144:147], v[32:35], v[56:59], v[144:147]
    ds_read_b64_tr_b16 v[46:47], v7 offset:50176
    v_mfma_f32_16x16x32_bf16 v[152:155], v[32:35], v[60:63], v[152:155]
    s_waitcnt lgkmcnt(4)
    v_mfma_f32_16x16x32_bf16 v[132:135], v[36:39], v[48:51], v[132:135]
    v_mfma_f32_16x16x32_bf16 v[140:143], v[36:39], v[52:55], v[140:143]
    v_mfma_f32_16x16x32_bf16 v[148:151], v[36:39], v[56:59], v[148:151]
    v_mfma_f32_16x16x32_bf16 v[156:159], v[36:39], v[60:63], v[156:159]
    ds_read_b64_tr_b16 v[64:65], v4 offset:57344
    s_waitcnt lgkmcnt(3)
    v_mfma_f32_16x16x32_bf16 v[160:163], v[40:43], v[48:51], v[160:163]
    ds_read_b64_tr_b16 v[66:67], v4 offset:58368
    v_mfma_f32_16x16x32_bf16 v[168:171], v[40:43], v[52:55], v[168:171]
    ds_read_b128 v[80:83], v24 offset:57344
    v_mfma_f32_16x16x32_bf16 v[176:179], v[40:43], v[56:59], v[176:179]
    ds_read_b128 v[84:87], v24 offset:57600
    v_mfma_f32_16x16x32_bf16 v[184:187], v[40:43], v[60:63], v[184:187]
    ds_read_b128 v[88:91], v25 offset:57344
    s_waitcnt lgkmcnt(5)
    v_mfma_f32_16x16x32_bf16 v[164:167], v[44:47], v[48:51], v[164:167]
    ds_read_b128 v[92:95], v25 offset:57600
    v_mfma_f32_16x16x32_bf16 v[172:175], v[44:47], v[52:55], v[172:175]
    ds_read_b64_tr_b16 v[68:69], v5 offset:57344
    v_mfma_f32_16x16x32_bf16 v[180:183], v[44:47], v[56:59], v[180:183]
    ds_read_b64_tr_b16 v[70:71], v5 offset:58368
    v_mfma_f32_16x16x32_bf16 v[188:191], v[44:47], v[60:63], v[188:191]
    ds_read_b64_tr_b16 v[72:73], v6 offset:57344
    s_waitcnt lgkmcnt(3)
    v_mfma_f32_16x16x32_bf16 v[128:131], v[64:67], v[80:83], v[128:131]
    ds_read_b64_tr_b16 v[74:75], v6 offset:58368
    v_mfma_f32_16x16x32_bf16 v[136:139], v[64:67], v[84:87], v[136:139]
    ds_read_b64_tr_b16 v[76:77], v7 offset:57344
    v_mfma_f32_16x16x32_bf16 v[144:147], v[64:67], v[88:91], v[144:147]
    ds_read_b64_tr_b16 v[78:79], v7 offset:58368
    v_mfma_f32_16x16x32_bf16 v[152:155], v[64:67], v[92:95], v[152:155]
    s_waitcnt lgkmcnt(4)
    v_mfma_f32_16x16x32_bf16 v[132:135], v[68:71], v[80:83], v[132:135]
    v_mfma_f32_16x16x32_bf16 v[140:143], v[68:71], v[84:87], v[140:143]
    v_mfma_f32_16x16x32_bf16 v[148:151], v[68:71], v[88:91], v[148:151]
    v_mfma_f32_16x16x32_bf16 v[156:159], v[68:71], v[92:95], v[156:159]
    s_barrier
    ds_read_b64_tr_b16 v[32:33], v4 offset:0
    s_waitcnt lgkmcnt(3)
    v_mfma_f32_16x16x32_bf16 v[160:163], v[72:75], v[80:83], v[160:163]
    ds_read_b64_tr_b16 v[34:35], v4 offset:1024
    v_mfma_f32_16x16x32_bf16 v[168:171], v[72:75], v[84:87], v[168:171]
    ds_read_b128 v[48:51], v24 offset:0
    v_mfma_f32_16x16x32_bf16 v[176:179], v[72:75], v[88:91], v[176:179]
    ds_read_b128 v[52:55], v24 offset:256
    v_mfma_f32_16x16x32_bf16 v[184:187], v[72:75], v[92:95], v[184:187]
    ds_read_b128 v[56:59], v25 offset:0
    s_waitcnt lgkmcnt(5)
    v_mfma_f32_16x16x32_bf16 v[164:167], v[76:79], v[80:83], v[164:167]
    ds_read_b128 v[60:63], v25 offset:256
    v_mfma_f32_16x16x32_bf16 v[172:175], v[76:79], v[84:87], v[172:175]
    ds_read_b64_tr_b16 v[36:37], v5 offset:0
    v_mfma_f32_16x16x32_bf16 v[180:183], v[76:79], v[88:91], v[180:183]
    ds_read_b64_tr_b16 v[38:39], v5 offset:1024
    v_mfma_f32_16x16x32_bf16 v[188:191], v[76:79], v[92:95], v[188:191]
    ds_read_b64_tr_b16 v[40:41], v6 offset:0
    s_waitcnt lgkmcnt(3)
    v_mfma_f32_16x16x32_bf16 v[128:131], v[32:35], v[48:51], v[128:131]
    ds_read_b64_tr_b16 v[42:43], v6 offset:1024
    v_mfma_f32_16x16x32_bf16 v[136:139], v[32:35], v[52:55], v[136:139]
    ds_read_b64_tr_b16 v[44:45], v7 offset:0
    v_mfma_f32_16x16x32_bf16 v[144:147], v[32:35], v[56:59], v[144:147]
    ds_read_b64_tr_b16 v[46:47], v7 offset:1024
    v_mfma_f32_16x16x32_bf16 v[152:155], v[32:35], v[60:63], v[152:155]
    s_waitcnt lgkmcnt(4)
    v_mfma_f32_16x16x32_bf16 v[132:135], v[36:39], v[48:51], v[132:135]
    v_mfma_f32_16x16x32_bf16 v[140:143], v[36:39], v[52:55], v[140:143]
    v_mfma_f32_16x16x32_bf16 v[148:151], v[36:39], v[56:59], v[148:151]
    v_mfma_f32_16x16x32_bf16 v[156:159], v[36:39], v[60:63], v[156:159]
    ds_read_b64_tr_b16 v[64:65], v4 offset:8192
    s_waitcnt lgkmcnt(3)
    v_mfma_f32_16x16x32_bf16 v[160:163], v[40:43], v[48:51], v[160:163]
    ds_read_b64_tr_b16 v[66:67], v4 offset:9216
    v_mfma_f32_16x16x32_bf16 v[168:171], v[40:43], v[52:55], v[168:171]
    ds_read_b128 v[80:83], v24 offset:8192
    v_mfma_f32_16x16x32_bf16 v[176:179], v[40:43], v[56:59], v[176:179]
    ds_read_b128 v[84:87], v24 offset:8448
    v_mfma_f32_16x16x32_bf16 v[184:187], v[40:43], v[60:63], v[184:187]
    ds_read_b128 v[88:91], v25 offset:8192
    s_waitcnt lgkmcnt(5)
    v_mfma_f32_16x16x32_bf16 v[164:167], v[44:47], v[48:51], v[164:167]
    ds_read_b128 v[92:95], v25 offset:8448
    v_mfma_f32_16x16x32_bf16 v[172:175], v[44:47], v[52:55], v[172:175]
    ds_read_b64_tr_b16 v[68:69], v5 offset:8192
    v_mfma_f32_16x16x32_bf16 v[180:183], v[44:47], v[56:59], v[180:183]
    ds_read_b64_tr_b16 v[70:71], v5 offset:9216
    v_mfma_f32_16x16x32_bf16 v[188:191], v[44:47], v[60:63], v[188:191]
    ds_read_b64_tr_b16 v[72:73], v6 offset:8192
    s_waitcnt lgkmcnt(3)
    v_mfma_f32_16x16x32_bf16 v[128:131], v[64:67], v[80:83], v[128:131]
    ds_read_b64_tr_b16 v[74:75], v6 offset:9216
    v_mfma_f32_16x16x32_bf16 v[136:139], v[64:67], v[84:87], v[136:139]
    ds_read_b64_tr_b16 v[76:77], v7 offset:8192
    v_mfma_f32_16x16x32_bf16 v[144:147], v[64:67], v[88:91], v[144:147]
    ds_read_b64_tr_b16 v[78:79], v7 offset:9216
    v_mfma_f32_16x16x32_bf16 v[152:155], v[64:67], v[92:95], v[152:155]
    s_waitcnt lgkmcnt(4)
    v_mfma_f32_16x16x32_bf16 v[132:135], v[68:71], v[80:83], v[132:135]
    v_mfma_f32_16x16x32_bf16 v[140:143], v[68:71], v[84:87], v[140:143]
    v_mfma_f32_16x16x32_bf16 v[148:151], v[68:71], v[88:91], v[148:151]
    v_mfma_f32_16x16x32_bf16 v[156:159], v[68:71], v[92:95], v[156:159]
    s_barrier
    ds_read_b64_tr_b16 v[32:33], v4 offset:16384
    s_waitcnt lgkmcnt(3)
    v_mfma_f32_16x16x32_bf16 v[160:163], v[72:75], v[80:83], v[160:163]
    ds_read_b64_tr_b16 v[34:35], v4 offset:17408
    v_mfma_f32_16x16x32_bf16 v[168:171], v[72:75], v[84:87], v[168:171]
    ds_read_b128 v[48:51], v24 offset:16384
    v_mfma_f32_16x16x32_bf16 v[176:179], v[72:75], v[88:91], v[176:179]
    ds_read_b128 v[52:55], v24 offset:16640
    v_mfma_f32_16x16x32_bf16 v[184:187], v[72:75], v[92:95], v[184:187]
    ds_read_b128 v[56:59], v25 offset:16384
    s_waitcnt lgkmcnt(5)
    v_mfma_f32_16x16x32_bf16 v[164:167], v[76:79], v[80:83], v[164:167]
    ds_read_b128 v[60:63], v25 offset:16640
    v_mfma_f32_16x16x32_bf16 v[172:175], v[76:79], v[84:87], v[172:175]
    ds_read_b64_tr_b16 v[36:37], v5 offset:16384
    v_mfma_f32_16x16x32_bf16 v[180:183], v[76:79], v[88:91], v[180:183]
    ds_read_b64_tr_b16 v[38:39], v5 offset:17408
    v_mfma_f32_16x16x32_bf16 v[188:191], v[76:79], v[92:95], v[188:191]
    ds_read_b64_tr_b16 v[40:41], v6 offset:16384
    s_waitcnt lgkmcnt(3)
    v_mfma_f32_16x16x32_bf16 v[128:131], v[32:35], v[48:51], v[128:131]
    ds_read_b64_tr_b16 v[42:43], v6 offset:17408
    v_mfma_f32_16x16x32_bf16 v[136:139], v[32:35], v[52:55], v[136:139]
    ds_read_b64_tr_b16 v[44:45], v7 offset:16384
    v_mfma_f32_16x16x32_bf16 v[144:147], v[32:35], v[56:59], v[144:147]
    ds_read_b64_tr_b16 v[46:47], v7 offset:17408
    v_mfma_f32_16x16x32_bf16 v[152:155], v[32:35], v[60:63], v[152:155]
    s_waitcnt lgkmcnt(4)
    v_mfma_f32_16x16x32_bf16 v[132:135], v[36:39], v[48:51], v[132:135]
    v_mfma_f32_16x16x32_bf16 v[140:143], v[36:39], v[52:55], v[140:143]
    v_mfma_f32_16x16x32_bf16 v[148:151], v[36:39], v[56:59], v[148:151]
    v_mfma_f32_16x16x32_bf16 v[156:159], v[36:39], v[60:63], v[156:159]
    ds_read_b64_tr_b16 v[64:65], v4 offset:24576
    s_waitcnt lgkmcnt(3)
    v_mfma_f32_16x16x32_bf16 v[160:163], v[40:43], v[48:51], v[160:163]
    ds_read_b64_tr_b16 v[66:67], v4 offset:25600
    v_mfma_f32_16x16x32_bf16 v[168:171], v[40:43], v[52:55], v[168:171]
    ds_read_b128 v[80:83], v24 offset:24576
    v_mfma_f32_16x16x32_bf16 v[176:179], v[40:43], v[56:59], v[176:179]
    ds_read_b128 v[84:87], v24 offset:24832
    v_mfma_f32_16x16x32_bf16 v[184:187], v[40:43], v[60:63], v[184:187]
    ds_read_b128 v[88:91], v25 offset:24576
    s_waitcnt lgkmcnt(5)
    v_mfma_f32_16x16x32_bf16 v[164:167], v[44:47], v[48:51], v[164:167]
    ds_read_b128 v[92:95], v25 offset:24832
    v_mfma_f32_16x16x32_bf16 v[172:175], v[44:47], v[52:55], v[172:175]
    ds_read_b64_tr_b16 v[68:69], v5 offset:24576
    v_mfma_f32_16x16x32_bf16 v[180:183], v[44:47], v[56:59], v[180:183]
    ds_read_b64_tr_b16 v[70:71], v5 offset:25600
    v_mfma_f32_16x16x32_bf16 v[188:191], v[44:47], v[60:63], v[188:191]
    ds_read_b64_tr_b16 v[72:73], v6 offset:24576
    s_waitcnt lgkmcnt(3)
    v_mfma_f32_16x16x32_bf16 v[128:131], v[64:67], v[80:83], v[128:131]
    ds_read_b64_tr_b16 v[74:75], v6 offset:25600
    v_mfma_f32_16x16x32_bf16 v[136:139], v[64:67], v[84:87], v[136:139]
    ds_read_b64_tr_b16 v[76:77], v7 offset:24576
    v_mfma_f32_16x16x32_bf16 v[144:147], v[64:67], v[88:91], v[144:147]
    ds_read_b64_tr_b16 v[78:79], v7 offset:25600
    v_mfma_f32_16x16x32_bf16 v[152:155], v[64:67], v[92:95], v[152:155]
    s_waitcnt lgkmcnt(4)
    v_mfma_f32_16x16x32_bf16 v[132:135], v[68:71], v[80:83], v[132:135]
    v_mfma_f32_16x16x32_bf16 v[140:143], v[68:71], v[84:87], v[140:143]
    v_mfma_f32_16x16x32_bf16 v[148:151], v[68:71], v[88:91], v[148:151]
    v_mfma_f32_16x16x32_bf16 v[156:159], v[68:71], v[92:95], v[156:159]
    s_waitcnt lgkmcnt(2)
    v_mfma_f32_16x16x32_bf16 v[160:163], v[72:75], v[80:83], v[160:163]
    v_mfma_f32_16x16x32_bf16 v[168:171], v[72:75], v[84:87], v[168:171]
    v_mfma_f32_16x16x32_bf16 v[176:179], v[72:75], v[88:91], v[176:179]
    v_mfma_f32_16x16x32_bf16 v[184:187], v[72:75], v[92:95], v[184:187]
    s_waitcnt lgkmcnt(0)
    s_mov_b64 exec, 1
    ds_add_u32 v254, v255 offset:0
    s_mov_b64 exec, -1
    v_mfma_f32_16x16x32_bf16 v[164:167], v[76:79], v[80:83], v[164:167]
    v_mfma_f32_16x16x32_bf16 v[172:175], v[76:79], v[84:87], v[172:175]
    v_mfma_f32_16x16x32_bf16 v[180:183], v[76:79], v[88:91], v[180:183]
    v_mfma_f32_16x16x32_bf16 v[188:191], v[76:79], v[92:95], v[188:191]
    v_cvt_pk_bf16_f32 v144, v144, v145
    v_cvt_pk_bf16_f32 v145, v146, v147
    v_cvt_pk_bf16_f32 v146, v148, v149
    v_cvt_pk_bf16_f32 v147, v150, v151
    v_cvt_pk_bf16_f32 v148, v152, v153
    v_cvt_pk_bf16_f32 v149, v154, v155
    v_cvt_pk_bf16_f32 v150, v156, v157
    v_cvt_pk_bf16_f32 v151, v158, v159
    v_cvt_pk_bf16_f32 v176, v176, v177
    v_cvt_pk_bf16_f32 v177, v178, v179
    v_cvt_pk_bf16_f32 v178, v180, v181
    v_cvt_pk_bf16_f32 v179, v182, v183
    v_cvt_pk_bf16_f32 v180, v184, v185
    v_cvt_pk_bf16_f32 v181, v186, v187
    v_cvt_pk_bf16_f32 v182, v188, v189
    v_cvt_pk_bf16_f32 v183, v190, v191
    v_cvt_pk_bf16_f32 v160, v160, v161
    v_cvt_pk_bf16_f32 v161, v162, v163
    v_cvt_pk_bf16_f32 v162, v164, v165
    v_cvt_pk_bf16_f32 v163, v166, v167
    v_cvt_pk_bf16_f32 v164, v168, v169
    v_cvt_pk_bf16_f32 v165, v170, v171
    v_cvt_pk_bf16_f32 v166, v172, v173
    v_cvt_pk_bf16_f32 v167, v174, v175
    s_setprio 3
    s_mul_i32 s16, s36, 5
    s_add_u32 s16, s16, s37
    s_lshl_b32 s16, s16, 2
    v_lshlrev_b32 v10, 4, v1
    s_add_u32 s17, s16, s22
    s_lshl_b32 s17, s17, 2
    s_add_u32 s17, s17, s77
    s_lshl_b32 s3, s16, 2
    s_add_u32 s3, s3, s77
    s_lshl_b32 s3, s3, 6
    s_add_u32 s3, s3, 32768
    v_and_b32 v11, 3, v1
    v_max_u32 v11, 1, v11
    v_xor_b32 v11, s22, v11
    v_lshl_add_u32 v11, v11, 8, s3
    s_mov_b32 s82, 262144
L_lw_17:
    ds_read_b32 v16, v254 offset:0
    s_waitcnt lgkmcnt(0)
    v_readfirstlane_b32 s3, v16
    s_nop 0
    s_cmp_ge_u32 s3, 8
    s_cbranch_scc1 L_lwd_18
    s_sleep 2
    s_sub_u32 s82, s82, 1
    s_cmp_lg_u32 s82, 0
    s_cbranch_scc1 L_lw_17
L_lwd_18:
    s_setprio 0
    s_xor_b32 s3, s22, 1
    s_add_u32 s3, s3, s16
    s_lshl_b32 s3, s3, 2
    s_add_u32 s3, s3, s77
    s_mul_i32 s3, s3, 6144
    s_add_u32 s3, s3, 15990784
    buffer_store_dwordx4 v[144:147], v10, s[12:15], s3 offen offset:0 sc1
    buffer_store_dwordx4 v[148:151], v10, s[12:15], s3 offen offset:1024 sc1
    s_xor_b32 s3, s22, 3
    s_add_u32 s3, s3, s16
    s_lshl_b32 s3, s3, 2
    s_add_u32 s3, s3, s77
    s_mul_i32 s3, s3, 6144
    s_add_u32 s3, s3, 15994880
    buffer_store_dwordx4 v[176:179], v10, s[12:15], s3 offen offset:0 sc1
    buffer_store_dwordx4 v[180:183], v10, s[12:15], s3 offen offset:1024 sc1
    s_xor_b32 s3, s22, 2
    s_add_u32 s3, s3, s16
    s_lshl_b32 s3, s3, 2
    s_add_u32 s3, s3, s77
    s_mul_i32 s3, s3, 6144
    s_add_u32 s3, s3, 15992832
    buffer_store_dwordx4 v[160:163], v10, s[12:15], s3 offen offset:0 sc1
    buffer_store_dwordx4 v[164:167], v10, s[12:15], s3 offen offset:1024 sc1
    s_lshl_b32 s85, s17, 6
    s_add_u32 s85, s85, 32768
    s_waitcnt vmcnt(0)
    s_setprio 3
    v_mov_b32 v16, s74
    v_mov_b32 v17, s75
    v_mov_b32 v18, 0
    s_mov_b64 exec, 1
    buffer_store_dwordx2 v[16:17], v18, s[12:15], s85 offen sc1
    s_mov_b64 exec, -1
    s_setprio 0
    s_add_u32 s3, s33, 0
    s_and_b32 s3, s3, 3
    s_mul_i32 s32, s3, 40960
    s_mul_i32 s3, s3, 5120
    s_add_u32 s3, s3, s23
    s_mov_b32 m0, s3
    s_nop 0
    buffer_load_dwordx4 v232, s[48:51], s32 offen offset:0  lds
    s_waitcnt vmcnt(1)
    buffer_load_dwordx4 v233, s[48:51], s32 offen offset:1024  lds
    s_waitcnt vmcnt(1)
    buffer_load_dwordx4 v234, s[48:51], s32 offen offset:2048  lds
    s_waitcnt vmcnt(1)
    buffer_load_dwordx4 v235, s[48:51], s32 offen offset:3072  lds
    s_waitcnt vmcnt(1)
    s_add_u32 m0, s3, 4096
    s_nop 0
    buffer_load_dwordx4 v236, s[48:51], s32 offen offset:0  lds
    s_waitcnt vmcnt(1)
    s_setprio 3
    s_mov_b32 s82, 65536
    s_mov_b32 exec_lo, 0xe
    s_mov_b32 exec_hi, 0x0
L_po_19:
    v_mov_b32 v12, 0
    v_mov_b32 v13, 0
    buffer_atomic_add_x2 v[12:13], v11, s[12:15], 0 offen sc0 sc1
    s_waitcnt vmcnt(0)
    v_cmp_ne_u64 vcc, s[74:75], v[12:13]
    s_cbranch_vccz L_pod_20
    s_sleep 4
    s_sub_u32 s82, s82, 1
    s_cmp_lg_u32 s82, 0
    s_cbranch_scc1 L_po_19
L_pod_20:
    s_mov_b64 exec, -1
    s_setprio 0
    s_mul_i32 s3, s17, 6144
    s_add_u32 s3, s3, 15990784
    buffer_load_dwordx4 v[144:147], v10, s[12:15], s3 offen offset:0 sc1
    s_waitcnt vmcnt(2)
    buffer_load_dwordx4 v[148:151], v10, s[12:15], s3 offen offset:1024 sc1
    s_waitcnt vmcnt(2)
    s_add_u32 s3, s3, 2048
    buffer_load_dwordx4 v[160:163], v10, s[12:15], s3 offen offset:0 sc1
    s_waitcnt vmcnt(2)
    buffer_load_dwordx4 v[164:167], v10, s[12:15], s3 offen offset:1024 sc1
    s_waitcnt vmcnt(2)
    s_add_u32 s3, s3, 2048
    buffer_load_dwordx4 v[176:179], v10, s[12:15], s3 offen offset:0 sc1
    s_waitcnt vmcnt(2)
    buffer_load_dwordx4 v[180:183], v10, s[12:15], s3 offen offset:1024 sc1
    s_waitcnt vmcnt(2)
    s_add_u32 s3, s3, 2048
    s_waitcnt vmcnt(0)
    s_setprio 3
    v_mfma_f32_16x16x16_bf16 v[128:131], v[192:193], v[144:145], v[128:131]
    v_mfma_f32_16x16x16_bf16 v[132:135], v[192:193], v[146:147], v[132:135]
    v_mfma_f32_16x16x16_bf16 v[136:139], v[192:193], v[148:149], v[136:139]
    v_mfma_f32_16x16x16_bf16 v[140:143], v[192:193], v[150:151], v[140:143]
    v_mfma_f32_16x16x16_bf16 v[128:131], v[192:193], v[160:161], v[128:131]
    v_mfma_f32_16x16x16_bf16 v[132:135], v[192:193], v[162:163], v[132:135]
    v_mfma_f32_16x16x16_bf16 v[136:139], v[192:193], v[164:165], v[136:139]
    v_mfma_f32_16x16x16_bf16 v[140:143], v[192:193], v[166:167], v[140:143]
    v_mfma_f32_16x16x16_bf16 v[128:131], v[192:193], v[176:177], v[128:131]
    v_mfma_f32_16x16x16_bf16 v[132:135], v[192:193], v[178:179], v[132:135]
    v_mfma_f32_16x16x16_bf16 v[136:139], v[192:193], v[180:181], v[136:139]
    v_mfma_f32_16x16x16_bf16 v[140:143], v[192:193], v[182:183], v[140:143]
    s_mov_b32 s26, 0xbdd2d3e8
    s_mov_b32 s27, 0xbdd2d3e8
    v_mov_b32 v16, 0xc0135761
    v_mov_b32 v17, 0xc0135761
    s_nop 0
    v_pk_mul_f32 v[144:145], v[128:129], v[128:129]
    v_pk_mul_f32 v[146:147], v[130:131], v[130:131]
    v_pk_mul_f32 v[148:149], v[132:133], v[132:133]
    v_pk_mul_f32 v[150:151], v[134:135], v[134:135]
    v_pk_mul_f32 v[152:153], v[136:137], v[136:137]
    v_pk_mul_f32 v[154:155], v[138:139], v[138:139]
    v_pk_mul_f32 v[156:157], v[140:141], v[140:141]
    v_pk_mul_f32 v[158:159], v[142:143], v[142:143]
    v_pk_fma_f32 v[144:145], v[144:145], s[26:27], v[16:17]
    v_pk_fma_f32 v[146:147], v[146:147], s[26:27], v[16:17]
    v_pk_fma_f32 v[148:149], v[148:149], s[26:27], v[16:17]
    v_pk_fma_f32 v[150:151], v[150:151], s[26:27], v[16:17]
    v_pk_fma_f32 v[152:153], v[152:153], s[26:27], v[16:17]
    v_pk_fma_f32 v[154:155], v[154:155], s[26:27], v[16:17]
    v_pk_fma_f32 v[156:157], v[156:157], s[26:27], v[16:17]
    v_pk_fma_f32 v[158:159], v[158:159], s[26:27], v[16:17]
    v_pk_mul_f32 v[144:145], v[144:145], v[128:129]
    v_pk_mul_f32 v[146:147], v[146:147], v[130:131]
    v_pk_mul_f32 v[148:149], v[148:149], v[132:133]
    v_pk_mul_f32 v[150:151], v[150:151], v[134:135]
    v_pk_mul_f32 v[152:153], v[152:153], v[136:137]
    v_pk_mul_f32 v[154:155], v[154:155], v[138:139]
    v_pk_mul_f32 v[156:157], v[156:157], v[140:141]
    v_pk_mul_f32 v[158:159], v[158:159], v[142:143]
    v_exp_f32 v144, v144
    v_exp_f32 v145, v145
    v_exp_f32 v146, v146
    v_exp_f32 v147, v147
    v_exp_f32 v148, v148
    v_exp_f32 v149, v149
    v_exp_f32 v150, v150
    v_exp_f32 v151, v151
    v_exp_f32 v152, v152
    v_exp_f32 v153, v153
    v_exp_f32 v154, v154
    v_exp_f32 v155, v155
    v_exp_f32 v156, v156
    v_exp_f32 v157, v157
    v_exp_f32 v158, v158
    v_exp_f32 v159, v159
    v_pk_add_f32 v[144:145], v[144:145], 1.0 op_sel_hi:[1,0]
    v_pk_add_f32 v[146:147], v[146:147], 1.0 op_sel_hi:[1,0]
    v_pk_add_f32 v[148:149], v[148:149], 1.0 op_sel_hi:[1,0]
    v_pk_add_f32 v[150:151], v[150:151], 1.0 op_sel_hi:[1,0]
    v_pk_add_f32 v[152:153], v[152:153], 1.0 op_sel_hi:[1,0]
    v_pk_add_f32 v[154:155], v[154:155], 1.0 op_sel_hi:[1,0]
    v_pk_add_f32 v[156:157], v[156:157], 1.0 op_sel_hi:[1,0]
    v_pk_add_f32 v[158:159], v[158:159], 1.0 op_sel_hi:[1,0]
    v_rcp_f32 v144, v144
    v_rcp_f32 v145, v145
    v_rcp_f32 v146, v146
    v_rcp_f32 v147, v147
    v_rcp_f32 v148, v148
    v_rcp_f32 v149, v149
    v_rcp_f32 v150, v150
    v_rcp_f32 v151, v151
    v_rcp_f32 v152, v152
    v_rcp_f32 v153, v153
    v_rcp_f32 v154, v154
    v_rcp_f32 v155, v155
    v_rcp_f32 v156, v156
    v_rcp_f32 v157, v157
    v_rcp_f32 v158, v158
    v_rcp_f32 v159, v159
    v_pk_mul_f32 v[128:129], v[128:129], v[144:145]
    v_pk_mul_f32 v[130:131], v[130:131], v[146:147]
    v_pk_mul_f32 v[132:133], v[132:133], v[148:149]
    v_pk_mul_f32 v[134:135], v[134:135], v[150:151]
    v_pk_mul_f32 v[136:137], v[136:137], v[152:153]
    v_pk_mul_f32 v[138:139], v[138:139], v[154:155]
    v_pk_mul_f32 v[140:141], v[140:141], v[156:157]
    v_pk_mul_f32 v[142:143], v[142:143], v[158:159]
    v_cvt_pk_bf16_f32 v144, v128, v129
    v_cvt_pk_bf16_f32 v145, v130, v131
    v_cvt_pk_bf16_f32 v146, v136, v137
    v_cvt_pk_bf16_f32 v147, v138, v139
    v_cvt_pk_bf16_f32 v148, v132, v133
    v_cvt_pk_bf16_f32 v149, v134, v135
    v_cvt_pk_bf16_f32 v150, v140, v141
    v_cvt_pk_bf16_f32 v151, v142, v143
    v_mul_u32_u24 v10, 10240, v21
    v_add_u32 v10, v10, v20
    v_permlane32_swap_b32 v144, v146
    v_permlane32_swap_b32 v145, v147
    v_permlane32_swap_b32 v148, v150
    v_permlane32_swap_b32 v149, v151
    s_mul_i32 s85, s24, 40960
    s_lshl_b32 s3, s25, 9
    s_add_u32 s85, s85, s3
    s_add_u32 s85, s85, 11239424
    s_add_u32 s3, s85, 20480
    buffer_store_dwordx4 v[144:147], v10, s[12:15], s85 offen sc1
    s_waitcnt vmcnt(2)
    buffer_store_dwordx4 v[148:151], v10, s[12:15], s3 offen sc1
    s_waitcnt vmcnt(2)
    s_mul_i32 s85, s25, 48
    s_add_u32 s85, s85, s24
    s_lshl_b32 s85, s85, 4
    s_add_u32 s85, s85, 393216
    s_setprio 0
    s_waitcnt vmcnt(0)
    s_setprio 3
    v_mov_b32 v16, s74
    v_mov_b32 v17, s75
    v_mov_b32 v18, 0
    s_mov_b64 exec, 1
    buffer_store_dwordx2 v[16:17], v18, s[12:15], s85 offen sc1
    s_mov_b64 exec, -1
    s_branch L_M_j
L_M_idle:
    ds_read_b64_tr_b16 v[200:201], v12 offset:0
    ds_read_b64_tr_b16 v[202:203], v12 offset:5120
    ds_read_b64_tr_b16 v[204:205], v12 offset:512
    ds_read_b64_tr_b16 v[206:207], v12 offset:5632
    ds_read_b64_tr_b16 v[208:209], v12 offset:1024
    ds_read_b64_tr_b16 v[210:211], v12 offset:6144
    s_waitcnt lgkmcnt(0)
    buffer_store_dwordx4 v[200:203], v13, s[12:15], s8 offen sc1
    buffer_store_dwordx4 v[204:207], v13, s[12:15], s9 offen sc1
    buffer_store_dwordx4 v[208:211], v13, s[12:15], s10 offen sc1
    s_waitcnt vmcnt(0)
    s_barrier
    s_cmp_lg_u32 s77, 0
    s_cbranch_scc1 L_nf_21
    s_mov_b64 exec, 1
    buffer_store_dwordx2 v[28:29], v13, s[12:15], s11 offen sc1
    s_mov_b64 exec, -1
L_nf_21:
    s_setprio 3
    s_mov_b32 s82, 262144
L_lw_22:
    ds_read_b32 v16, v254 offset:0
    s_waitcnt lgkmcnt(0)
    v_readfirstlane_b32 s3, v16
    s_nop 0
    s_cmp_ge_u32 s3, 4
    s_cbranch_scc1 L_lwd_23
    s_sleep 8
    s_sub_u32 s82, s82, 1
    s_cmp_lg_u32 s82, 0
    s_cbranch_scc1 L_lw_22
L_lwd_23:
    s_and_b32 s3, s78, 1
    s_mul_i32 s3, s3, 30
    s_add_u32 s3, s3, s79
    s_sub_u32 s3, s3, 8
    s_lshl_b32 s3, s3, 2
    s_add_u32 s3, s3, s22
    s_lshl_b32 s3, s3, 2
    s_add_u32 s3, s3, s77
    s_lshl_b32 s3, s3, 6
    s_add_u32 s3, s3, 32768
    v_mov_b32 v11, s3
    s_mov_b32 s82, 65536
    s_mov_b32 exec_lo, 0x1
    s_mov_b32 exec_hi, 0x0
L_po_24:
    v_mov_b32 v12, 0
    v_mov_b32 v13, 0
    buffer_atomic_add_x2 v[12:13], v11, s[12:15], 0 offen sc0 sc1
    s_waitcnt vmcnt(0)
    v_cmp_ne_u64 vcc, s[74:75], v[12:13]
    s_cbranch_vccz L_pod_25
    s_sleep 8
    s_sub_u32 s82, s82, 1
    s_cmp_lg_u32 s82, 0
    s_cbranch_scc1 L_po_24
L_pod_25:
    s_mov_b64 exec, -1
    s_setprio 0
    s_waitcnt vmcnt(0)
    s_waitcnt vmcnt(0)
    s_waitcnt vmcnt(0)
    s_setprio 0
    s_add_u32 s3, s33, 0
    s_and_b32 s3, s3, 3
    s_mul_i32 s32, s3, 40960
    s_mul_i32 s3, s3, 5120
    s_add_u32 s3, s3, s23
    s_mov_b32 m0, s3
    s_nop 0
    buffer_load_dwordx4 v232, s[48:51], s32 offen offset:0  lds
    s_waitcnt vmcnt(1)
    buffer_load_dwordx4 v233, s[48:51], s32 offen offset:1024  lds
    s_waitcnt vmcnt(1)
    buffer_load_dwordx4 v234, s[48:51], s32 offen offset:2048  lds
    s_waitcnt vmcnt(1)
    buffer_load_dwordx4 v235, s[48:51], s32 offen offset:3072  lds
    s_waitcnt vmcnt(1)
    s_add_u32 m0, s3, 4096
    s_nop 0
    buffer_load_dwordx4 v236, s[48:51], s32 offen offset:0  lds
    s_waitcnt vmcnt(1)
    s_setprio 3
    s_setprio 0
    s_add_u32 s3, s33, 1
    s_and_b32 s3, s3, 3
    s_mul_i32 s32, s3, 40960
    s_mul_i32 s3, s3, 5120
    s_add_u32 s3, s3, s23
    s_mov_b32 m0, s3
    s_nop 0
    buffer_load_dwordx4 v232, s[48:51], s32 offen offset:0  lds
    s_waitcnt vmcnt(1)
    buffer_load_dwordx4 v233, s[48:51], s32 offen offset:1024  lds
    s_waitcnt vmcnt(1)
    buffer_load_dwordx4 v234, s[48:51], s32 offen offset:2048  lds
    s_waitcnt vmcnt(1)
    buffer_load_dwordx4 v235, s[48:51], s32 offen offset:3072  lds
    s_waitcnt vmcnt(1)
    s_add_u32 m0, s3, 4096
    s_nop 0
    buffer_load_dwordx4 v236, s[48:51], s32 offen offset:0  lds
    s_waitcnt vmcnt(1)
    s_setprio 3
    s_setprio 0
    s_add_u32 s3, s33, 2
    s_and_b32 s3, s3, 3
    s_mul_i32 s32, s3, 40960
    s_mul_i32 s3, s3, 5120
    s_add_u32 s3, s3, s23
    s_mov_b32 m0, s3
    s_nop 0
    buffer_load_dwordx4 v232, s[48:51], s32 offen offset:0  lds
    s_waitcnt vmcnt(1)
    buffer_load_dwordx4 v233, s[48:51], s32 offen offset:1024  lds
    s_waitcnt vmcnt(1)
    buffer_load_dwordx4 v234, s[48:51], s32 offen offset:2048  lds
    s_waitcnt vmcnt(1)
    buffer_load_dwordx4 v235, s[48:51], s32 offen offset:3072  lds
    s_waitcnt vmcnt(1)
    s_add_u32 m0, s3, 4096
    s_nop 0
    buffer_load_dwordx4 v236, s[48:51], s32 offen offset:0  lds
    s_waitcnt vmcnt(1)
    s_setprio 3
    s_setprio 0
    s_add_u32 s3, s33, 3
    s_and_b32 s3, s3, 3
    s_mul_i32 s32, s3, 40960
    s_mul_i32 s3, s3, 5120
    s_add_u32 s3, s3, s23
    s_mov_b32 m0, s3
    s_nop 0
    buffer_load_dwordx4 v232, s[48:51], s32 offen offset:0  lds
    s_waitcnt vmcnt(1)
    buffer_load_dwordx4 v233, s[48:51], s32 offen offset:1024  lds
    s_waitcnt vmcnt(1)
    buffer_load_dwordx4 v234, s[48:51], s32 offen offset:2048  lds
    s_waitcnt vmcnt(1)
    buffer_load_dwordx4 v235, s[48:51], s32 offen offset:3072  lds
    s_waitcnt vmcnt(1)
    s_add_u32 m0, s3, 4096
    s_nop 0
    buffer_load_dwordx4 v236, s[48:51], s32 offen offset:0  lds
    s_waitcnt vmcnt(1)
    s_setprio 3
L_M_j:
    s_setprio 3
    s_lshl_b32 s24, s30, 2
    s_add_u32 s24, s24, s77
L_G2:
    s_setprio 0
    s_add_u32 m0, s23, 20480
    s_nop 0
    buffer_load_dwordx4 v224, s[44:47], s34 offen offset:0  lds
    s_waitcnt vmcnt(2)
    s_add_u32 m0, s23, 20480
    s_nop 0
    buffer_load_dwordx4 v225, s[44:47], s34 offen offset:1024  lds
    s_waitcnt vmcnt(2)
    s_add_u32 m0, s23, 20480
    s_nop 0
    buffer_load_dwordx4 v226, s[44:47], s34 offen offset:2048  lds
    s_waitcnt vmcnt(2)
    s_add_u32 m0, s23, 20480
    s_nop 0
    buffer_load_dwordx4 v227, s[44:47], s34 offen offset:3072  lds
    s_add_u32 s34, s34, 131072
    s_cmp_eq_u32 s34, 1572864
    s_cselect_b32 s34, 0, s34
    s_waitcnt vmcnt(2)
    s_add_u32 m0, s23, 25600
    s_nop 0
    buffer_load_dwordx4 v224, s[44:47], s34 offen offset:0  lds
    s_waitcnt vmcnt(2)
    s_add_u32 m0, s23, 25600
    s_nop 0
    buffer_load_dwordx4 v225, s[44:47], s34 offen offset:1024  lds
    s_waitcnt vmcnt(2)
    s_add_u32 m0, s23, 25600
    s_nop 0
    buffer_load_dwordx4 v226, s[44:47], s34 offen offset:2048  lds
    s_waitcnt vmcnt(2)
    s_add_u32 m0, s23, 25600
    s_nop 0
    buffer_load_dwordx4 v227, s[44:47], s34 offen offset:3072  lds
    s_add_u32 s34, s34, 131072
    s_cmp_eq_u32 s34, 1572864
    s_cselect_b32 s34, 0, s34
    s_waitcnt vmcnt(2)
    s_cmp_ge_u32 s79, 30
    s_cbranch_scc1 L_nod_26
    s_setprio 0
    s_add_u32 s3, s33, 1
    s_and_b32 s3, s3, 3
    s_mul_i32 s32, s3, 40960
    s_mul_i32 s3, s3, 5120
    s_add_u32 s3, s3, s23
    s_mov_b32 m0, s3
    s_nop 0
    buffer_load_dwordx4 v232, s[48:51], s32 offen offset:0  lds
    s_waitcnt vmcnt(2)
    buffer_load_dwordx4 v233, s[48:51], s32 offen offset:1024  lds
    s_waitcnt vmcnt(2)
    buffer_load_dwordx4 v234, s[48:51], s32 offen offset:2048  lds
    s_waitcnt vmcnt(2)
    buffer_load_dwordx4 v235, s[48:51], s32 offen offset:3072  lds
    s_waitcnt vmcnt(2)
    s_add_u32 m0, s3, 4096
    s_nop 0
    buffer_load_dwordx4 v236, s[48:51], s32 offen offset:0  lds
    s_waitcnt vmcnt(2)
    s_setprio 3
    s_setprio 0
    s_add_u32 s3, s33, 2
    s_and_b32 s3, s3, 3
    s_mul_i32 s32, s3, 40960
    s_mul_i32 s3, s3, 5120
    s_add_u32 s3, s3, s23
    s_mov_b32 m0, s3
    s_nop 0
    buffer_load_dwordx4 v232, s[48:51], s32 offen offset:0  lds
    s_waitcnt vmcnt(2)
    buffer_load_dwordx4 v233, s[48:51], s32 offen offset:1024  lds
    s_waitcnt vmcnt(2)
    buffer_load_dwordx4 v234, s[48:51], s32 offen offset:2048  lds
    s_waitcnt vmcnt(2)
    buffer_load_dwordx4 v235, s[48:51], s32 offen offset:3072  lds
    s_waitcnt vmcnt(2)
    s_add_u32 m0, s3, 4096
    s_nop 0
    buffer_load_dwordx4 v236, s[48:51], s32 offen offset:0  lds
    s_waitcnt vmcnt(2)
    s_setprio 3
    s_setprio 0
    s_add_u32 s3, s33, 3
    s_and_b32 s3, s3, 3
    s_mul_i32 s32, s3, 40960
    s_mul_i32 s3, s3, 5120
    s_add_u32 s3, s3, s23
    s_mov_b32 m0, s3
    s_nop 0
    buffer_load_dwordx4 v232, s[48:51], s32 offen offset:0  lds
    s_waitcnt vmcnt(2)
    buffer_load_dwordx4 v233, s[48:51], s32 offen offset:1024  lds
    s_waitcnt vmcnt(2)
    buffer_load_dwordx4 v234, s[48:51], s32 offen offset:2048  lds
    s_waitcnt vmcnt(2)
    buffer_load_dwordx4 v235, s[48:51], s32 offen offset:3072  lds
    s_waitcnt vmcnt(2)
    s_add_u32 m0, s3, 4096
    s_nop 0
    buffer_load_dwordx4 v236, s[48:51], s32 offen offset:0  lds
    s_waitcnt vmcnt(2)
    s_setprio 3
L_nod_26:
    s_setprio 3
    s_mov_b32 s82, 65536
L_po_27:
    buffer_load_dwordx2 v[12:13], v229, s[12:15], 0 offen sc1
    s_waitcnt vmcnt(0)
    v_cmp_ne_u64 vcc, s[74:75], v[12:13]
    s_cbranch_vccz L_pod_28
    s_sleep 8
    s_sub_u32 s82, s82, 1
    s_cmp_lg_u32 s82, 0
    s_cbranch_scc1 L_po_27
L_pod_28:
    s_setprio 0
    s_cmp_lg_u32 s77, 0
    s_cbranch_scc1 L_npf_29
    s_mul_i32 s3, s79, 1408
    v_lshlrev_b32 v10, 7, v1
    s_mov_b64 exec, 0x7ff
    buffer_load_dword v11, v10, s[68:71], s3 offen
    s_mov_b64 exec, -1
L_npf_29:
    s_xor_b32 s3, s24, 0
    s_lshl_b32 s3, s3, 8
    s_add_u32 s3, s3, 229376
    buffer_load_dword v244, v237, s[12:15], s3 offen sc1
    s_xor_b32 s3, s24, 1
    s_lshl_b32 s3, s3, 8
    s_add_u32 s3, s3, 229376
    buffer_load_dword v246, v237, s[12:15], s3 offen sc1
    s_xor_b32 s3, s24, 2
    s_lshl_b32 s3, s3, 8
    s_add_u32 s3, s3, 229376
    buffer_load_dword v248, v237, s[12:15], s3 offen sc1
    s_xor_b32 s3, s24, 3
    s_lshl_b32 s3, s3, 8
    s_add_u32 s3, s3, 229376
    buffer_load_dword v250, v237, s[12:15], s3 offen sc1
    s_lshl_b32 s3, s24, 5
    buffer_load_ushort v252, v238, s[56:59], s3 offen
    buffer_load_dwordx4 v[144:147], v228, s[12:15], s35 offen offset:0 sc1
    s_waitcnt vmcnt(3)
    buffer_load_dwordx4 v[148:151], v228, s[12:15], s35 offen offset:256 sc1
    s_waitcnt vmcnt(3)
    buffer_load_dwordx4 v[152:155], v228, s[12:15], s35 offen offset:512 sc1
    s_waitcnt vmcnt(3)
    buffer_load_dwordx4 v[156:159], v228, s[12:15], s35 offen offset:768 sc1
    s_waitcnt vmcnt(3)
    buffer_load_dwordx4 v[160:163], v228, s[12:15], s35 offen offset:1024 sc1
    s_waitcnt vmcnt(3)
    s_add_u32 s35, s35, 40960
    s_cmp_eq_u32 s35, 491520
    s_cselect_b32 s35, 0, s35
    buffer_load_dwordx4 v[164:167], v228, s[12:15], s35 offen offset:0 sc1
    s_waitcnt vmcnt(3)
    buffer_load_dwordx4 v[168:171], v228, s[12:15], s35 offen offset:256 sc1
    s_waitcnt vmcnt(3)
    buffer_load_dwordx4 v[172:175], v228, s[12:15], s35 offen offset:512 sc1
    s_waitcnt vmcnt(3)
    buffer_load_dwordx4 v[176:179], v228, s[12:15], s35 offen offset:768 sc1
    s_waitcnt vmcnt(3)
    buffer_load_dwordx4 v[180:183], v228, s[12:15], s35 offen offset:1024 sc1
    s_waitcnt vmcnt(3)
    s_add_u32 s35, s35, 40960
    s_cmp_eq_u32 s35, 491520
    s_cselect_b32 s35, 0, s35
    s_waitcnt vmcnt(5)
    ds_read_b64_tr_b16 v[32:33], v245 offset:20480
    ds_read_b64_tr_b16 v[34:35], v245 offset:21504
    ds_read_b64_tr_b16 v[36:37], v247 offset:20480
    ds_read_b64_tr_b16 v[38:39], v247 offset:21504
    ds_read_b64_tr_b16 v[40:41], v249 offset:20480
    ds_read_b64_tr_b16 v[42:43], v249 offset:21504
    ds_read_b64_tr_b16 v[44:45], v251 offset:20480
    ds_read_b64_tr_b16 v[46:47], v251 offset:21504
    s_waitcnt lgkmcnt(6)
    v_mfma_f32_16x16x32_bf16 v[64:67], v[144:147], v[32:35], 0
    v_mfma_f32_16x16x32_bf16 v[68:71], v[148:151], v[32:35], 0
    s_add_u32 m0, s23, 29696
    s_nop 0
    buffer_load_dwordx4 v224, s[44:47], s34 offen offset:0  lds
    s_waitcnt vmcnt(3)
    v_mfma_f32_16x16x32_bf16 v[72:75], v[152:155], v[32:35], 0
    v_mfma_f32_16x16x32_bf16 v[76:79], v[156:159], v[32:35], 0
    buffer_load_dwordx4 v225, s[44:47], s34 offen offset:1024  lds
    s_waitcnt vmcnt(3)
    v_mfma_f32_16x16x32_bf16 v[80:83], v[160:163], v[32:35], 0
    s_waitcnt lgkmcnt(4)
    v_mfma_f32_16x16x32_bf16 v[84:87], v[144:147], v[36:39], 0
    buffer_load_dwordx4 v226, s[44:47], s34 offen offset:2048  lds
    s_waitcnt vmcnt(3)
    v_mfma_f32_16x16x32_bf16 v[88:91], v[148:151], v[36:39], 0
    v_mfma_f32_16x16x32_bf16 v[92:95], v[152:155], v[36:39], 0
    buffer_load_dwordx4 v227, s[44:47], s34 offen offset:3072  lds
    s_waitcnt vmcnt(3)
    s_add_u32 s34, s34, 131072
    s_cmp_eq_u32 s34, 1572864
    s_cselect_b32 s34, 0, s34
    v_mfma_f32_16x16x32_bf16 v[96:99], v[156:159], v[36:39], 0
    v_mfma_f32_16x16x32_bf16 v[100:103], v[160:163], v[36:39], 0
    buffer_load_dwordx4 v[184:187], v228, s[12:15], s35 offen offset:0 sc1
    s_waitcnt vmcnt(3)
    s_waitcnt lgkmcnt(2)
    v_mfma_f32_16x16x32_bf16 v[104:107], v[144:147], v[40:43], 0
    v_mfma_f32_16x16x32_bf16 v[108:111], v[148:151], v[40:43], 0
    buffer_load_dwordx4 v[188:191], v228, s[12:15], s35 offen offset:256 sc1
    s_waitcnt vmcnt(3)
    v_mfma_f32_16x16x32_bf16 v[112:115], v[152:155], v[40:43], 0
    v_mfma_f32_16x16x32_bf16 v[116:119], v[156:159], v[40:43], 0
    buffer_load_dwordx4 v[192:195], v228, s[12:15], s35 offen offset:512 sc1
    s_waitcnt vmcnt(3)
    v_mfma_f32_16x16x32_bf16 v[120:123], v[160:163], v[40:43], 0
    s_waitcnt lgkmcnt(0)
    v_mfma_f32_16x16x32_bf16 v[124:127], v[144:147], v[44:47], 0
    buffer_load_dwordx4 v[196:199], v228, s[12:15], s35 offen offset:768 sc1
    s_waitcnt vmcnt(3)
    v_mfma_f32_16x16x32_bf16 v[128:131], v[148:151], v[44:47], 0
    v_mfma_f32_16x16x32_bf16 v[132:135], v[152:155], v[44:47], 0
    buffer_load_dwordx4 v[200:203], v228, s[12:15], s35 offen offset:1024 sc1
    s_waitcnt vmcnt(3)
    s_add_u32 s35, s35, 40960
    s_cmp_eq_u32 s35, 491520
    s_cselect_b32 s35, 0, s35
    v_mfma_f32_16x16x32_bf16 v[136:139], v[156:159], v[44:47], 0
    v_mfma_f32_16x16x32_bf16 v[140:143], v[160:163], v[44:47], 0
    s_waitcnt vmcnt(9)
    ds_read_b64_tr_b16 v[32:33], v245 offset:25600
    ds_read_b64_tr_b16 v[34:35], v245 offset:26624
    ds_read_b64_tr_b16 v[36:37], v247 offset:25600
    ds_read_b64_tr_b16 v[38:39], v247 offset:26624
    ds_read_b64_tr_b16 v[40:41], v249 offset:25600
    ds_read_b64_tr_b16 v[42:43], v249 offset:26624
    ds_read_b64_tr_b16 v[44:45], v251 offset:25600
    ds_read_b64_tr_b16 v[46:47], v251 offset:26624
    s_waitcnt lgkmcnt(6)
    v_mfma_f32_16x16x32_bf16 v[64:67], v[164:167], v[32:35], v[64:67]
    v_mfma_f32_16x16x32_bf16 v[68:71], v[168:171], v[32:35], v[68:71]
    s_add_u32 m0, s23, 20480
    s_nop 0
    buffer_load_dwordx4 v224, s[44:47], s34 offen offset:0  lds
    s_waitcnt vmcnt(5)
    v_mfma_f32_16x16x32_bf16 v[72:75], v[172:175], v[32:35], v[72:75]
    v_mfma_f32_16x16x32_bf16 v[76:79], v[176:179], v[32:35], v[76:79]
    buffer_load_dwordx4 v225, s[44:47], s34 offen offset:1024  lds
    s_waitcnt vmcnt(5)
    v_mfma_f32_16x16x32_bf16 v[80:83], v[180:183], v[32:35], v[80:83]
    s_waitcnt lgkmcnt(4)
    v_mfma_f32_16x16x32_bf16 v[84:87], v[164:167], v[36:39], v[84:87]
    buffer_load_dwordx4 v226, s[44:47], s34 offen offset:2048  lds
    s_waitcnt vmcnt(5)
    v_mfma_f32_16x16x32_bf16 v[88:91], v[168:171], v[36:39], v[88:91]
    v_mfma_f32_16x16x32_bf16 v[92:95], v[172:175], v[36:39], v[92:95]
    buffer_load_dwordx4 v227, s[44:47], s34 offen offset:3072  lds
    s_waitcnt vmcnt(5)
    s_add_u32 s34, s34, 131072
    s_cmp_eq_u32 s34, 1572864
    s_cselect_b32 s34, 0, s34
    v_mfma_f32_16x16x32_bf16 v[96:99], v[176:179], v[36:39], v[96:99]
    v_mfma_f32_16x16x32_bf16 v[100:103], v[180:183], v[36:39], v[100:103]
    buffer_load_dwordx4 v[204:207], v228, s[12:15], s35 offen offset:0 sc1
    s_waitcnt vmcnt(5)
    s_waitcnt lgkmcnt(2)
    v_mfma_f32_16x16x32_bf16 v[104:107], v[164:167], v[40:43], v[104:107]
    v_mfma_f32_16x16x32_bf16 v[108:111], v[168:171], v[40:43], v[108:111]
    buffer_load_dwordx4 v[208:211], v228, s[12:15], s35 offen offset:256 sc1
    s_waitcnt vmcnt(5)
    v_mfma_f32_16x16x32_bf16 v[112:115], v[172:175], v[40:43], v[112:115]
    v_mfma_f32_16x16x32_bf16 v[116:119], v[176:179], v[40:43], v[116:119]
    buffer_load_dwordx4 v[212:215], v228, s[12:15], s35 offen offset:512 sc1
    s_waitcnt vmcnt(5)
    v_mfma_f32_16x16x32_bf16 v[120:123], v[180:183], v[40:43], v[120:123]
    s_waitcnt lgkmcnt(0)
    v_mfma_f32_16x16x32_bf16 v[124:127], v[164:167], v[44:47], v[124:127]
    buffer_load_dwordx4 v[216:219], v228, s[12:15], s35 offen offset:768 sc1
    s_waitcnt vmcnt(5)
    v_mfma_f32_16x16x32_bf16 v[128:131], v[168:171], v[44:47], v[128:131]
    v_mfma_f32_16x16x32_bf16 v[132:135], v[172:175], v[44:47], v[132:135]
    buffer_load_dwordx4 v[220:223], v228, s[12:15], s35 offen offset:1024 sc1
    s_waitcnt vmcnt(5)
    s_add_u32 s35, s35, 40960
    s_cmp_eq_u32 s35, 491520
    s_cselect_b32 s35, 0, s35
    v_mfma_f32_16x16x32_bf16 v[136:139], v[176:179], v[44:47], v[136:139]
    v_mfma_f32_16x16x32_bf16 v[140:143], v[180:183], v[44:47], v[140:143]
    s_waitcnt vmcnt(9)
    ds_read_b64_tr_b16 v[32:33], v245 offset:29696
    ds_read_b64_tr_b16 v[34:35], v245 offset:30720
    ds_read_b64_tr_b16 v[36:37], v247 offset:29696
    ds_read_b64_tr_b16 v[38:39], v247 offset:30720
    ds_read_b64_tr_b16 v[40:41], v249 offset:29696
    ds_read_b64_tr_b16 v[42:43], v249 offset:30720
    ds_read_b64_tr_b16 v[44:45], v251 offset:29696
    ds_read_b64_tr_b16 v[46:47], v251 offset:30720
    s_waitcnt lgkmcnt(6)
    v_mfma_f32_16x16x32_bf16 v[64:67], v[184:187], v[32:35], v[64:67]
    v_mfma_f32_16x16x32_bf16 v[68:71], v[188:191], v[32:35], v[68:71]
    s_add_u32 m0, s23, 25600
    s_nop 0
    buffer_load_dwordx4 v224, s[44:47], s34 offen offset:0  lds
    s_waitcnt vmcnt(5)
    v_mfma_f32_16x16x32_bf16 v[72:75], v[192:195], v[32:35], v[72:75]
    v_mfma_f32_16x16x32_bf16 v[76:79], v[196:199], v[32:35], v[76:79]
    buffer_load_dwordx4 v225, s[44:47], s34 offen offset:1024  lds
    s_waitcnt vmcnt(5)
    v_mfma_f32_16x16x32_bf16 v[80:83], v[200:203], v[32:35], v[80:83]
    s_waitcnt lgkmcnt(4)
    v_mfma_f32_16x16x32_bf16 v[84:87], v[184:187], v[36:39], v[84:87]
    buffer_load_dwordx4 v226, s[44:47], s34 offen offset:2048  lds
    s_waitcnt vmcnt(5)
    v_mfma_f32_16x16x32_bf16 v[88:91], v[188:191], v[36:39], v[88:91]
    v_mfma_f32_16x16x32_bf16 v[92:95], v[192:195], v[36:39], v[92:95]
    buffer_load_dwordx4 v227, s[44:47], s34 offen offset:3072  lds
    s_waitcnt vmcnt(5)
    s_add_u32 s34, s34, 131072
    s_cmp_eq_u32 s34, 1572864
    s_cselect_b32 s34, 0, s34
    v_mfma_f32_16x16x32_bf16 v[96:99], v[196:199], v[36:39], v[96:99]
    v_mfma_f32_16x16x32_bf16 v[100:103], v[200:203], v[36:39], v[100:103]
    buffer_load_dwordx4 v[144:147], v228, s[12:15], s35 offen offset:0 sc1
    s_waitcnt vmcnt(5)
    s_waitcnt lgkmcnt(2)
    v_mfma_f32_16x16x32_bf16 v[104:107], v[184:187], v[40:43], v[104:107]
    v_mfma_f32_16x16x32_bf16 v[108:111], v[188:191], v[40:43], v[108:111]
    buffer_load_dwordx4 v[148:151], v228, s[12:15], s35 offen offset:256 sc1
    s_waitcnt vmcnt(5)
    v_mfma_f32_16x16x32_bf16 v[112:115], v[192:195], v[40:43], v[112:115]
    v_mfma_f32_16x16x32_bf16 v[116:119], v[196:199], v[40:43], v[116:119]
    buffer_load_dwordx4 v[152:155], v228, s[12:15], s35 offen offset:512 sc1
    s_waitcnt vmcnt(5)
    v_mfma_f32_16x16x32_bf16 v[120:123], v[200:203], v[40:43], v[120:123]
    s_waitcnt lgkmcnt(0)
    v_mfma_f32_16x16x32_bf16 v[124:127], v[184:187], v[44:47], v[124:127]
    buffer_load_dwordx4 v[156:159], v228, s[12:15], s35 offen offset:768 sc1
    s_waitcnt vmcnt(5)
    v_mfma_f32_16x16x32_bf16 v[128:131], v[188:191], v[44:47], v[128:131]
    v_mfma_f32_16x16x32_bf16 v[132:135], v[192:195], v[44:47], v[132:135]
    buffer_load_dwordx4 v[160:163], v228, s[12:15], s35 offen offset:1024 sc1
    s_waitcnt vmcnt(5)
    s_add_u32 s35, s35, 40960
    s_cmp_eq_u32 s35, 491520
    s_cselect_b32 s35, 0, s35
    v_mfma_f32_16x16x32_bf16 v[136:139], v[196:199], v[44:47], v[136:139]
    v_mfma_f32_16x16x32_bf16 v[140:143], v[200:203], v[44:47], v[140:143]
    s_waitcnt vmcnt(9)
    ds_read_b64_tr_b16 v[32:33], v245 offset:20480
    ds_read_b64_tr_b16 v[34:35], v245 offset:21504
    ds_read_b64_tr_b16 v[36:37], v247 offset:20480
    ds_read_b64_tr_b16 v[38:39], v247 offset:21504
    ds_read_b64_tr_b16 v[40:41], v249 offset:20480
    ds_read_b64_tr_b16 v[42:43], v249 offset:21504
    ds_read_b64_tr_b16 v[44:45], v251 offset:20480
    ds_read_b64_tr_b16 v[46:47], v251 offset:21504
    s_waitcnt lgkmcnt(6)
    v_mfma_f32_16x16x32_bf16 v[64:67], v[204:207], v[32:35], v[64:67]
    v_mfma_f32_16x16x32_bf16 v[68:71], v[208:211], v[32:35], v[68:71]
    s_add_u32 m0, s23, 29696
    s_nop 0
    buffer_load_dwordx4 v224, s[44:47], s34 offen offset:0  lds
    s_waitcnt vmcnt(5)
    v_mfma_f32_16x16x32_bf16 v[72:75], v[212:215], v[32:35], v[72:75]
    v_mfma_f32_16x16x32_bf16 v[76:79], v[216:219], v[32:35], v[76:79]
    buffer_load_dwordx4 v225, s[44:47], s34 offen offset:1024  lds
    s_waitcnt vmcnt(5)
    v_mfma_f32_16x16x32_bf16 v[80:83], v[220:223], v[32:35], v[80:83]
    s_waitcnt lgkmcnt(4)
    v_mfma_f32_16x16x32_bf16 v[84:87], v[204:207], v[36:39], v[84:87]
    buffer_load_dwordx4 v226, s[44:47], s34 offen offset:2048  lds
    s_waitcnt vmcnt(5)
    v_mfma_f32_16x16x32_bf16 v[88:91], v[208:211], v[36:39], v[88:91]
    v_mfma_f32_16x16x32_bf16 v[92:95], v[212:215], v[36:39], v[92:95]
    buffer_load_dwordx4 v227, s[44:47], s34 offen offset:3072  lds
    s_waitcnt vmcnt(5)
    s_add_u32 s34, s34, 131072
    s_cmp_eq_u32 s34, 1572864
    s_cselect_b32 s34, 0, s34
    v_mfma_f32_16x16x32_bf16 v[96:99], v[216:219], v[36:39], v[96:99]
    v_mfma_f32_16x16x32_bf16 v[100:103], v[220:223], v[36:39], v[100:103]
    buffer_load_dwordx4 v[164:167], v228, s[12:15], s35 offen offset:0 sc1
    s_waitcnt vmcnt(5)
    s_waitcnt lgkmcnt(2)
    v_mfma_f32_16x16x32_bf16 v[104:107], v[204:207], v[40:43], v[104:107]
    v_mfma_f32_16x16x32_bf16 v[108:111], v[208:211], v[40:43], v[108:111]
    buffer_load_dwordx4 v[168:171], v228, s[12:15], s35 offen offset:256 sc1
    s_waitcnt vmcnt(5)
    v_mfma_f32_16x16x32_bf16 v[112:115], v[212:215], v[40:43], v[112:115]
    v_mfma_f32_16x16x32_bf16 v[116:119], v[216:219], v[40:43], v[116:119]
    buffer_load_dwordx4 v[172:175], v228, s[12:15], s35 offen offset:512 sc1
    s_waitcnt vmcnt(5)
    v_mfma_f32_16x16x32_bf16 v[120:123], v[220:223], v[40:43], v[120:123]
    s_waitcnt lgkmcnt(0)
    v_mfma_f32_16x16x32_bf16 v[124:127], v[204:207], v[44:47], v[124:127]
    buffer_load_dwordx4 v[176:179], v228, s[12:15], s35 offen offset:768 sc1
    s_waitcnt vmcnt(5)
    v_mfma_f32_16x16x32_bf16 v[128:131], v[208:211], v[44:47], v[128:131]
    v_mfma_f32_16x16x32_bf16 v[132:135], v[212:215], v[44:47], v[132:135]
    buffer_load_dwordx4 v[180:183], v228, s[12:15], s35 offen offset:1024 sc1
    s_waitcnt vmcnt(5)
    s_add_u32 s35, s35, 40960
    s_cmp_eq_u32 s35, 491520
    s_cselect_b32 s35, 0, s35
    v_mfma_f32_16x16x32_bf16 v[136:139], v[216:219], v[44:47], v[136:139]
    v_mfma_f32_16x16x32_bf16 v[140:143], v[220:223], v[44:47], v[140:143]
    s_waitcnt vmcnt(9)
    ds_read_b64_tr_b16 v[32:33], v245 offset:25600
    ds_read_b64_tr_b16 v[34:35], v245 offset:26624
    ds_read_b64_tr_b16 v[36:37], v247 offset:25600
    ds_read_b64_tr_b16 v[38:39], v247 offset:26624
    ds_read_b64_tr_b16 v[40:41], v249 offset:25600
    ds_read_b64_tr_b16 v[42:43], v249 offset:26624
    ds_read_b64_tr_b16 v[44:45], v251 offset:25600
    ds_read_b64_tr_b16 v[46:47], v251 offset:26624
    s_waitcnt lgkmcnt(6)
    v_mfma_f32_16x16x32_bf16 v[64:67], v[144:147], v[32:35], v[64:67]
    v_mfma_f32_16x16x32_bf16 v[68:71], v[148:151], v[32:35], v[68:71]
    s_add_u32 m0, s23, 20480
    s_nop 0
    buffer_load_dwordx4 v224, s[44:47], s34 offen offset:0  lds
    s_waitcnt vmcnt(5)
    v_mfma_f32_16x16x32_bf16 v[72:75], v[152:155], v[32:35], v[72:75]
    v_mfma_f32_16x16x32_bf16 v[76:79], v[156:159], v[32:35], v[76:79]
    buffer_load_dwordx4 v225, s[44:47], s34 offen offset:1024  lds
    s_waitcnt vmcnt(5)
    v_mfma_f32_16x16x32_bf16 v[80:83], v[160:163], v[32:35], v[80:83]
    s_waitcnt lgkmcnt(4)
    v_mfma_f32_16x16x32_bf16 v[84:87], v[144:147], v[36:39], v[84:87]
    buffer_load_dwordx4 v226, s[44:47], s34 offen offset:2048  lds
    s_waitcnt vmcnt(5)
    v_mfma_f32_16x16x32_bf16 v[88:91], v[148:151], v[36:39], v[88:91]
    v_mfma_f32_16x16x32_bf16 v[92:95], v[152:155], v[36:39], v[92:95]
    buffer_load_dwordx4 v227, s[44:47], s34 offen offset:3072  lds
    s_waitcnt vmcnt(5)
    s_add_u32 s34, s34, 131072
    s_cmp_eq_u32 s34, 1572864
    s_cselect_b32 s34, 0, s34
    v_mfma_f32_16x16x32_bf16 v[96:99], v[156:159], v[36:39], v[96:99]
    v_mfma_f32_16x16x32_bf16 v[100:103], v[160:163], v[36:39], v[100:103]
    buffer_load_dwordx4 v[184:187], v228, s[12:15], s35 offen offset:0 sc1
    s_waitcnt vmcnt(5)
    s_waitcnt lgkmcnt(2)
    v_mfma_f32_16x16x32_bf16 v[104:107], v[144:147], v[40:43], v[104:107]
    v_mfma_f32_16x16x32_bf16 v[108:111], v[148:151], v[40:43], v[108:111]
    buffer_load_dwordx4 v[188:191], v228, s[12:15], s35 offen offset:256 sc1
    s_waitcnt vmcnt(5)
    v_mfma_f32_16x16x32_bf16 v[112:115], v[152:155], v[40:43], v[112:115]
    v_mfma_f32_16x16x32_bf16 v[116:119], v[156:159], v[40:43], v[116:119]
    buffer_load_dwordx4 v[192:195], v228, s[12:15], s35 offen offset:512 sc1
    s_waitcnt vmcnt(5)
    v_mfma_f32_16x16x32_bf16 v[120:123], v[160:163], v[40:43], v[120:123]
    s_waitcnt lgkmcnt(0)
    v_mfma_f32_16x16x32_bf16 v[124:127], v[144:147], v[44:47], v[124:127]
    buffer_load_dwordx4 v[196:199], v228, s[12:15], s35 offen offset:768 sc1
    s_waitcnt vmcnt(5)
    v_mfma_f32_16x16x32_bf16 v[128:131], v[148:151], v[44:47], v[128:131]
    v_mfma_f32_16x16x32_bf16 v[132:135], v[152:155], v[44:47], v[132:135]
    buffer_load_dwordx4 v[200:203], v228, s[12:15], s35 offen offset:1024 sc1
    s_waitcnt vmcnt(5)
    s_add_u32 s35, s35, 40960
    s_cmp_eq_u32 s35, 491520
    s_cselect_b32 s35, 0, s35
    v_mfma_f32_16x16x32_bf16 v[136:139], v[156:159], v[44:47], v[136:139]
    v_mfma_f32_16x16x32_bf16 v[140:143], v[160:163], v[44:47], v[140:143]
    s_waitcnt vmcnt(9)
    ds_read_b64_tr_b16 v[32:33], v245 offset:29696
    ds_read_b64_tr_b16 v[34:35], v245 offset:30720
    ds_read_b64_tr_b16 v[36:37], v247 offset:29696
    ds_read_b64_tr_b16 v[38:39], v247 offset:30720
    ds_read_b64_tr_b16 v[40:41], v249 offset:29696
    ds_read_b64_tr_b16 v[42:43], v249 offset:30720
    ds_read_b64_tr_b16 v[44:45], v251 offset:29696
    ds_read_b64_tr_b16 v[46:47], v251 offset:30720
    s_waitcnt lgkmcnt(6)
    v_mfma_f32_16x16x32_bf16 v[64:67], v[164:167], v[32:35], v[64:67]
    v_mfma_f32_16x16x32_bf16 v[68:71], v[168:171], v[32:35], v[68:71]
    s_add_u32 m0, s23, 25600
    s_nop 0
    buffer_load_dwordx4 v224, s[44:47], s34 offen offset:0  lds
    s_waitcnt vmcnt(5)
    v_mfma_f32_16x16x32_bf16 v[72:75], v[172:175], v[32:35], v[72:75]
    v_mfma_f32_16x16x32_bf16 v[76:79], v[176:179], v[32:35], v[76:79]
    buffer_load_dwordx4 v225, s[44:47], s34 offen offset:1024  lds
    s_waitcnt vmcnt(5)
    v_mfma_f32_16x16x32_bf16 v[80:83], v[180:183], v[32:35], v[80:83]
    s_waitcnt lgkmcnt(4)
    v_mfma_f32_16x16x32_bf16 v[84:87], v[164:167], v[36:39], v[84:87]
    buffer_load_dwordx4 v226, s[44:47], s34 offen offset:2048  lds
    s_waitcnt vmcnt(5)
    v_mfma_f32_16x16x32_bf16 v[88:91], v[168:171], v[36:39], v[88:91]
    v_mfma_f32_16x16x32_bf16 v[92:95], v[172:175], v[36:39], v[92:95]
    buffer_load_dwordx4 v227, s[44:47], s34 offen offset:3072  lds
    s_waitcnt vmcnt(5)
    s_add_u32 s34, s34, 131072
    s_cmp_eq_u32 s34, 1572864
    s_cselect_b32 s34, 0, s34
    v_mfma_f32_16x16x32_bf16 v[96:99], v[176:179], v[36:39], v[96:99]
    v_mfma_f32_16x16x32_bf16 v[100:103], v[180:183], v[36:39], v[100:103]
    buffer_load_dwordx4 v[204:207], v228, s[12:15], s35 offen offset:0 sc1
    s_waitcnt vmcnt(5)
    s_waitcnt lgkmcnt(2)
    v_mfma_f32_16x16x32_bf16 v[104:107], v[164:167], v[40:43], v[104:107]
    v_mfma_f32_16x16x32_bf16 v[108:111], v[168:171], v[40:43], v[108:111]
    buffer_load_dwordx4 v[208:211], v228, s[12:15], s35 offen offset:256 sc1
    s_waitcnt vmcnt(5)
    v_mfma_f32_16x16x32_bf16 v[112:115], v[172:175], v[40:43], v[112:115]
    v_mfma_f32_16x16x32_bf16 v[116:119], v[176:179], v[40:43], v[116:119]
    buffer_load_dwordx4 v[212:215], v228, s[12:15], s35 offen offset:512 sc1
    s_waitcnt vmcnt(5)
    v_mfma_f32_16x16x32_bf16 v[120:123], v[180:183], v[40:43], v[120:123]
    s_waitcnt lgkmcnt(0)
    v_mfma_f32_16x16x32_bf16 v[124:127], v[164:167], v[44:47], v[124:127]
    buffer_load_dwordx4 v[216:219], v228, s[12:15], s35 offen offset:768 sc1
    s_waitcnt vmcnt(5)
    v_mfma_f32_16x16x32_bf16 v[128:131], v[168:171], v[44:47], v[128:131]
    v_mfma_f32_16x16x32_bf16 v[132:135], v[172:175], v[44:47], v[132:135]
    buffer_load_dwordx4 v[220:223], v228, s[12:15], s35 offen offset:1024 sc1
    s_waitcnt vmcnt(5)
    s_add_u32 s35, s35, 40960
    s_cmp_eq_u32 s35, 491520
    s_cselect_b32 s35, 0, s35
    v_mfma_f32_16x16x32_bf16 v[136:139], v[176:179], v[44:47], v[136:139]
    v_mfma_f32_16x16x32_bf16 v[140:143], v[180:183], v[44:47], v[140:143]
    s_waitcnt vmcnt(9)
    ds_read_b64_tr_b16 v[32:33], v245 offset:20480
    ds_read_b64_tr_b16 v[34:35], v245 offset:21504
    ds_read_b64_tr_b16 v[36:37], v247 offset:20480
    ds_read_b64_tr_b16 v[38:39], v247 offset:21504
    ds_read_b64_tr_b16 v[40:41], v249 offset:20480
    ds_read_b64_tr_b16 v[42:43], v249 offset:21504
    ds_read_b64_tr_b16 v[44:45], v251 offset:20480
    ds_read_b64_tr_b16 v[46:47], v251 offset:21504
    s_waitcnt lgkmcnt(6)
    v_mfma_f32_16x16x32_bf16 v[64:67], v[184:187], v[32:35], v[64:67]
    v_mfma_f32_16x16x32_bf16 v[68:71], v[188:191], v[32:35], v[68:71]
    s_add_u32 m0, s23, 29696
    s_nop 0
    buffer_load_dwordx4 v224, s[44:47], s34 offen offset:0  lds
    s_waitcnt vmcnt(5)
    v_mfma_f32_16x16x32_bf16 v[72:75], v[192:195], v[32:35], v[72:75]
    v_mfma_f32_16x16x32_bf16 v[76:79], v[196:199], v[32:35], v[76:79]
    buffer_load_dwordx4 v225, s[44:47], s34 offen offset:1024  lds
    s_waitcnt vmcnt(5)
    v_mfma_f32_16x16x32_bf16 v[80:83], v[200:203], v[32:35], v[80:83]
    s_waitcnt lgkmcnt(4)
    v_mfma_f32_16x16x32_bf16 v[84:87], v[184:187], v[36:39], v[84:87]
    buffer_load_dwordx4 v226, s[44:47], s34 offen offset:2048  lds
    s_waitcnt vmcnt(5)
    v_mfma_f32_16x16x32_bf16 v[88:91], v[188:191], v[36:39], v[88:91]
    v_mfma_f32_16x16x32_bf16 v[92:95], v[192:195], v[36:39], v[92:95]
    buffer_load_dwordx4 v227, s[44:47], s34 offen offset:3072  lds
    s_waitcnt vmcnt(5)
    s_add_u32 s34, s34, 131072
    s_cmp_eq_u32 s34, 1572864
    s_cselect_b32 s34, 0, s34
    v_mfma_f32_16x16x32_bf16 v[96:99], v[196:199], v[36:39], v[96:99]
    v_mfma_f32_16x16x32_bf16 v[100:103], v[200:203], v[36:39], v[100:103]
    buffer_load_dwordx4 v[144:147], v228, s[12:15], s35 offen offset:0 sc1
    s_waitcnt vmcnt(5)
    s_waitcnt lgkmcnt(2)
    v_mfma_f32_16x16x32_bf16 v[104:107], v[184:187], v[40:43], v[104:107]
    v_mfma_f32_16x16x32_bf16 v[108:111], v[188:191], v[40:43], v[108:111]
    buffer_load_dwordx4 v[148:151], v228, s[12:15], s35 offen offset:256 sc1
    s_waitcnt vmcnt(5)
    v_mfma_f32_16x16x32_bf16 v[112:115], v[192:195], v[40:43], v[112:115]
    v_mfma_f32_16x16x32_bf16 v[116:119], v[196:199], v[40:43], v[116:119]
    buffer_load_dwordx4 v[152:155], v228, s[12:15], s35 offen offset:512 sc1
    s_waitcnt vmcnt(5)
    v_mfma_f32_16x16x32_bf16 v[120:123], v[200:203], v[40:43], v[120:123]
    s_waitcnt lgkmcnt(0)
    v_mfma_f32_16x16x32_bf16 v[124:127], v[184:187], v[44:47], v[124:127]
    buffer_load_dwordx4 v[156:159], v228, s[12:15], s35 offen offset:768 sc1
    s_waitcnt vmcnt(5)
    v_mfma_f32_16x16x32_bf16 v[128:131], v[188:191], v[44:47], v[128:131]
    v_mfma_f32_16x16x32_bf16 v[132:135], v[192:195], v[44:47], v[132:135]
    buffer_load_dwordx4 v[160:163], v228, s[12:15], s35 offen offset:1024 sc1
    s_waitcnt vmcnt(5)
    s_add_u32 s35, s35, 40960
    s_cmp_eq_u32 s35, 491520
    s_cselect_b32 s35, 0, s35
    v_mfma_f32_16x16x32_bf16 v[136:139], v[196:199], v[44:47], v[136:139]
    v_mfma_f32_16x16x32_bf16 v[140:143], v[200:203], v[44:47], v[140:143]
    s_waitcnt vmcnt(9)
    ds_read_b64_tr_b16 v[32:33], v245 offset:25600
    ds_read_b64_tr_b16 v[34:35], v245 offset:26624
    ds_read_b64_tr_b16 v[36:37], v247 offset:25600
    ds_read_b64_tr_b16 v[38:39], v247 offset:26624
    ds_read_b64_tr_b16 v[40:41], v249 offset:25600
    ds_read_b64_tr_b16 v[42:43], v249 offset:26624
    ds_read_b64_tr_b16 v[44:45], v251 offset:25600
    ds_read_b64_tr_b16 v[46:47], v251 offset:26624
    s_waitcnt lgkmcnt(6)
    v_mfma_f32_16x16x32_bf16 v[64:67], v[204:207], v[32:35], v[64:67]
    v_mfma_f32_16x16x32_bf16 v[68:71], v[208:211], v[32:35], v[68:71]
    s_add_u32 m0, s23, 20480
    s_nop 0
    buffer_load_dwordx4 v224, s[44:47], s34 offen offset:0  lds
    s_waitcnt vmcnt(5)
    v_mfma_f32_16x16x32_bf16 v[72:75], v[212:215], v[32:35], v[72:75]
    v_mfma_f32_16x16x32_bf16 v[76:79], v[216:219], v[32:35], v[76:79]
    buffer_load_dwordx4 v225, s[44:47], s34 offen offset:1024  lds
    s_waitcnt vmcnt(5)
    v_mfma_f32_16x16x32_bf16 v[80:83], v[220:223], v[32:35], v[80:83]
    s_waitcnt lgkmcnt(4)
    v_mfma_f32_16x16x32_bf16 v[84:87], v[204:207], v[36:39], v[84:87]
    buffer_load_dwordx4 v226, s[44:47], s34 offen offset:2048  lds
    s_waitcnt vmcnt(5)
    v_mfma_f32_16x16x32_bf16 v[88:91], v[208:211], v[36:39], v[88:91]
    v_mfma_f32_16x16x32_bf16 v[92:95], v[212:215], v[36:39], v[92:95]
    buffer_load_dwordx4 v227, s[44:47], s34 offen offset:3072  lds
    s_waitcnt vmcnt(5)
    s_add_u32 s34, s34, 131072
    s_cmp_eq_u32 s34, 1572864
    s_cselect_b32 s34, 0, s34
    v_mfma_f32_16x16x32_bf16 v[96:99], v[216:219], v[36:39], v[96:99]
    v_mfma_f32_16x16x32_bf16 v[100:103], v[220:223], v[36:39], v[100:103]
    buffer_load_dwordx4 v[164:167], v228, s[12:15], s35 offen offset:0 sc1
    s_waitcnt vmcnt(5)
    s_waitcnt lgkmcnt(2)
    v_mfma_f32_16x16x32_bf16 v[104:107], v[204:207], v[40:43], v[104:107]
    v_mfma_f32_16x16x32_bf16 v[108:111], v[208:211], v[40:43], v[108:111]
    buffer_load_dwordx4 v[168:171], v228, s[12:15], s35 offen offset:256 sc1
    s_waitcnt vmcnt(5)
    v_mfma_f32_16x16x32_bf16 v[112:115], v[212:215], v[40:43], v[112:115]
    v_mfma_f32_16x16x32_bf16 v[116:119], v[216:219], v[40:43], v[116:119]
    buffer_load_dwordx4 v[172:175], v228, s[12:15], s35 offen offset:512 sc1
    s_waitcnt vmcnt(5)
    v_mfma_f32_16x16x32_bf16 v[120:123], v[220:223], v[40:43], v[120:123]
    s_waitcnt lgkmcnt(0)
    v_mfma_f32_16x16x32_bf16 v[124:127], v[204:207], v[44:47], v[124:127]
    buffer_load_dwordx4 v[176:179], v228, s[12:15], s35 offen offset:768 sc1
    s_waitcnt vmcnt(5)
    v_mfma_f32_16x16x32_bf16 v[128:131], v[208:211], v[44:47], v[128:131]
    v_mfma_f32_16x16x32_bf16 v[132:135], v[212:215], v[44:47], v[132:135]
    buffer_load_dwordx4 v[180:183], v228, s[12:15], s35 offen offset:1024 sc1
    s_waitcnt vmcnt(5)
    s_add_u32 s35, s35, 40960
    s_cmp_eq_u32 s35, 491520
    s_cselect_b32 s35, 0, s35
    v_mfma_f32_16x16x32_bf16 v[136:139], v[216:219], v[44:47], v[136:139]
    v_mfma_f32_16x16x32_bf16 v[140:143], v[220:223], v[44:47], v[140:143]
    s_waitcnt vmcnt(9)
    ds_read_b64_tr_b16 v[32:33], v245 offset:29696
    ds_read_b64_tr_b16 v[34:35], v245 offset:30720
    ds_read_b64_tr_b16 v[36:37], v247 offset:29696
    ds_read_b64_tr_b16 v[38:39], v247 offset:30720
    ds_read_b64_tr_b16 v[40:41], v249 offset:29696
    ds_read_b64_tr_b16 v[42:43], v249 offset:30720
    ds_read_b64_tr_b16 v[44:45], v251 offset:29696
    ds_read_b64_tr_b16 v[46:47], v251 offset:30720
    s_waitcnt lgkmcnt(6)
    v_mfma_f32_16x16x32_bf16 v[64:67], v[144:147], v[32:35], v[64:67]
    v_mfma_f32_16x16x32_bf16 v[68:71], v[148:151], v[32:35], v[68:71]
    s_add_u32 m0, s23, 25600
    s_nop 0
    buffer_load_dwordx4 v224, s[44:47], s34 offen offset:0  lds
    s_waitcnt vmcnt(5)
    v_mfma_f32_16x16x32_bf16 v[72:75], v[152:155], v[32:35], v[72:75]
    v_mfma_f32_16x16x32_bf16 v[76:79], v[156:159], v[32:35], v[76:79]
    buffer_load_dwordx4 v225, s[44:47], s34 offen offset:1024  lds
    s_waitcnt vmcnt(5)
    v_mfma_f32_16x16x32_bf16 v[80:83], v[160:163], v[32:35], v[80:83]
    s_waitcnt lgkmcnt(4)
    v_mfma_f32_16x16x32_bf16 v[84:87], v[144:147], v[36:39], v[84:87]
    buffer_load_dwordx4 v226, s[44:47], s34 offen offset:2048  lds
    s_waitcnt vmcnt(5)
    v_mfma_f32_16x16x32_bf16 v[88:91], v[148:151], v[36:39], v[88:91]
    v_mfma_f32_16x16x32_bf16 v[92:95], v[152:155], v[36:39], v[92:95]
    buffer_load_dwordx4 v227, s[44:47], s34 offen offset:3072  lds
    s_waitcnt vmcnt(5)
    s_add_u32 s34, s34, 131072
    s_cmp_eq_u32 s34, 1572864
    s_cselect_b32 s34, 0, s34
    v_mfma_f32_16x16x32_bf16 v[96:99], v[156:159], v[36:39], v[96:99]
    v_mfma_f32_16x16x32_bf16 v[100:103], v[160:163], v[36:39], v[100:103]
    buffer_load_dwordx4 v[184:187], v228, s[12:15], s35 offen offset:0 sc1
    s_waitcnt vmcnt(5)
    s_waitcnt lgkmcnt(2)
    v_mfma_f32_16x16x32_bf16 v[104:107], v[144:147], v[40:43], v[104:107]
    v_mfma_f32_16x16x32_bf16 v[108:111], v[148:151], v[40:43], v[108:111]
    buffer_load_dwordx4 v[188:191], v228, s[12:15], s35 offen offset:256 sc1
    s_waitcnt vmcnt(5)
    v_mfma_f32_16x16x32_bf16 v[112:115], v[152:155], v[40:43], v[112:115]
    v_mfma_f32_16x16x32_bf16 v[116:119], v[156:159], v[40:43], v[116:119]
    buffer_load_dwordx4 v[192:195], v228, s[12:15], s35 offen offset:512 sc1
    s_waitcnt vmcnt(5)
    v_mfma_f32_16x16x32_bf16 v[120:123], v[160:163], v[40:43], v[120:123]
    s_waitcnt lgkmcnt(0)
    v_mfma_f32_16x16x32_bf16 v[124:127], v[144:147], v[44:47], v[124:127]
    buffer_load_dwordx4 v[196:199], v228, s[12:15], s35 offen offset:768 sc1
    s_waitcnt vmcnt(5)
    v_mfma_f32_16x16x32_bf16 v[128:131], v[148:151], v[44:47], v[128:131]
    v_mfma_f32_16x16x32_bf16 v[132:135], v[152:155], v[44:47], v[132:135]
    buffer_load_dwordx4 v[200:203], v228, s[12:15], s35 offen offset:1024 sc1
    s_waitcnt vmcnt(5)
    s_add_u32 s35, s35, 40960
    s_cmp_eq_u32 s35, 491520
    s_cselect_b32 s35, 0, s35
    v_mfma_f32_16x16x32_bf16 v[136:139], v[156:159], v[44:47], v[136:139]
    v_mfma_f32_16x16x32_bf16 v[140:143], v[160:163], v[44:47], v[140:143]
    s_add_u32 m0, s23, 29696
    s_nop 0
    buffer_load_dwordx4 v224, s[44:47], s34 offen offset:0  lds
    s_waitcnt vmcnt(5)
    buffer_load_dwordx4 v225, s[44:47], s34 offen offset:1024  lds
    s_waitcnt vmcnt(5)
    buffer_load_dwordx4 v226, s[44:47], s34 offen offset:2048  lds
    s_waitcnt vmcnt(5)
    buffer_load_dwordx4 v227, s[44:47], s34 offen offset:3072  lds
    s_waitcnt vmcnt(5)
    s_add_u32 s34, s34, 131072
    s_cmp_eq_u32 s34, 1572864
    s_cselect_b32 s34, 0, s34
    buffer_load_dwordx4 v[204:207], v228, s[12:15], s35 offen offset:0 sc1
    s_waitcnt vmcnt(5)
    buffer_load_dwordx4 v[208:211], v228, s[12:15], s35 offen offset:256 sc1
    s_waitcnt vmcnt(5)
    buffer_load_dwordx4 v[212:215], v228, s[12:15], s35 offen offset:512 sc1
    s_waitcnt vmcnt(5)
    buffer_load_dwordx4 v[216:219], v228, s[12:15], s35 offen offset:768 sc1
    s_waitcnt vmcnt(5)
    buffer_load_dwordx4 v[220:223], v228, s[12:15], s35 offen offset:1024 sc1
    s_waitcnt vmcnt(5)
    s_add_u32 s35, s35, 40960
    s_cmp_eq_u32 s35, 491520
    s_cselect_b32 s35, 0, s35
    s_setprio 3
    s_lshl_b32 s3, s77, 8
    v_lshlrev_b32 v2, 15, v230
    v_lshl_add_u32 v2, v231, 4, v2
    v_add_u32 v2, s3, v2
    v_xor_b32 v3, 256, v2
    v_xor_b32 v4, 512, v2
    v_xor_b32 v5, 768, v2
    v_lshrrev_b32 v6, 1, v2
    v_lshrrev_b32 v7, 1, v3
    v_lshrrev_b32 v8, 1, v4
    v_lshrrev_b32 v9, 1, v5
    s_lshl_b32 s26, s77, 19
    s_lshl_b32 s3, s30, 10
    s_add_u32 s26, s26, s3
    s_lshr_b32 s3, s3, 1
    s_add_u32 s26, s26, 13205504
    s_lshl_b32 s27, s77, 17
    s_add_u32 s27, s27, s3
    s_add_u32 s27, s27, 15302656
    s_add_u32 s29, s27, 0x10000
    v_mul_u32_u24 v10, 1280, v231
    v_lshl_add_u32 v10, v230, 3, v10
    s_mul_i32 s28, s24, 20480
    s_mul_i32 s3, s31, 160
    s_add_u32 s28, s28, s3
    v_lshl_add_u32 v11, v1, 4, s23
    v_and_b32 v12, 7, v1
    s_lshl_b32 s3, s30, 2
    s_add_u32 s3, s3, s77
    s_lshl_b32 s3, s3, 10
    s_add_u32 s3, s3, 98304
    v_lshl_add_u32 v14, v12, 7, s3
    v_mul_u32_u24 v10, 160, v231
    v_lshl_add_u32 v10, v230, 3, v10
    v_add_u32 v10, s23, v10
    v_add_u32 v12, 128, v1
    v_mul_u32_u24 v13, 205, v12
    v_lshrrev_b32 v13, 11, v13
    v_mul_u32_u24 v13, 1120, v13
    v_lshl_add_u32 v255, v12, 4, v13
    v_add_u32 v12, 64, v1
    v_mul_u32_u24 v13, 205, v12
    v_lshrrev_b32 v13, 11, v13
    v_mul_u32_u24 v13, 1120, v13
    v_lshl_add_u32 v15, v12, 4, v13
    v_add_u32 v12, 0, v1
    v_mul_u32_u24 v13, 205, v12
    v_lshrrev_b32 v13, 11, v13
    v_mul_u32_u24 v13, 1120, v13
    v_lshl_add_u32 v1, v12, 4, v13
    v_sub_f32 v244, 1.0, v244
    v_sub_f32 v246, 1.0, v246
    v_sub_f32 v248, 1.0, v248
    v_sub_f32 v250, 1.0, v250
    v_lshlrev_b32 v252, 16, v252
    v_mul_f32 v252, v252, v244
    s_setprio 0
    s_waitcnt vmcnt(0)
    ds_read_b64_tr_b16 v[32:33], v245 offset:20480
    ds_read_b64_tr_b16 v[34:35], v245 offset:21504
    ds_read_b64_tr_b16 v[36:37], v247 offset:20480
    ds_read_b64_tr_b16 v[38:39], v247 offset:21504
    ds_read_b64_tr_b16 v[40:41], v249 offset:20480
    ds_read_b64_tr_b16 v[42:43], v249 offset:21504
    ds_read_b64_tr_b16 v[44:45], v251 offset:20480
    ds_read_b64_tr_b16 v[46:47], v251 offset:21504
    s_waitcnt lgkmcnt(0)
    s_mov_b32 s32, 163840
    s_add_u32 s3, s23, 20480
    s_mov_b32 m0, s3
    s_nop 0
    buffer_load_dwordx4 v232, s[48:51], s32 offen offset:0  lds
    s_waitcnt vmcnt(5)
    buffer_load_dwordx4 v233, s[48:51], s32 offen offset:1024  lds
    s_waitcnt vmcnt(5)
    buffer_load_dwordx4 v234, s[48:51], s32 offen offset:2048  lds
    s_waitcnt vmcnt(5)
    buffer_load_dwordx4 v235, s[48:51], s32 offen offset:3072  lds
    s_waitcnt vmcnt(5)
    s_add_u32 m0, s3, 4096
    s_nop 0
    buffer_load_dwordx4 v236, s[48:51], s32 offen offset:0  lds
    s_waitcnt vmcnt(5)
    s_setprio 3
    s_mov_b32 s82, 262144
L_lw_30:
    ds_read_b32 v12, v254 offset:24
    s_waitcnt lgkmcnt(0)
    v_readfirstlane_b32 s3, v12
    s_nop 0
    s_cmp_ge_u32 s3, 4
    s_cbranch_scc1 L_lwd_31
    s_sleep 2
    s_sub_u32 s82, s82, 1
    s_cmp_lg_u32 s82, 0
    s_cbranch_scc1 L_lw_30
L_lwd_31:
    s_setprio 0
    s_waitcnt lgkmcnt(0)
    v_mfma_f32_16x16x32_bf16 v[64:67], v[164:167], v[32:35], v[64:67]
    ds_read_b64_tr_b16 v[16:17], v245 offset:25600
    v_mfma_f32_16x16x32_bf16 v[68:71], v[168:171], v[32:35], v[68:71]
    ds_read_b64_tr_b16 v[18:19], v245 offset:26624
    v_mfma_f32_16x16x32_bf16 v[72:75], v[172:175], v[32:35], v[72:75]
    ds_read_b64_tr_b16 v[20:21], v247 offset:25600
    v_mfma_f32_16x16x32_bf16 v[76:79], v[176:179], v[32:35], v[76:79]
    ds_read_b64_tr_b16 v[22:23], v247 offset:26624
    v_mfma_f32_16x16x32_bf16 v[80:83], v[180:183], v[32:35], v[80:83]
    ds_read_b64_tr_b16 v[56:57], v249 offset:25600
    v_mfma_f32_16x16x32_bf16 v[84:87], v[164:167], v[36:39], v[84:87]
    ds_read_b64_tr_b16 v[58:59], v249 offset:26624
    v_mfma_f32_16x16x32_bf16 v[88:91], v[168:171], v[36:39], v[88:91]
    ds_read_b64_tr_b16 v[60:61], v251 offset:25600
    v_mfma_f32_16x16x32_bf16 v[92:95], v[172:175], v[36:39], v[92:95]
    ds_read_b64_tr_b16 v[62:63], v251 offset:26624
    v_mfma_f32_16x16x32_bf16 v[96:99], v[176:179], v[36:39], v[96:99]
    ds_read_b64_tr_b16 v[144:145], v253 offset:0
    v_mfma_f32_16x16x32_bf16 v[100:103], v[180:183], v[36:39], v[100:103]
    ds_read_b64_tr_b16 v[146:147], v253 offset:1280
    v_mfma_f32_16x16x32_bf16 v[104:107], v[164:167], v[40:43], v[104:107]
    ds_read_b64_tr_b16 v[148:149], v253 offset:32
    v_mfma_f32_16x16x32_bf16 v[108:111], v[168:171], v[40:43], v[108:111]
    ds_read_b64_tr_b16 v[150:151], v253 offset:1312
    v_mfma_f32_16x16x32_bf16 v[112:115], v[172:175], v[40:43], v[112:115]
    ds_read_b64_tr_b16 v[152:153], v253 offset:64
    v_mfma_f32_16x16x32_bf16 v[116:119], v[176:179], v[40:43], v[116:119]
    ds_read_b64_tr_b16 v[154:155], v253 offset:1344
    v_mfma_f32_16x16x32_bf16 v[120:123], v[180:183], v[40:43], v[120:123]
    ds_read_b64_tr_b16 v[156:157], v253 offset:96
    v_mfma_f32_16x16x32_bf16 v[124:127], v[164:167], v[44:47], v[124:127]
    ds_read_b64_tr_b16 v[158:159], v253 offset:1376
    v_mfma_f32_16x16x32_bf16 v[128:131], v[168:171], v[44:47], v[128:131]
    ds_read_b64_tr_b16 v[160:161], v253 offset:128
    v_mfma_f32_16x16x32_bf16 v[132:135], v[172:175], v[44:47], v[132:135]
    ds_read_b64_tr_b16 v[162:163], v253 offset:1408
    v_mfma_f32_16x16x32_bf16 v[136:139], v[176:179], v[44:47], v[136:139]
    v_mfma_f32_16x16x32_bf16 v[140:143], v[180:183], v[44:47], v[140:143]
    s_waitcnt lgkmcnt(10)
    v_mfma_f32_16x16x32_bf16 v[64:67], v[184:187], v[16:19], v[64:67]
    ds_read_b64_tr_b16 v[32:33], v245 offset:29696
    v_mfma_f32_16x16x32_bf16 v[68:71], v[188:191], v[16:19], v[68:71]
    ds_read_b64_tr_b16 v[34:35], v245 offset:30720
    v_mfma_f32_16x16x32_bf16 v[72:75], v[192:195], v[16:19], v[72:75]
    ds_read_b64_tr_b16 v[36:37], v247 offset:29696
    v_mfma_f32_16x16x32_bf16 v[76:79], v[196:199], v[16:19], v[76:79]
    ds_read_b64_tr_b16 v[38:39], v247 offset:30720
    v_mfma_f32_16x16x32_bf16 v[80:83], v[200:203], v[16:19], v[80:83]
    ds_read_b64_tr_b16 v[40:41], v249 offset:29696
    v_mfma_f32_16x16x32_bf16 v[84:87], v[184:187], v[20:23], v[84:87]
    ds_read_b64_tr_b16 v[42:43], v249 offset:30720
    v_mfma_f32_16x16x32_bf16 v[88:91], v[188:191], v[20:23], v[88:91]
    ds_read_b64_tr_b16 v[44:45], v251 offset:29696
    v_mfma_f32_16x16x32_bf16 v[92:95], v[192:195], v[20:23], v[92:95]
    ds_read_b64_tr_b16 v[46:47], v251 offset:30720
    v_mfma_f32_16x16x32_bf16 v[96:99], v[196:199], v[20:23], v[96:99]
    ds_read_b64_tr_b16 v[164:165], v253 offset:6400
    v_mfma_f32_16x16x32_bf16 v[100:103], v[200:203], v[20:23], v[100:103]
    ds_read_b64_tr_b16 v[166:167], v253 offset:7680
    v_mfma_f32_16x16x32_bf16 v[104:107], v[184:187], v[56:59], v[104:107]
    ds_read_b64_tr_b16 v[168:169], v253 offset:6432
    v_mfma_f32_16x16x32_bf16 v[108:111], v[188:191], v[56:59], v[108:111]
    ds_read_b64_tr_b16 v[170:171], v253 offset:7712
    v_mfma_f32_16x16x32_bf16 v[112:115], v[192:195], v[56:59], v[112:115]
    ds_read_b64_tr_b16 v[172:173], v253 offset:6464
    v_mfma_f32_16x16x32_bf16 v[116:119], v[196:199], v[56:59], v[116:119]
    ds_read_b64_tr_b16 v[174:175], v253 offset:7744
    v_mfma_f32_16x16x32_bf16 v[120:123], v[200:203], v[56:59], v[120:123]
    ds_read_b64_tr_b16 v[176:177], v253 offset:6496
    v_mfma_f32_16x16x32_bf16 v[124:127], v[184:187], v[60:63], v[124:127]
    ds_read_b64_tr_b16 v[178:179], v253 offset:7776
    v_mfma_f32_16x16x32_bf16 v[128:131], v[188:191], v[60:63], v[128:131]
    ds_read_b64_tr_b16 v[180:181], v253 offset:6528
    v_mfma_f32_16x16x32_bf16 v[132:135], v[192:195], v[60:63], v[132:135]
    ds_read_b64_tr_b16 v[182:183], v253 offset:7808
    v_mfma_f32_16x16x32_bf16 v[136:139], v[196:199], v[60:63], v[136:139]
    v_mfma_f32_16x16x32_bf16 v[140:143], v[200:203], v[60:63], v[140:143]
    v_mov_b32 v12, 0
    v_mov_b32 v13, 0
    s_mov_b64 exec, 0xff
    buffer_atomic_add_x2 v[12:13], v14, s[12:15], 0 offen sc0 sc1
    s_mov_b64 exec, -1
    s_waitcnt lgkmcnt(10)
    v_mfma_f32_16x16x32_bf16 v[64:67], v[204:207], v[32:35], v[64:67]
    ds_read_b64_tr_b16 v[184:185], v253 offset:12800
    v_mfma_f32_16x16x32_bf16 v[68:71], v[208:211], v[32:35], v[68:71]
    ds_read_b64_tr_b16 v[186:187], v253 offset:14080
    v_mfma_f32_16x16x32_bf16 v[72:75], v[212:215], v[32:35], v[72:75]
    ds_read_b64_tr_b16 v[188:189], v253 offset:12832
    v_mfma_f32_16x16x32_bf16 v[76:79], v[216:219], v[32:35], v[76:79]
    ds_read_b64_tr_b16 v[190:191], v253 offset:14112
    v_mfma_f32_16x16x32_bf16 v[80:83], v[220:223], v[32:35], v[80:83]
    ds_read_b64_tr_b16 v[192:193], v253 offset:12864
    v_mfma_f32_16x16x32_bf16 v[84:87], v[204:207], v[36:39], v[84:87]
    ds_read_b64_tr_b16 v[194:195], v253 offset:14144
    v_mfma_f32_16x16x32_bf16 v[88:91], v[208:211], v[36:39], v[88:91]
    ds_read_b64_tr_b16 v[196:197], v253 offset:12896
    v_mfma_f32_16x16x32_bf16 v[92:95], v[212:215], v[36:39], v[92:95]
    ds_read_b64_tr_b16 v[198:199], v253 offset:14176
    v_mfma_f32_16x16x32_bf16 v[96:99], v[216:219], v[36:39], v[96:99]
    ds_read_b64_tr_b16 v[200:201], v253 offset:12928
    v_mfma_f32_16x16x32_bf16 v[100:103], v[220:223], v[36:39], v[100:103]
    ds_read_b64_tr_b16 v[202:203], v253 offset:14208
    v_mfma_f32_16x16x32_bf16 v[104:107], v[204:207], v[40:43], v[104:107]
    v_mfma_f32_16x16x32_bf16 v[108:111], v[208:211], v[40:43], v[108:111]
    v_mfma_f32_16x16x32_bf16 v[112:115], v[212:215], v[40:43], v[112:115]
    v_mfma_f32_16x16x32_bf16 v[116:119], v[216:219], v[40:43], v[116:119]
    v_mfma_f32_16x16x32_bf16 v[120:123], v[220:223], v[40:43], v[120:123]
    v_mfma_f32_16x16x32_bf16 v[124:127], v[204:207], v[44:47], v[124:127]
    v_mfma_f32_16x16x32_bf16 v[128:131], v[208:211], v[44:47], v[128:131]
    v_mfma_f32_16x16x32_bf16 v[132:135], v[212:215], v[44:47], v[132:135]
    v_mfma_f32_16x16x32_bf16 v[136:139], v[216:219], v[44:47], v[136:139]
    v_mfma_f32_16x16x32_bf16 v[140:143], v[220:223], v[44:47], v[140:143]
    s_setprio 3
    s_waitcnt vmcnt(1)
    ds_read_b64_tr_b16 v[224:225], v0 offset:0
    ds_read_b64_tr_b16 v[226:227], v0 offset:12800
    ds_read_b64_tr_b16 v[228:229], v0 offset:32
    ds_read_b64_tr_b16 v[230:231], v0 offset:12832
    ds_read_b64_tr_b16 v[232:233], v0 offset:64
    ds_read_b64_tr_b16 v[234:235], v0 offset:12864
    ds_read_b64_tr_b16 v[236:237], v0 offset:96
    ds_read_b64_tr_b16 v[238:239], v0 offset:12896
    ds_read_b64_tr_b16 v[240:241], v0 offset:128
    ds_read_b64_tr_b16 v[242:243], v0 offset:12928
    ds_read_b64_tr_b16 v[204:205], v253 offset:19200
    ds_read_b64_tr_b16 v[206:207], v253 offset:20480
    ds_read_b64_tr_b16 v[208:209], v253 offset:19232
    ds_read_b64_tr_b16 v[210:211], v253 offset:20512
    ds_read_b64_tr_b16 v[212:213], v253 offset:19264
    ds_read_b64_tr_b16 v[214:215], v253 offset:20544
    ds_read_b64_tr_b16 v[216:217], v253 offset:19296
    ds_read_b64_tr_b16 v[218:219], v253 offset:20576
    ds_read_b64_tr_b16 v[220:221], v253 offset:19328
    ds_read_b64_tr_b16 v[222:223], v253 offset:20608
    s_xor_b32 s3, s77, 1
    s_mul_i32 s3, s3, 33792
    s_sub_u32 s3, s3, s23
    v_add_u32 v245, s3, v11
    s_xor_b32 s3, s77, 2
    s_mul_i32 s3, s3, 33792
    s_sub_u32 s3, s3, s23
    v_add_u32 v247, s3, v11
    s_xor_b32 s3, s77, 3
    s_mul_i32 s3, s3, 33792
    s_sub_u32 s3, s3, s23
    v_add_u32 v249, s3, v11
    v_pk_fma_f32 v[64:65], v[64:65], v[244:245], v[252:253] op_sel_hi:[1,0,0]
    v_pk_fma_f32 v[66:67], v[66:67], v[244:245], v[252:253] op_sel_hi:[1,0,0]
    v_pk_fma_f32 v[68:69], v[68:69], v[244:245], v[252:253] op_sel_hi:[1,0,0]
    v_pk_fma_f32 v[70:71], v[70:71], v[244:245], v[252:253] op_sel_hi:[1,0,0]
    v_pk_fma_f32 v[72:73], v[72:73], v[244:245], v[252:253] op_sel_hi:[1,0,0]
    v_pk_fma_f32 v[74:75], v[74:75], v[244:245], v[252:253] op_sel_hi:[1,0,0]
    v_pk_fma_f32 v[76:77], v[76:77], v[244:245], v[252:253] op_sel_hi:[1,0,0]
    v_pk_fma_f32 v[78:79], v[78:79], v[244:245], v[252:253] op_sel_hi:[1,0,0]
    v_pk_fma_f32 v[80:81], v[80:81], v[244:245], v[252:253] op_sel_hi:[1,0,0]
    v_pk_fma_f32 v[82:83], v[82:83], v[244:245], v[252:253] op_sel_hi:[1,0,0]
    v_pk_mul_f32 v[84:85], v[84:85], v[246:247] op_sel_hi:[1,0]
    v_pk_mul_f32 v[86:87], v[86:87], v[246:247] op_sel_hi:[1,0]
    v_pk_mul_f32 v[88:89], v[88:89], v[246:247] op_sel_hi:[1,0]
    v_pk_mul_f32 v[90:91], v[90:91], v[246:247] op_sel_hi:[1,0]
    v_pk_mul_f32 v[92:93], v[92:93], v[246:247] op_sel_hi:[1,0]
    v_pk_mul_f32 v[94:95], v[94:95], v[246:247] op_sel_hi:[1,0]
    v_pk_mul_f32 v[96:97], v[96:97], v[246:247] op_sel_hi:[1,0]
    v_pk_mul_f32 v[98:99], v[98:99], v[246:247] op_sel_hi:[1,0]
    v_pk_mul_f32 v[100:101], v[100:101], v[246:247] op_sel_hi:[1,0]
    v_pk_mul_f32 v[102:103], v[102:103], v[246:247] op_sel_hi:[1,0]
    v_pk_mul_f32 v[104:105], v[104:105], v[248:249] op_sel_hi:[1,0]
    v_pk_mul_f32 v[106:107], v[106:107], v[248:249] op_sel_hi:[1,0]
    v_pk_mul_f32 v[108:109], v[108:109], v[248:249] op_sel_hi:[1,0]
    v_pk_mul_f32 v[110:111], v[110:111], v[248:249] op_sel_hi:[1,0]
    v_pk_mul_f32 v[112:113], v[112:113], v[248:249] op_sel_hi:[1,0]
    v_pk_mul_f32 v[114:115], v[114:115], v[248:249] op_sel_hi:[1,0]
    v_pk_mul_f32 v[116:117], v[116:117], v[248:249] op_sel_hi:[1,0]
    v_pk_mul_f32 v[118:119], v[118:119], v[248:249] op_sel_hi:[1,0]
    v_pk_mul_f32 v[120:121], v[120:121], v[248:249] op_sel_hi:[1,0]
    v_pk_mul_f32 v[122:123], v[122:123], v[248:249] op_sel_hi:[1,0]
    v_pk_mul_f32 v[124:125], v[124:125], v[250:251] op_sel_hi:[1,0]
    v_pk_mul_f32 v[126:127], v[126:127], v[250:251] op_sel_hi:[1,0]
    v_pk_mul_f32 v[128:129], v[128:129], v[250:251] op_sel_hi:[1,0]
    v_pk_mul_f32 v[130:131], v[130:131], v[250:251] op_sel_hi:[1,0]
    v_pk_mul_f32 v[132:133], v[132:133], v[250:251] op_sel_hi:[1,0]
    v_pk_mul_f32 v[134:135], v[134:135], v[250:251] op_sel_hi:[1,0]
    v_pk_mul_f32 v[136:137], v[136:137], v[250:251] op_sel_hi:[1,0]
    v_pk_mul_f32 v[138:139], v[138:139], v[250:251] op_sel_hi:[1,0]
    v_pk_mul_f32 v[140:141], v[140:141], v[250:251] op_sel_hi:[1,0]
    v_pk_mul_f32 v[142:143], v[142:143], v[250:251] op_sel_hi:[1,0]
    s_mov_b32 s82, 65536
    s_waitcnt lgkmcnt(0)
    s_branch L_o_eval
L_o_poll:
    s_mov_b32 exec_lo, s17
    s_mov_b32 exec_hi, 0
    v_mov_b32 v12, 0
    v_mov_b32 v13, 0
    buffer_atomic_add_x2 v[12:13], v14, s[12:15], 0 offen sc0 sc1
    s_mov_b64 exec, -1
L_o_eval:
    s_sub_u32 s82, s82, 1
    s_cselect_b32 s17, 0, 0xff
    s_waitcnt vmcnt(0)
    v_cmp_ne_u64 vcc, s[74:75], v[12:13]
    s_nop 0
    s_and_b32 s17, s17, vcc_lo
    s_cbranch_scc1 L_o_poll
L_o_all:
    s_add_u32 s16, s26, 131072
    s_add_u32 s17, s26, 262144
    s_add_u32 s18, s26, 393216
    buffer_load_dwordx4 v[16:19], v3, s[12:15], s26 offen sc1
    buffer_load_dwordx4 v[20:23], v3, s[12:15], s16 offen sc1
    buffer_load_dwordx4 v[24:27], v3, s[12:15], s17 offen sc1
    buffer_load_dwordx4 v[28:31], v3, s[12:15], s18 offen sc1
    buffer_load_dwordx2 v[32:33], v7, s[12:15], s27 offen sc1
    buffer_load_dwordx2 v[34:35], v7, s[12:15], s29 offen sc1
    buffer_load_dwordx4 v[36:39], v4, s[12:15], s26 offen sc1
    buffer_load_dwordx4 v[40:43], v4, s[12:15], s16 offen sc1
    buffer_load_dwordx4 v[44:47], v4, s[12:15], s17 offen sc1
    buffer_load_dwordx4 v[48:51], v4, s[12:15], s18 offen sc1
    buffer_load_dwordx2 v[52:53], v8, s[12:15], s27 offen sc1
    buffer_load_dwordx2 v[54:55], v8, s[12:15], s29 offen sc1
    buffer_load_dwordx4 v[56:59], v5, s[12:15], s26 offen sc1
    buffer_load_dwordx4 v[60:63], v5, s[12:15], s16 offen sc1
    s_waitcnt vmcnt(13)
    v_mfma_f32_16x16x32_bf16 v[84:87], v[144:147], v[16:19], v[84:87]
    v_mfma_f32_16x16x32_bf16 v[88:91], v[148:151], v[16:19], v[88:91]
    v_mfma_f32_16x16x32_bf16 v[92:95], v[152:155], v[16:19], v[92:95]
    v_mfma_f32_16x16x32_bf16 v[96:99], v[156:159], v[16:19], v[96:99]
    v_mfma_f32_16x16x32_bf16 v[100:103], v[160:163], v[16:19], v[100:103]
    buffer_load_dwordx4 v[16:19], v5, s[12:15], s17 offen sc1
    s_waitcnt vmcnt(13)
    v_mfma_f32_16x16x32_bf16 v[84:87], v[164:167], v[20:23], v[84:87]
    v_mfma_f32_16x16x32_bf16 v[88:91], v[168:171], v[20:23], v[88:91]
    v_mfma_f32_16x16x32_bf16 v[92:95], v[172:175], v[20:23], v[92:95]
    v_mfma_f32_16x16x32_bf16 v[96:99], v[176:179], v[20:23], v[96:99]
    v_mfma_f32_16x16x32_bf16 v[100:103], v[180:183], v[20:23], v[100:103]
    buffer_load_dwordx4 v[20:23], v5, s[12:15], s18 offen sc1
    s_waitcnt vmcnt(13)
    v_mfma_f32_16x16x32_bf16 v[84:87], v[184:187], v[24:27], v[84:87]
    v_mfma_f32_16x16x32_bf16 v[88:91], v[188:191], v[24:27], v[88:91]
    v_mfma_f32_16x16x32_bf16 v[92:95], v[192:195], v[24:27], v[92:95]
    v_mfma_f32_16x16x32_bf16 v[96:99], v[196:199], v[24:27], v[96:99]
    v_mfma_f32_16x16x32_bf16 v[100:103], v[200:203], v[24:27], v[100:103]
    buffer_load_dwordx2 v[24:25], v9, s[12:15], s27 offen sc1
    buffer_load_dwordx2 v[26:27], v9, s[12:15], s29 offen sc1
    s_waitcnt vmcnt(14)
    v_mfma_f32_16x16x32_bf16 v[84:87], v[204:207], v[28:31], v[84:87]
    v_mfma_f32_16x16x32_bf16 v[88:91], v[208:211], v[28:31], v[88:91]
    v_mfma_f32_16x16x32_bf16 v[92:95], v[212:215], v[28:31], v[92:95]
    v_mfma_f32_16x16x32_bf16 v[96:99], v[216:219], v[28:31], v[96:99]
    v_mfma_f32_16x16x32_bf16 v[100:103], v[220:223], v[28:31], v[100:103]
    buffer_load_dwordx4 v[28:31], v2, s[12:15], s26 offen sc1
    s_waitcnt vmcnt(13)
    v_mfma_f32_16x16x32_bf16 v[84:87], v[224:227], v[32:35], v[84:87]
    v_mfma_f32_16x16x32_bf16 v[88:91], v[228:231], v[32:35], v[88:91]
    v_mfma_f32_16x16x32_bf16 v[92:95], v[232:235], v[32:35], v[92:95]
    v_mfma_f32_16x16x32_bf16 v[96:99], v[236:239], v[32:35], v[96:99]
    v_mfma_f32_16x16x32_bf16 v[100:103], v[240:243], v[32:35], v[100:103]
    buffer_load_dwordx4 v[32:35], v2, s[12:15], s16 offen sc1
    s_waitcnt vmcnt(13)
    v_mfma_f32_16x16x32_bf16 v[104:107], v[144:147], v[36:39], v[104:107]
    v_mfma_f32_16x16x32_bf16 v[108:111], v[148:151], v[36:39], v[108:111]
    v_mfma_f32_16x16x32_bf16 v[112:115], v[152:155], v[36:39], v[112:115]
    v_mfma_f32_16x16x32_bf16 v[116:119], v[156:159], v[36:39], v[116:119]
    v_mfma_f32_16x16x32_bf16 v[120:123], v[160:163], v[36:39], v[120:123]
    ds_write_b128 v11, v[84:87] offset:0
    buffer_load_dwordx4 v[36:39], v2, s[12:15], s17 offen sc1
    s_waitcnt vmcnt(13)
    v_mfma_f32_16x16x32_bf16 v[104:107], v[164:167], v[40:43], v[104:107]
    ds_write_b128 v11, v[88:91] offset:1024
    v_mfma_f32_16x16x32_bf16 v[108:111], v[168:171], v[40:43], v[108:111]
    ds_write_b128 v11, v[92:95] offset:2048
    v_mfma_f32_16x16x32_bf16 v[112:115], v[172:175], v[40:43], v[112:115]
    ds_write_b128 v11, v[96:99] offset:3072
    v_mfma_f32_16x16x32_bf16 v[116:119], v[176:179], v[40:43], v[116:119]
    ds_write_b128 v11, v[100:103] offset:4096
    v_mfma_f32_16x16x32_bf16 v[120:123], v[180:183], v[40:43], v[120:123]
    buffer_load_dwordx4 v[40:43], v2, s[12:15], s18 offen sc1
    s_waitcnt vmcnt(13)
    v_mfma_f32_16x16x32_bf16 v[104:107], v[184:187], v[44:47], v[104:107]
    v_mfma_f32_16x16x32_bf16 v[108:111], v[188:191], v[44:47], v[108:111]
    v_mfma_f32_16x16x32_bf16 v[112:115], v[192:195], v[44:47], v[112:115]
    v_mfma_f32_16x16x32_bf16 v[116:119], v[196:199], v[44:47], v[116:119]
    v_mfma_f32_16x16x32_bf16 v[120:123], v[200:203], v[44:47], v[120:123]
    buffer_load_dwordx2 v[44:45], v6, s[12:15], s27 offen sc1
    buffer_load_dwordx2 v[46:47], v6, s[12:15], s29 offen sc1
    s_waitcnt vmcnt(14)
    v_mfma_f32_16x16x32_bf16 v[104:107], v[204:207], v[48:51], v[104:107]
    v_mfma_f32_16x16x32_bf16 v[108:111], v[208:211], v[48:51], v[108:111]
    v_mfma_f32_16x16x32_bf16 v[112:115], v[212:215], v[48:51], v[112:115]
    v_mfma_f32_16x16x32_bf16 v[116:119], v[216:219], v[48:51], v[116:119]
    v_mfma_f32_16x16x32_bf16 v[120:123], v[220:223], v[48:51], v[120:123]
    s_waitcnt vmcnt(12)
    v_mfma_f32_16x16x32_bf16 v[104:107], v[224:227], v[52:55], v[104:107]
    v_mfma_f32_16x16x32_bf16 v[108:111], v[228:231], v[52:55], v[108:111]
    v_mfma_f32_16x16x32_bf16 v[112:115], v[232:235], v[52:55], v[112:115]
    v_mfma_f32_16x16x32_bf16 v[116:119], v[236:239], v[52:55], v[116:119]
    v_mfma_f32_16x16x32_bf16 v[120:123], v[240:243], v[52:55], v[120:123]
    s_waitcnt vmcnt(11)
    v_mfma_f32_16x16x32_bf16 v[124:127], v[144:147], v[56:59], v[124:127]
    v_mfma_f32_16x16x32_bf16 v[128:131], v[148:151], v[56:59], v[128:131]
    v_mfma_f32_16x16x32_bf16 v[132:135], v[152:155], v[56:59], v[132:135]
    v_mfma_f32_16x16x32_bf16 v[136:139], v[156:159], v[56:59], v[136:139]
    v_mfma_f32_16x16x32_bf16 v[140:143], v[160:163], v[56:59], v[140:143]
    ds_write_b128 v11, v[104:107] offset:5120
    s_waitcnt vmcnt(10)
    v_mfma_f32_16x16x32_bf16 v[124:127], v[164:167], v[60:63], v[124:127]
    ds_write_b128 v11, v[108:111] offset:6144
    v_mfma_f32_16x16x32_bf16 v[128:131], v[168:171], v[60:63], v[128:131]
    ds_write_b128 v11, v[112:115] offset:7168
    v_mfma_f32_16x16x32_bf16 v[132:135], v[172:175], v[60:63], v[132:135]
    ds_write_b128 v11, v[116:119] offset:8192
    v_mfma_f32_16x16x32_bf16 v[136:139], v[176:179], v[60:63], v[136:139]
    ds_write_b128 v11, v[120:123] offset:9216
    v_mfma_f32_16x16x32_bf16 v[140:143], v[180:183], v[60:63], v[140:143]
    s_waitcnt vmcnt(9)
    v_mfma_f32_16x16x32_bf16 v[124:127], v[184:187], v[16:19], v[124:127]
    v_mfma_f32_16x16x32_bf16 v[128:131], v[188:191], v[16:19], v[128:131]
    v_mfma_f32_16x16x32_bf16 v[132:135], v[192:195], v[16:19], v[132:135]
    v_mfma_f32_16x16x32_bf16 v[136:139], v[196:199], v[16:19], v[136:139]
    v_mfma_f32_16x16x32_bf16 v[140:143], v[200:203], v[16:19], v[140:143]
    s_waitcnt vmcnt(8)
    v_mfma_f32_16x16x32_bf16 v[124:127], v[204:207], v[20:23], v[124:127]
    v_mfma_f32_16x16x32_bf16 v[128:131], v[208:211], v[20:23], v[128:131]
    v_mfma_f32_16x16x32_bf16 v[132:135], v[212:215], v[20:23], v[132:135]
    v_mfma_f32_16x16x32_bf16 v[136:139], v[216:219], v[20:23], v[136:139]
    v_mfma_f32_16x16x32_bf16 v[140:143], v[220:223], v[20:23], v[140:143]
    s_waitcnt vmcnt(6)
    v_mfma_f32_16x16x32_bf16 v[124:127], v[224:227], v[24:27], v[124:127]
    v_mfma_f32_16x16x32_bf16 v[128:131], v[228:231], v[24:27], v[128:131]
    v_mfma_f32_16x16x32_bf16 v[132:135], v[232:235], v[24:27], v[132:135]
    v_mfma_f32_16x16x32_bf16 v[136:139], v[236:239], v[24:27], v[136:139]
    v_mfma_f32_16x16x32_bf16 v[140:143], v[240:243], v[24:27], v[140:143]
    s_waitcnt vmcnt(5)
    v_mfma_f32_16x16x32_bf16 v[64:67], v[144:147], v[28:31], v[64:67]
    v_mfma_f32_16x16x32_bf16 v[68:71], v[148:151], v[28:31], v[68:71]
    v_mfma_f32_16x16x32_bf16 v[72:75], v[152:155], v[28:31], v[72:75]
    v_mfma_f32_16x16x32_bf16 v[76:79], v[156:159], v[28:31], v[76:79]
    v_mfma_f32_16x16x32_bf16 v[80:83], v[160:163], v[28:31], v[80:83]
    ds_write_b128 v11, v[124:127] offset:10240
    s_waitcnt vmcnt(4)
    v_mfma_f32_16x16x32_bf16 v[64:67], v[164:167], v[32:35], v[64:67]
    ds_write_b128 v11, v[128:131] offset:11264
    v_mfma_f32_16x16x32_bf16 v[68:71], v[168:171], v[32:35], v[68:71]
    ds_write_b128 v11, v[132:135] offset:12288
    v_mfma_f32_16x16x32_bf16 v[72:75], v[172:175], v[32:35], v[72:75]
    ds_write_b128 v11, v[136:139] offset:13312
    v_mfma_f32_16x16x32_bf16 v[76:79], v[176:179], v[32:35], v[76:79]
    ds_write_b128 v11, v[140:143] offset:14336
    v_mfma_f32_16x16x32_bf16 v[80:83], v[180:183], v[32:35], v[80:83]
    s_waitcnt vmcnt(3)
    v_mfma_f32_16x16x32_bf16 v[64:67], v[184:187], v[36:39], v[64:67]
    v_mfma_f32_16x16x32_bf16 v[68:71], v[188:191], v[36:39], v[68:71]
    v_mfma_f32_16x16x32_bf16 v[72:75], v[192:195], v[36:39], v[72:75]
    v_mfma_f32_16x16x32_bf16 v[76:79], v[196:199], v[36:39], v[76:79]
    v_mfma_f32_16x16x32_bf16 v[80:83], v[200:203], v[36:39], v[80:83]
    s_waitcnt lgkmcnt(0)
    s_barrier
    ds_read_b128 v[84:87], v245 offset:0
    ds_read_b128 v[104:107], v247 offset:5120
    s_waitcnt vmcnt(2)
    v_mfma_f32_16x16x32_bf16 v[64:67], v[204:207], v[40:43], v[64:67]
    ds_read_b128 v[124:127], v249 offset:10240
    ds_read_b128 v[88:91], v245 offset:1024
    v_mfma_f32_16x16x32_bf16 v[68:71], v[208:211], v[40:43], v[68:71]
    ds_read_b128 v[108:111], v247 offset:6144
    ds_read_b128 v[128:131], v249 offset:11264
    v_mfma_f32_16x16x32_bf16 v[72:75], v[212:215], v[40:43], v[72:75]
    ds_read_b128 v[92:95], v245 offset:2048
    ds_read_b128 v[112:115], v247 offset:7168
    v_mfma_f32_16x16x32_bf16 v[76:79], v[216:219], v[40:43], v[76:79]
    ds_read_b128 v[132:135], v249 offset:12288
    ds_read_b128 v[96:99], v245 offset:3072
    v_mfma_f32_16x16x32_bf16 v[80:83], v[220:223], v[40:43], v[80:83]
    ds_read_b128 v[116:119], v247 offset:8192
    ds_read_b128 v[136:139], v249 offset:13312
    s_waitcnt vmcnt(0)
    v_mfma_f32_16x16x32_bf16 v[64:67], v[224:227], v[44:47], v[64:67]
    ds_read_b128 v[100:103], v245 offset:4096
    ds_read_b128 v[120:123], v247 offset:9216
    v_mfma_f32_16x16x32_bf16 v[68:71], v[228:231], v[44:47], v[68:71]
    ds_read_b128 v[140:143], v249 offset:14336
    v_mfma_f32_16x16x32_bf16 v[72:75], v[232:235], v[44:47], v[72:75]
    v_mfma_f32_16x16x32_bf16 v[76:79], v[236:239], v[44:47], v[76:79]
    v_mfma_f32_16x16x32_bf16 v[80:83], v[240:243], v[44:47], v[80:83]
    s_waitcnt lgkmcnt(12)
    v_pk_add_f32 v[84:85], v[84:85], v[104:105]
    v_pk_add_f32 v[86:87], v[86:87], v[106:107]
    v_pk_add_f32 v[84:85], v[84:85], v[124:125]
    v_pk_add_f32 v[86:87], v[86:87], v[126:127]
    v_pk_add_f32 v[64:65], v[64:65], v[84:85]
    v_pk_add_f32 v[66:67], v[66:67], v[86:87]
    v_cvt_pk_bf16_f32 v64, v64, v65
    v_cvt_pk_bf16_f32 v65, v66, v67
    ds_write_b64 v10, v[64:65] offset:16384
    s_waitcnt lgkmcnt(10)
    v_pk_add_f32 v[88:89], v[88:89], v[108:109]
    v_pk_add_f32 v[90:91], v[90:91], v[110:111]
    v_pk_add_f32 v[88:89], v[88:89], v[128:129]
    v_pk_add_f32 v[90:91], v[90:91], v[130:131]
    v_pk_add_f32 v[68:69], v[68:69], v[88:89]
    v_pk_add_f32 v[70:71], v[70:71], v[90:91]
    v_cvt_pk_bf16_f32 v68, v68, v69
    v_cvt_pk_bf16_f32 v69, v70, v71
    ds_write_b64 v10, v[68:69] offset:16416
    s_waitcnt lgkmcnt(8)
    v_pk_add_f32 v[92:93], v[92:93], v[112:113]
    v_pk_add_f32 v[94:95], v[94:95], v[114:115]
    v_pk_add_f32 v[92:93], v[92:93], v[132:133]
    v_pk_add_f32 v[94:95], v[94:95], v[134:135]
    v_pk_add_f32 v[72:73], v[72:73], v[92:93]
    v_pk_add_f32 v[74:75], v[74:75], v[94:95]
    v_cvt_pk_bf16_f32 v72, v72, v73
    v_cvt_pk_bf16_f32 v73, v74, v75
    ds_write_b64 v10, v[72:73] offset:16448
    s_waitcnt lgkmcnt(6)
    v_pk_add_f32 v[96:97], v[96:97], v[116:117]
    v_pk_add_f32 v[98:99], v[98:99], v[118:119]
    v_pk_add_f32 v[96:97], v[96:97], v[136:137]
    v_pk_add_f32 v[98:99], v[98:99], v[138:139]
    v_pk_add_f32 v[76:77], v[76:77], v[96:97]
    v_pk_add_f32 v[78:79], v[78:79], v[98:99]
    v_cvt_pk_bf16_f32 v76, v76, v77
    v_cvt_pk_bf16_f32 v77, v78, v79
    ds_write_b64 v10, v[76:77] offset:16480
    s_waitcnt lgkmcnt(4)
    v_pk_add_f32 v[100:101], v[100:101], v[120:121]
    v_pk_add_f32 v[102:103], v[102:103], v[122:123]
    v_pk_add_f32 v[100:101], v[100:101], v[140:141]
    v_pk_add_f32 v[102:103], v[102:103], v[142:143]
    v_pk_add_f32 v[80:81], v[80:81], v[100:101]
    v_pk_add_f32 v[82:83], v[82:83], v[102:103]
    v_cvt_pk_bf16_f32 v80, v80, v81
    v_cvt_pk_bf16_f32 v81, v82, v83
    ds_write_b64 v10, v[80:81] offset:16512
    ds_read_b128 v[16:19], v11 offset:16384
    ds_read_b128 v[20:23], v11 offset:17408
    ds_read_b128 v[24:27], v11 offset:18432
    s_waitcnt lgkmcnt(2)
    buffer_store_dwordx4 v[16:19], v1, s[64:67], s28 offen
    s_waitcnt lgkmcnt(1)
    buffer_store_dwordx4 v[20:23], v15, s[64:67], s28 offen
    s_waitcnt lgkmcnt(0)
    s_mov_b32 exec_hi, 0
    buffer_store_dwordx4 v[24:27], v255, s[64:67], s28 offen
    s_mov_b32 exec_hi, -1
    s_or_b32 s3, s2, s77
    s_cmp_lg_u32 s3, 0
    s_cbranch_scc1 L_noe_32
    s_mov_b32 s85, 0
    v_mov_b32 v16, s74
    v_mov_b32 v17, s75
    v_mov_b32 v18, 0
    s_mov_b64 exec, 1
    buffer_store_dwordx2 v[16:17], v18, s[12:15], s85 offen sc1
    s_mov_b64 exec, -1
L_noe_32:
L_end:
    s_endpgm
.section .rodata,"a"
.p2align 6
.amdhsa_kernel gated_mix__mha_block__mixer_token_mlp__prompt_kernel
  .amdhsa_next_free_vgpr 256
  .amdhsa_next_free_sgpr 102
  .amdhsa_accum_offset 256
  .amdhsa_group_segment_fixed_size 0
  .amdhsa_kernarg_size 96
  .amdhsa_user_sgpr_count 2
  .amdhsa_user_sgpr_kernarg_segment_ptr 1
  .amdhsa_system_sgpr_workgroup_id_x 1
.end_amdhsa_kernel
```
